```python
import torch

def _softmax(x, axis=-1):
    return torch.softmax(x, dim=axis)
def _gelu(x):
    return torch.nn.functional.gelu(x, approximate="tanh")
def _silu(x):
    return torch.nn.functional.silu(x)
def _sigmoid(x):
    return torch.sigmoid(x)
def _layernorm(x, axis=-1, eps=1e-5):
    m = x.mean(dim=axis, keepdim=True)
    v = x.var(dim=axis, keepdim=True, unbiased=False)
    return (x - m) / torch.sqrt(v + eps)
def _scatter_add(tgt, idx, src, axis=0):
    return tgt.clone().index_add_(axis, idx, src)
def _segment_sum(src, seg, n):
    out = torch.zeros((n,) + src.shape[1:], dtype=src.dtype)
    return out.index_add_(0, seg, src)
def _pad(x, pw):
    flat = tuple(v for pair in reversed(pw) for v in pair)
    return torch.nn.functional.pad(x, flat)

kernel_name = 'recurrent_scan__linear_kernel_hedgehog__glu_gated_bilinear__prompt'

def setup_inputs():

    _w = (lambda a: (lambda t: t.to(torch.bfloat16) if t.is_floating_point() else t)(torch.as_tensor(a)))
    def _A_setup():
        B, S, D, H = 1, 2048, 512, 32
        Dh = D // H
        return {
            "x": _w((lambda *s: torch.randn(*s, dtype=torch.bfloat16) * 0.05)(B, S, D)),
            "wqkv": _w((lambda *s: torch.randn(*s, dtype=torch.bfloat16) * 0.8)(D, 3 * D)),
            "w_phi": _w((lambda *s: torch.randn(*s, dtype=torch.bfloat16) * 0.8)(H, Dh, Dh) * (Dh ** -0.5)),
            "wo": _w((lambda *s: torch.randn(*s, dtype=torch.bfloat16) * 0.8)(D, D)),
        }
    _A_in = _A_setup()

    def _B_setup():
        B, S, D, F = 1, 2048, 512, 1792
        return {
            "x": _w((lambda *s: torch.randn(*s, dtype=torch.bfloat16) * 0.05)(B, S, D)),
            "w_gate": _w((lambda *s: torch.randn(*s, dtype=torch.bfloat16) * 0.2)(D, F) * (D ** -0.5)),
            "w_up": _w((lambda *s: torch.randn(*s, dtype=torch.bfloat16) * 0.2)(D, F) * (D ** -0.5)),
            "w_down": _w((lambda *s: torch.randn(*s, dtype=torch.bfloat16) * 0.2)(F, D) * (F ** -0.5)),
        }
    _B_in = _B_setup()

    return {
        "A_x": _A_in["x"],
        "A_wqkv": _A_in["wqkv"],
        "A_w_phi": _A_in["w_phi"],
        "A_wo": _A_in["wo"],
        "B_x": _B_in["x"],
        "B_w_gate": _B_in["w_gate"],
        "B_w_up": _B_in["w_up"],
        "B_w_down": _B_in["w_down"],
    }

def reference(A_x, A_wqkv, A_w_phi, A_wo, B_x, B_w_gate, B_w_up, B_w_down):
    def _A_ref(x, wqkv, w_phi, wo):
        B, S, D = x.shape
        H = 32; Dh = D // H
        qkv = (lambda x, *d: x.permute(*d))((x @ wqkv).reshape(B, S, 3, H, Dh), 2, 0, 3, 1, 4)
        q, k, v = qkv[0], qkv[1], qkv[2]
        pq = torch.einsum("bhsd,hdf->bhsf", q, w_phi)
        pk = torch.einsum("bhsd,hdf->bhsf", k, w_phi)
        phi_q = torch.concatenate([_softmax(pq, axis=-1), _softmax(-pq, axis=-1)], axis=-1)
        phi_k = torch.concatenate([_softmax(pk, axis=-1), _softmax(-pk, axis=-1)], axis=-1)
        kv = torch.einsum("bhsf,bhsd->bhfd", phi_k, v)
        z  = torch.einsum("bhsf->bhf", phi_k)
        num = torch.einsum("bhqf,bhfd->bhqd", phi_q, kv)
        den = torch.einsum("bhqf,bhf->bhq", phi_q, z)[..., None] + 1e-6
        o = num / den
        return (lambda x, *d: x.permute(*d))(o, 0, 2, 1, 3).reshape(B, S, D) @ wo

    def _B_ref(x, w_gate, w_up, w_down):
        g = torch.einsum("bsd,df->bsf", x, w_gate)
        u = torch.einsum("bsd,df->bsf", x, w_up)
        h = g * u
        return torch.einsum("bsf,fd->bsd", h, w_down)

    x = A_x
    xn = _layernorm(x, axis=-1)
    s = _A_ref(xn, A_wqkv, A_w_phi, A_wo)
    g = _silu(_B_ref(xn, B_w_gate, B_w_up, B_w_down))
    return x + s * g
```

```asm
; @launch grid=(256,1,1) block=(256,1,1) lds=163840
.amdgcn_target "amdgcn-amd-amdhsa--gfx950"
.text
.globl recurrent_scan__linear_kernel_hedgehog__glu_gated_bilinear__prompt_kernel
.p2align 8
.type recurrent_scan__linear_kernel_hedgehog__glu_gated_bilinear__prompt_kernel,@function
recurrent_scan__linear_kernel_hedgehog__glu_gated_bilinear__prompt_kernel:
    s_load_dwordx2 s[8:9], s[0:1], 0
    s_load_dwordx2 s[44:45], s[0:1], 80
    s_cmp_ge_u32 s2, 256
    s_cbranch_scc1 L_end
    v_lshrrev_b32 v20, 6, v0
    v_and_b32 v1, 63, v0
    s_lshr_b32 s6, s2, 3
    v_readfirstlane_b32 s3, v20
    v_lshrrev_b32 v23, 3, v1
    v_and_b32_e64 v24, 7, v1
    s_bfe_u32 s4, s2, 0x10002
    s_lshl_b32 s4, s4, 3
    s_and_b32 s59, s6, 7
    s_add_u32 s4, s4, s59
    s_lshr_b32 s59, s2, 6
    s_and_b32 s64, s59, 1
    s_cmp_eq_u32 s59, 1
    s_cselect_b32 s59, 1, 0
    s_xor_b32 s60, s3, s59
    s_lshl_b32 s61, s4, 2
    s_add_u32 s61, s60, s61
    s_lshl_b32 s61, s61, 2
    s_add_u32 s61, s61, s64
    s_lshl_b32 s72, s61, 13
    s_and_b32 s65, s6, 3
    s_lshl_b32 s59, s65, 8
    v_lshlrev_b32 v25, 10, v23
    v_lshl_add_u32 v25, v24, 4, v25
    v_add_u32 v52, s59, v25
    s_movk_i32 s59, 256
    v_xor_b32 v53, s59, v52
    s_movk_i32 s59, 512
    v_xor_b32 v54, s59, v52
    v_xor_b32 v55, s59, v53
    s_mov_b32 s10, 0x200000
    s_mov_b32 s11, 0x20000
    s_getpc_b64 s[90:91]
L_pc:
    s_lshl_b32 s59, s6, 12
    v_lshlrev_b32 v26, 4, v0
    v_add_u32 v26, s59, v26
    v_min_u32 v26, L_code_end-L_pc-16, v26
    v_mov_b32 v27, s91
    v_add_co_u32 v26, vcc, s90, v26
    s_nop 1
    v_addc_co_u32 v27, vcc, 0, v27, vcc
    global_load_dwordx4 v[80:83], v[26:27], off
    s_waitcnt lgkmcnt(0)
    s_nop 0
    buffer_load_dwordx4 v[128:131], v52, s[8:11], s72 offen offset:0
    buffer_load_dwordx4 v[132:135], v52, s[8:11], s72 offen offset:128
    buffer_load_dwordx4 v[136:139], v53, s[8:11], s72 offen offset:0
    buffer_load_dwordx4 v[140:143], v53, s[8:11], s72 offen offset:128
    buffer_load_dwordx4 v[192:195], v54, s[8:11], s72 offen offset:0
    buffer_load_dwordx4 v[196:199], v54, s[8:11], s72 offen offset:128
    buffer_load_dwordx4 v[200:203], v55, s[8:11], s72 offen offset:0
    buffer_load_dwordx4 v[204:207], v55, s[8:11], s72 offen offset:128
    s_xor_b32 s73, s72, 8192
    buffer_load_dwordx4 v[144:147], v52, s[8:11], s73 offen offset:0
    buffer_load_dwordx4 v[148:151], v52, s[8:11], s73 offen offset:128
    s_load_dwordx2 s[12:13], s[0:1], 8
    s_load_dwordx2 s[32:33], s[0:1], 16
    s_load_dwordx2 s[28:29], s[0:1], 24
    s_load_dwordx2 s[24:25], s[0:1], 56
    s_load_dwordx2 s[36:37], s[0:1], 64
    s_load_dwordx2 s[40:41], s[0:1], 72
    s_load_dwordx4 s[76:79], s[0:1], 40
    s_lshl_b32 s60, s3, 13
    s_add_u32 s60, s60, 98304
    v_lshlrev_b32 v4, 8, v24
    v_xor_b32_e64 v25, v23, v24
    v_lshl_add_u32 v4, v25, 4, v4
    v_add_u32_e64 v4, s60, v4
    v_add_u32 v63, 32768, v4
    v_subrev_u32 v4, 32768, v4
    v_lshrrev_b32 v21, 4, v1
    v_and_b32 v22, 15, v1
    s_mov_b32 s14, 0x180000
    s_mov_b32 s15, 0x20000
    s_mov_b32 s34, 0x4000
    s_mov_b32 s35, 0x20000
    s_bfe_u32 s59, s2, 0x10006
    s_and_b32 s5, s2, 3
    s_lshl_b32 s5, s5, 1
    s_add_u32 s5, s5, s59
    v_lshlrev_b32 v2, 4, v1
    s_add_u32 s68, s60, 4096
    s_lshl_b32 s62, s5, 1
    s_and_b32 s61, s3, 1
    s_add_u32 s62, s62, s61
    s_lshl_b32 s62, s62, 10
    v_bfe_u32 v61, v1, 1, 1
    v_lshlrev_b32 v61, 9, v61
    v_lshrrev_b32 v62, 2, v1
    v_lshl_add_u32 v61, v62, 5, v61
    v_add_u32 v61, s60, v61
    s_lshl_b32 s59, s3, 5
    v_add_u32 v27, s59, v23
    v_and_b32 v26, 2, v23
    v_xor_b32 v26, v26, v24
    v_lshlrev_b32 v26, 4, v26
    s_movk_i32 s59, 3072
    v_mad_u32_u24 v12, v27, s59, v26
    v_xor_b32 v13, 64, v12
    v_add_u32 v13, 23552, v13
    s_movk_i32 s59, 3584
    v_mad_u32_u24 v14, v27, s59, v26
    v_xor_b32 v15, 64, v14
    v_add_u32 v15, 27648, v15
    s_lshl_b32 s56, s3, 12
    s_lshl_b32 s57, s5, 7
    s_bitcmp1_b32 s4, 2
    s_waitcnt lgkmcnt(0)
    s_cselect_b64 s[16:17], s[78:79], s[76:77]
    s_cselect_b64 s[20:21], s[76:77], s[78:79]
    s_mov_b32 s18, 0x1c0000
    s_mov_b32 s19, 0x20000
    v_xor_b32 v25, v22, v21
    v_lshlrev_b32 v25, 4, v25
    v_lshl_add_u32 v6, v21, 8, v25
    s_lshr_b32 s59, s3, 1
    s_lshl_b32 s59, s59, 14
    s_add_u32 s59, s59, 65536
    v_add_u32 v6, s59, v6
    v_xor_b32 v7, 64, v6
    v_bfe_u32 v25, v1, 2, 2
    v_lshl_add_u32 v25, v21, 3, v25
    v_lshlrev_b32 v25, 7, v25
    v_and_b32 v26, 3, v1
    v_lshl_add_u32 v25, v26, 3, v25
    v_and_b32 v26, 3, v23
    s_lshl_b32 s60, s61, 1
    v_xor_b32_e64 v26, s60, v26
    v_lshl_add_u32 v8, v26, 5, v25
    v_xor_b32_e64 v10, 32, v8
    s_mov_b32 s77, 0x3f803f80
    s_mul_i32 s90, s65, 393216
    s_mul_i32 s86, s65, 458752
    s_xor_b32 s59, s65, 1
    s_mul_i32 s91, s59, 393216
    s_xor_b32 s59, s65, 2
    s_mul_i32 s92, s59, 393216
    v_lshlrev_b32_e64 v5, 4, v0
    v_add_u32 v28, 0x10000, v6
    v_add_u32 v29, 0x10000, v7
    s_mov_b32 s81, 0x3b000000
    s_mov_b32 s82, 0x3727c5ac
    s_bitcmp1_b32 s2, 7
    s_cbranch_scc1 L_trace_q
L_split:
    s_waitcnt vmcnt(6)
    s_nop 0
    buffer_load_dwordx4 v[152:155], v53, s[8:11], s73 offen offset:0
    buffer_load_dwordx4 v[156:159], v53, s[8:11], s73 offen offset:128
    buffer_load_dwordx4 v[208:211], v54, s[8:11], s73 offen offset:0
    buffer_load_dwordx4 v[212:215], v54, s[8:11], s73 offen offset:128
    v_dot2_f32_bf16 v36, v128, s77, 0
    v_dot2_f32_bf16 v37, v128, v128, 0
    v_dot2_f32_bf16 v36, v129, s77, v36
    v_dot2_f32_bf16 v37, v129, v129, v37
    v_dot2_f32_bf16 v36, v130, s77, v36
    v_dot2_f32_bf16 v37, v130, v130, v37
    v_dot2_f32_bf16 v36, v131, s77, v36
    v_dot2_f32_bf16 v37, v131, v131, v37
    v_dot2_f32_bf16 v36, v132, s77, v36
    v_dot2_f32_bf16 v37, v132, v132, v37
    v_dot2_f32_bf16 v36, v133, s77, v36
    v_dot2_f32_bf16 v37, v133, v133, v37
    v_dot2_f32_bf16 v36, v134, s77, v36
    v_dot2_f32_bf16 v37, v134, v134, v37
    v_dot2_f32_bf16 v36, v135, s77, v36
    v_dot2_f32_bf16 v37, v135, v135, v37
    v_dot2_f32_bf16 v36, v136, s77, v36
    v_dot2_f32_bf16 v37, v136, v136, v37
    v_dot2_f32_bf16 v36, v137, s77, v36
    v_dot2_f32_bf16 v37, v137, v137, v37
    v_dot2_f32_bf16 v36, v138, s77, v36
    v_dot2_f32_bf16 v37, v138, v138, v37
    v_dot2_f32_bf16 v36, v139, s77, v36
    v_dot2_f32_bf16 v37, v139, v139, v37
    v_dot2_f32_bf16 v36, v140, s77, v36
    v_dot2_f32_bf16 v37, v140, v140, v37
    v_dot2_f32_bf16 v36, v141, s77, v36
    v_dot2_f32_bf16 v37, v141, v141, v37
    v_dot2_f32_bf16 v36, v142, s77, v36
    v_dot2_f32_bf16 v37, v142, v142, v37
    v_dot2_f32_bf16 v36, v143, s77, v36
    v_dot2_f32_bf16 v37, v143, v143, v37
    s_waitcnt vmcnt(6)
    s_nop 0
    buffer_load_dwordx4 v[216:219], v55, s[8:11], s73 offen offset:0
    buffer_load_dwordx4 v[220:223], v55, s[8:11], s73 offen offset:128
    s_xor_b32 s73, s72, 16384
    buffer_load_dwordx4 v[160:163], v52, s[8:11], s73 offen offset:0
    buffer_load_dwordx4 v[164:167], v52, s[8:11], s73 offen offset:128
    s_mov_b32 m0, s68
    s_nop 0
    buffer_load_dwordx4 v2, s[32:35], s62 offen lds
    v_dot2_f32_bf16 v36, v192, s77, v36
    v_dot2_f32_bf16 v37, v192, v192, v37
    v_dot2_f32_bf16 v36, v193, s77, v36
    v_dot2_f32_bf16 v37, v193, v193, v37
    v_dot2_f32_bf16 v36, v194, s77, v36
    v_dot2_f32_bf16 v37, v194, v194, v37
    v_dot2_f32_bf16 v36, v195, s77, v36
    v_dot2_f32_bf16 v37, v195, v195, v37
    v_dot2_f32_bf16 v36, v196, s77, v36
    v_dot2_f32_bf16 v37, v196, v196, v37
    v_dot2_f32_bf16 v36, v197, s77, v36
    v_dot2_f32_bf16 v37, v197, v197, v37
    v_dot2_f32_bf16 v36, v198, s77, v36
    v_dot2_f32_bf16 v37, v198, v198, v37
    v_dot2_f32_bf16 v36, v199, s77, v36
    v_dot2_f32_bf16 v37, v199, v199, v37
    v_dot2_f32_bf16 v36, v200, s77, v36
    v_dot2_f32_bf16 v37, v200, v200, v37
    v_dot2_f32_bf16 v36, v201, s77, v36
    v_dot2_f32_bf16 v37, v201, v201, v37
    v_dot2_f32_bf16 v36, v202, s77, v36
    v_dot2_f32_bf16 v37, v202, v202, v37
    v_dot2_f32_bf16 v36, v203, s77, v36
    v_dot2_f32_bf16 v37, v203, v203, v37
    v_dot2_f32_bf16 v36, v204, s77, v36
    v_dot2_f32_bf16 v37, v204, v204, v37
    v_dot2_f32_bf16 v36, v205, s77, v36
    v_dot2_f32_bf16 v37, v205, v205, v37
    v_dot2_f32_bf16 v36, v206, s77, v36
    v_dot2_f32_bf16 v37, v206, v206, v37
    v_dot2_f32_bf16 v36, v207, s77, v36
    v_dot2_f32_bf16 v37, v207, v207, v37
    s_nop 1
    v_add_f32_dpp v36, v36, v36 quad_perm:[1,0,3,2] row_mask:0xf bank_mask:0xf
    v_add_f32_dpp v37, v37, v37 quad_perm:[1,0,3,2] row_mask:0xf bank_mask:0xf
    s_nop 0
    v_add_f32_dpp v36, v36, v36 quad_perm:[2,3,0,1] row_mask:0xf bank_mask:0xf
    v_add_f32_dpp v37, v37, v37 quad_perm:[2,3,0,1] row_mask:0xf bank_mask:0xf
    s_nop 0
    v_add_f32_dpp v36, v36, v36 row_half_mirror row_mask:0xf bank_mask:0xf
    v_add_f32_dpp v37, v37, v37 row_half_mirror row_mask:0xf bank_mask:0xf
    v_mul_f32 v38, s81, v36
    v_mul_f32_e64 v39, v38, v38
    v_fma_f32 v39, v37, s81, -v39
    v_max_f32 v39, 0, v39
    v_add_f32 v39, s82, v39
    v_rsq_f32 v39, v39
    s_nop 0
    v_cvt_pk_bf16_f32 v40, v39, 0
    v_lshlrev_b32_e64 v41, 16, v40
    v_mul_f32 v42, -v38, v41
    v_dot2_f32_bf16 v64, v128, v40, v42
    v_dot2_f32_bf16 v65, v128, v41, v42
    v_dot2_f32_bf16 v66, v129, v40, v42
    v_dot2_f32_bf16 v67, v129, v41, v42
    v_dot2_f32_bf16 v68, v130, v40, v42
    v_dot2_f32_bf16 v69, v130, v41, v42
    v_dot2_f32_bf16 v70, v131, v40, v42
    v_dot2_f32_bf16 v71, v131, v41, v42
    v_cvt_pk_bf16_f32 v128, v64, v65
    v_cvt_pk_bf16_f32 v129, v66, v67
    v_cvt_pk_bf16_f32 v130, v68, v69
    v_cvt_pk_bf16_f32 v131, v70, v71
    ds_write_b128 v4, v[128:131] offset:32768
    v_dot2_f32_bf16 v72, v132, v40, v42
    v_dot2_f32_bf16 v73, v132, v41, v42
    v_dot2_f32_bf16 v74, v133, v40, v42
    v_dot2_f32_bf16 v75, v133, v41, v42
    v_dot2_f32_bf16 v76, v134, v40, v42
    v_dot2_f32_bf16 v77, v134, v41, v42
    v_dot2_f32_bf16 v78, v135, v40, v42
    v_dot2_f32_bf16 v79, v135, v41, v42
    v_cvt_pk_bf16_f32 v132, v72, v73
    v_cvt_pk_bf16_f32 v133, v74, v75
    v_cvt_pk_bf16_f32 v134, v76, v77
    v_cvt_pk_bf16_f32 v135, v78, v79
    ds_write_b128 v4, v[132:135] offset:34816
    v_dot2_f32_bf16 v64, v136, v40, v42
    v_dot2_f32_bf16 v65, v136, v41, v42
    v_dot2_f32_bf16 v66, v137, v40, v42
    v_dot2_f32_bf16 v67, v137, v41, v42
    v_dot2_f32_bf16 v68, v138, v40, v42
    v_dot2_f32_bf16 v69, v138, v41, v42
    v_dot2_f32_bf16 v70, v139, v40, v42
    v_dot2_f32_bf16 v71, v139, v41, v42
    v_cvt_pk_bf16_f32 v136, v64, v65
    v_cvt_pk_bf16_f32 v137, v66, v67
    v_cvt_pk_bf16_f32 v138, v68, v69
    v_cvt_pk_bf16_f32 v139, v70, v71
    ds_write_b128 v63, v[136:139] offset:0
    v_dot2_f32_bf16 v72, v140, v40, v42
    v_dot2_f32_bf16 v73, v140, v41, v42
    v_dot2_f32_bf16 v74, v141, v40, v42
    v_dot2_f32_bf16 v75, v141, v41, v42
    v_dot2_f32_bf16 v76, v142, v40, v42
    v_dot2_f32_bf16 v77, v142, v41, v42
    v_dot2_f32_bf16 v78, v143, v40, v42
    v_dot2_f32_bf16 v79, v143, v41, v42
    v_cvt_pk_bf16_f32 v140, v72, v73
    v_cvt_pk_bf16_f32 v141, v74, v75
    v_cvt_pk_bf16_f32 v142, v76, v77
    v_cvt_pk_bf16_f32 v143, v78, v79
    ds_write_b128 v63, v[140:143] offset:2048
    v_dot2_f32_bf16 v64, v192, v40, v42
    v_dot2_f32_bf16 v65, v192, v41, v42
    v_dot2_f32_bf16 v66, v193, v40, v42
    v_dot2_f32_bf16 v67, v193, v41, v42
    v_dot2_f32_bf16 v68, v194, v40, v42
    v_dot2_f32_bf16 v69, v194, v41, v42
    v_dot2_f32_bf16 v70, v195, v40, v42
    v_dot2_f32_bf16 v71, v195, v41, v42
    v_cvt_pk_bf16_f32 v192, v64, v65
    v_cvt_pk_bf16_f32 v193, v66, v67
    v_cvt_pk_bf16_f32 v194, v68, v69
    v_cvt_pk_bf16_f32 v195, v70, v71
    buffer_load_dwordx4 v[168:171], v53, s[8:11], s73 offen offset:0
    buffer_load_dwordx4 v[172:175], v53, s[8:11], s73 offen offset:128
    ds_write_b128 v4, v[192:195] offset:0
    v_dot2_f32_bf16 v72, v196, v40, v42
    v_dot2_f32_bf16 v73, v196, v41, v42
    v_dot2_f32_bf16 v74, v197, v40, v42
    v_dot2_f32_bf16 v75, v197, v41, v42
    v_dot2_f32_bf16 v76, v198, v40, v42
    v_dot2_f32_bf16 v77, v198, v41, v42
    v_dot2_f32_bf16 v78, v199, v40, v42
    v_dot2_f32_bf16 v79, v199, v41, v42
    v_cvt_pk_bf16_f32 v196, v72, v73
    v_cvt_pk_bf16_f32 v197, v74, v75
    v_cvt_pk_bf16_f32 v198, v76, v77
    v_cvt_pk_bf16_f32 v199, v78, v79
    ds_write_b128 v4, v[196:199] offset:2048
    v_dot2_f32_bf16 v64, v200, v40, v42
    v_dot2_f32_bf16 v65, v200, v41, v42
    v_dot2_f32_bf16 v66, v201, v40, v42
    v_dot2_f32_bf16 v67, v201, v41, v42
    v_dot2_f32_bf16 v68, v202, v40, v42
    v_dot2_f32_bf16 v69, v202, v41, v42
    v_dot2_f32_bf16 v70, v203, v40, v42
    v_dot2_f32_bf16 v71, v203, v41, v42
    v_cvt_pk_bf16_f32 v200, v64, v65
    v_cvt_pk_bf16_f32 v201, v66, v67
    v_cvt_pk_bf16_f32 v202, v68, v69
    v_cvt_pk_bf16_f32 v203, v70, v71
    buffer_load_dwordx4 v[224:227], v54, s[8:11], s73 offen offset:0
    buffer_load_dwordx4 v[228:231], v54, s[8:11], s73 offen offset:128
    v_dot2_f32_bf16 v72, v204, v40, v42
    v_dot2_f32_bf16 v73, v204, v41, v42
    v_dot2_f32_bf16 v74, v205, v40, v42
    v_dot2_f32_bf16 v75, v205, v41, v42
    v_dot2_f32_bf16 v76, v206, v40, v42
    v_dot2_f32_bf16 v77, v206, v41, v42
    v_dot2_f32_bf16 v78, v207, v40, v42
    v_dot2_f32_bf16 v79, v207, v41, v42
    v_cvt_pk_bf16_f32 v204, v72, v73
    v_cvt_pk_bf16_f32 v205, v74, v75
    v_cvt_pk_bf16_f32 v206, v76, v77
    v_cvt_pk_bf16_f32 v207, v78, v79
    s_waitcnt vmcnt(11)
    s_nop 0
    buffer_load_dwordx4 v[232:235], v55, s[8:11], s73 offen offset:0
    v_dot2_f32_bf16 v44, v144, s77, 0
    v_dot2_f32_bf16 v45, v144, v144, 0
    v_dot2_f32_bf16 v44, v145, s77, v44
    v_dot2_f32_bf16 v45, v145, v145, v45
    v_dot2_f32_bf16 v44, v146, s77, v44
    v_dot2_f32_bf16 v45, v146, v146, v45
    v_dot2_f32_bf16 v44, v147, s77, v44
    v_dot2_f32_bf16 v45, v147, v147, v45
    v_dot2_f32_bf16 v44, v148, s77, v44
    v_dot2_f32_bf16 v45, v148, v148, v45
    v_dot2_f32_bf16 v44, v149, s77, v44
    v_dot2_f32_bf16 v45, v149, v149, v45
    v_dot2_f32_bf16 v44, v150, s77, v44
    v_dot2_f32_bf16 v45, v150, v150, v45
    v_dot2_f32_bf16 v44, v151, s77, v44
    v_dot2_f32_bf16 v45, v151, v151, v45
    v_dot2_f32_bf16 v44, v152, s77, v44
    v_dot2_f32_bf16 v45, v152, v152, v45
    v_dot2_f32_bf16 v44, v153, s77, v44
    v_dot2_f32_bf16 v45, v153, v153, v45
    v_dot2_f32_bf16 v44, v154, s77, v44
    v_dot2_f32_bf16 v45, v154, v154, v45
    v_dot2_f32_bf16 v44, v155, s77, v44
    v_dot2_f32_bf16 v45, v155, v155, v45
    v_dot2_f32_bf16 v44, v156, s77, v44
    v_dot2_f32_bf16 v45, v156, v156, v45
    v_dot2_f32_bf16 v44, v157, s77, v44
    v_dot2_f32_bf16 v45, v157, v157, v45
    v_dot2_f32_bf16 v44, v158, s77, v44
    v_dot2_f32_bf16 v45, v158, v158, v45
    v_dot2_f32_bf16 v44, v159, s77, v44
    v_dot2_f32_bf16 v45, v159, v159, v45
    s_waitcnt vmcnt(8)
    s_nop 0
    buffer_load_dwordx4 v[236:239], v55, s[8:11], s73 offen offset:128
    s_xor_b32 s73, s72, 24576
    buffer_load_dwordx4 v[176:179], v52, s[8:11], s73 offen offset:0
    v_dot2_f32_bf16 v44, v208, s77, v44
    v_dot2_f32_bf16 v45, v208, v208, v45
    v_dot2_f32_bf16 v44, v209, s77, v44
    v_dot2_f32_bf16 v45, v209, v209, v45
    v_dot2_f32_bf16 v44, v210, s77, v44
    v_dot2_f32_bf16 v45, v210, v210, v45
    v_dot2_f32_bf16 v44, v211, s77, v44
    v_dot2_f32_bf16 v45, v211, v211, v45
    v_dot2_f32_bf16 v44, v212, s77, v44
    v_dot2_f32_bf16 v45, v212, v212, v45
    v_dot2_f32_bf16 v44, v213, s77, v44
    v_dot2_f32_bf16 v45, v213, v213, v45
    v_dot2_f32_bf16 v44, v214, s77, v44
    v_dot2_f32_bf16 v45, v214, v214, v45
    v_dot2_f32_bf16 v44, v215, s77, v44
    v_dot2_f32_bf16 v45, v215, v215, v45
    v_dot2_f32_bf16 v44, v216, s77, v44
    v_dot2_f32_bf16 v45, v216, v216, v45
    v_dot2_f32_bf16 v44, v217, s77, v44
    v_dot2_f32_bf16 v45, v217, v217, v45
    v_dot2_f32_bf16 v44, v218, s77, v44
    v_dot2_f32_bf16 v45, v218, v218, v45
    v_dot2_f32_bf16 v44, v219, s77, v44
    v_dot2_f32_bf16 v45, v219, v219, v45
    v_dot2_f32_bf16 v44, v220, s77, v44
    v_dot2_f32_bf16 v45, v220, v220, v45
    v_dot2_f32_bf16 v44, v221, s77, v44
    v_dot2_f32_bf16 v45, v221, v221, v45
    v_dot2_f32_bf16 v44, v222, s77, v44
    v_dot2_f32_bf16 v45, v222, v222, v45
    v_dot2_f32_bf16 v44, v223, s77, v44
    v_dot2_f32_bf16 v45, v223, v223, v45
    s_nop 1
    v_add_f32_dpp v44, v44, v44 quad_perm:[1,0,3,2] row_mask:0xf bank_mask:0xf
    v_add_f32_dpp v45, v45, v45 quad_perm:[1,0,3,2] row_mask:0xf bank_mask:0xf
    s_nop 0
    v_add_f32_dpp v44, v44, v44 quad_perm:[2,3,0,1] row_mask:0xf bank_mask:0xf
    v_add_f32_dpp v45, v45, v45 quad_perm:[2,3,0,1] row_mask:0xf bank_mask:0xf
    s_nop 0
    v_add_f32_dpp v44, v44, v44 row_half_mirror row_mask:0xf bank_mask:0xf
    v_add_f32_dpp v45, v45, v45 row_half_mirror row_mask:0xf bank_mask:0xf
    v_mul_f32 v46, s81, v44
    v_mul_f32_e64 v47, v46, v46
    v_fma_f32 v47, v45, s81, -v47
    v_max_f32 v47, 0, v47
    v_add_f32 v47, s82, v47
    v_rsq_f32 v47, v47
    s_nop 0
    v_cvt_pk_bf16_f32 v48, v47, 0
    v_lshlrev_b32_e64 v49, 16, v48
    v_mul_f32 v50, -v46, v49
    v_dot2_f32_bf16 v64, v144, v48, v50
    v_dot2_f32_bf16 v65, v144, v49, v50
    v_dot2_f32_bf16 v66, v145, v48, v50
    v_dot2_f32_bf16 v67, v145, v49, v50
    v_dot2_f32_bf16 v68, v146, v48, v50
    v_dot2_f32_bf16 v69, v146, v49, v50
    v_dot2_f32_bf16 v70, v147, v48, v50
    v_dot2_f32_bf16 v71, v147, v49, v50
    v_cvt_pk_bf16_f32 v144, v64, v65
    v_cvt_pk_bf16_f32 v145, v66, v67
    v_cvt_pk_bf16_f32 v146, v68, v69
    v_cvt_pk_bf16_f32 v147, v70, v71
    buffer_load_dwordx4 v[180:183], v52, s[8:11], s73 offen offset:128
    ds_write_b128 v4, v[144:147] offset:32896
    v_dot2_f32_bf16 v72, v148, v48, v50
    v_dot2_f32_bf16 v73, v148, v49, v50
    v_dot2_f32_bf16 v74, v149, v48, v50
    v_dot2_f32_bf16 v75, v149, v49, v50
    v_dot2_f32_bf16 v76, v150, v48, v50
    v_dot2_f32_bf16 v77, v150, v49, v50
    v_dot2_f32_bf16 v78, v151, v48, v50
    v_dot2_f32_bf16 v79, v151, v49, v50
    v_cvt_pk_bf16_f32 v148, v72, v73
    v_cvt_pk_bf16_f32 v149, v74, v75
    v_cvt_pk_bf16_f32 v150, v76, v77
    v_cvt_pk_bf16_f32 v151, v78, v79
    ds_write_b128 v4, v[148:151] offset:34944
    v_dot2_f32_bf16 v64, v152, v48, v50
    v_dot2_f32_bf16 v65, v152, v49, v50
    v_dot2_f32_bf16 v66, v153, v48, v50
    v_dot2_f32_bf16 v67, v153, v49, v50
    v_dot2_f32_bf16 v68, v154, v48, v50
    v_dot2_f32_bf16 v69, v154, v49, v50
    v_dot2_f32_bf16 v70, v155, v48, v50
    v_dot2_f32_bf16 v71, v155, v49, v50
    v_cvt_pk_bf16_f32 v152, v64, v65
    v_cvt_pk_bf16_f32 v153, v66, v67
    v_cvt_pk_bf16_f32 v154, v68, v69
    v_cvt_pk_bf16_f32 v155, v70, v71
    buffer_load_dwordx4 v[184:187], v53, s[8:11], s73 offen offset:0
    buffer_load_dwordx4 v[188:191], v53, s[8:11], s73 offen offset:128
    ds_write_b128 v63, v[152:155] offset:128
    v_dot2_f32_bf16 v72, v156, v48, v50
    v_dot2_f32_bf16 v73, v156, v49, v50
    v_dot2_f32_bf16 v74, v157, v48, v50
    v_dot2_f32_bf16 v75, v157, v49, v50
    v_dot2_f32_bf16 v76, v158, v48, v50
    v_dot2_f32_bf16 v77, v158, v49, v50
    v_dot2_f32_bf16 v78, v159, v48, v50
    v_dot2_f32_bf16 v79, v159, v49, v50
    v_cvt_pk_bf16_f32 v156, v72, v73
    v_cvt_pk_bf16_f32 v157, v74, v75
    v_cvt_pk_bf16_f32 v158, v76, v77
    v_cvt_pk_bf16_f32 v159, v78, v79
    ds_write_b128 v63, v[156:159] offset:2176
    v_dot2_f32_bf16 v64, v208, v48, v50
    v_dot2_f32_bf16 v65, v208, v49, v50
    v_dot2_f32_bf16 v66, v209, v48, v50
    v_dot2_f32_bf16 v67, v209, v49, v50
    v_dot2_f32_bf16 v68, v210, v48, v50
    v_dot2_f32_bf16 v69, v210, v49, v50
    v_dot2_f32_bf16 v70, v211, v48, v50
    v_dot2_f32_bf16 v71, v211, v49, v50
    v_cvt_pk_bf16_f32 v208, v64, v65
    v_cvt_pk_bf16_f32 v209, v66, v67
    v_cvt_pk_bf16_f32 v210, v68, v69
    v_cvt_pk_bf16_f32 v211, v70, v71
    buffer_load_dwordx4 v[240:243], v54, s[8:11], s73 offen offset:0
    ds_write_b128 v4, v[208:211] offset:128
    v_dot2_f32_bf16 v72, v212, v48, v50
    v_dot2_f32_bf16 v73, v212, v49, v50
    v_dot2_f32_bf16 v74, v213, v48, v50
    v_dot2_f32_bf16 v75, v213, v49, v50
    v_dot2_f32_bf16 v76, v214, v48, v50
    v_dot2_f32_bf16 v77, v214, v49, v50
    v_dot2_f32_bf16 v78, v215, v48, v50
    v_dot2_f32_bf16 v79, v215, v49, v50
    v_cvt_pk_bf16_f32 v212, v72, v73
    v_cvt_pk_bf16_f32 v213, v74, v75
    v_cvt_pk_bf16_f32 v214, v76, v77
    v_cvt_pk_bf16_f32 v215, v78, v79
    ds_write_b128 v4, v[212:215] offset:2176
    v_dot2_f32_bf16 v64, v216, v48, v50
    v_dot2_f32_bf16 v65, v216, v49, v50
    v_dot2_f32_bf16 v66, v217, v48, v50
    v_dot2_f32_bf16 v67, v217, v49, v50
    v_dot2_f32_bf16 v68, v218, v48, v50
    v_dot2_f32_bf16 v69, v218, v49, v50
    v_dot2_f32_bf16 v70, v219, v48, v50
    v_dot2_f32_bf16 v71, v219, v49, v50
    v_cvt_pk_bf16_f32 v216, v64, v65
    v_cvt_pk_bf16_f32 v217, v66, v67
    v_cvt_pk_bf16_f32 v218, v68, v69
    v_cvt_pk_bf16_f32 v219, v70, v71
    buffer_load_dwordx4 v[244:247], v54, s[8:11], s73 offen offset:128
    buffer_load_dwordx4 v[248:251], v55, s[8:11], s73 offen offset:0
    v_dot2_f32_bf16 v72, v220, v48, v50
    v_dot2_f32_bf16 v73, v220, v49, v50
    v_dot2_f32_bf16 v74, v221, v48, v50
    v_dot2_f32_bf16 v75, v221, v49, v50
    v_dot2_f32_bf16 v76, v222, v48, v50
    v_dot2_f32_bf16 v77, v222, v49, v50
    v_dot2_f32_bf16 v78, v223, v48, v50
    v_dot2_f32_bf16 v79, v223, v49, v50
    v_cvt_pk_bf16_f32 v220, v72, v73
    v_cvt_pk_bf16_f32 v221, v74, v75
    v_cvt_pk_bf16_f32 v222, v76, v77
    v_cvt_pk_bf16_f32 v223, v78, v79
    s_waitcnt vmcnt(11)
    s_nop 0
    buffer_load_dwordx4 v[252:255], v55, s[8:11], s73 offen offset:128
    v_dot2_f32_bf16 v36, v160, s77, 0
    v_dot2_f32_bf16 v37, v160, v160, 0
    v_dot2_f32_bf16 v36, v161, s77, v36
    v_dot2_f32_bf16 v37, v161, v161, v37
    v_dot2_f32_bf16 v36, v162, s77, v36
    v_dot2_f32_bf16 v37, v162, v162, v37
    v_dot2_f32_bf16 v36, v163, s77, v36
    v_dot2_f32_bf16 v37, v163, v163, v37
    v_dot2_f32_bf16 v36, v164, s77, v36
    v_dot2_f32_bf16 v37, v164, v164, v37
    v_dot2_f32_bf16 v36, v165, s77, v36
    v_dot2_f32_bf16 v37, v165, v165, v37
    v_dot2_f32_bf16 v36, v166, s77, v36
    v_dot2_f32_bf16 v37, v166, v166, v37
    v_dot2_f32_bf16 v36, v167, s77, v36
    v_dot2_f32_bf16 v37, v167, v167, v37
    v_dot2_f32_bf16 v36, v168, s77, v36
    v_dot2_f32_bf16 v37, v168, v168, v37
    v_dot2_f32_bf16 v36, v169, s77, v36
    v_dot2_f32_bf16 v37, v169, v169, v37
    v_dot2_f32_bf16 v36, v170, s77, v36
    v_dot2_f32_bf16 v37, v170, v170, v37
    v_dot2_f32_bf16 v36, v171, s77, v36
    v_dot2_f32_bf16 v37, v171, v171, v37
    v_dot2_f32_bf16 v36, v172, s77, v36
    v_dot2_f32_bf16 v37, v172, v172, v37
    v_dot2_f32_bf16 v36, v173, s77, v36
    v_dot2_f32_bf16 v37, v173, v173, v37
    v_dot2_f32_bf16 v36, v174, s77, v36
    v_dot2_f32_bf16 v37, v174, v174, v37
    v_dot2_f32_bf16 v36, v175, s77, v36
    v_dot2_f32_bf16 v37, v175, v175, v37
    s_waitcnt vmcnt(8)
    s_add_u32 m0, s56, 0
    s_add_u32 s59, s90, s57
    s_nop 0
    s_add_u32 s59, s59, 1024
    buffer_load_dwordx4 v12, s[12:15], s59 offen lds
    v_dot2_f32_bf16 v36, v224, s77, v36
    v_dot2_f32_bf16 v37, v224, v224, v37
    v_dot2_f32_bf16 v36, v225, s77, v36
    v_dot2_f32_bf16 v37, v225, v225, v37
    v_dot2_f32_bf16 v36, v226, s77, v36
    v_dot2_f32_bf16 v37, v226, v226, v37
    v_dot2_f32_bf16 v36, v227, s77, v36
    v_dot2_f32_bf16 v37, v227, v227, v37
    v_dot2_f32_bf16 v36, v228, s77, v36
    v_dot2_f32_bf16 v37, v228, v228, v37
    v_dot2_f32_bf16 v36, v229, s77, v36
    v_dot2_f32_bf16 v37, v229, v229, v37
    v_dot2_f32_bf16 v36, v230, s77, v36
    v_dot2_f32_bf16 v37, v230, v230, v37
    v_dot2_f32_bf16 v36, v231, s77, v36
    v_dot2_f32_bf16 v37, v231, v231, v37
    v_dot2_f32_bf16 v36, v232, s77, v36
    v_dot2_f32_bf16 v37, v232, v232, v37
    v_dot2_f32_bf16 v36, v233, s77, v36
    v_dot2_f32_bf16 v37, v233, v233, v37
    v_dot2_f32_bf16 v36, v234, s77, v36
    v_dot2_f32_bf16 v37, v234, v234, v37
    v_dot2_f32_bf16 v36, v235, s77, v36
    v_dot2_f32_bf16 v37, v235, v235, v37
    v_dot2_f32_bf16 v36, v236, s77, v36
    v_dot2_f32_bf16 v37, v236, v236, v37
    v_dot2_f32_bf16 v36, v237, s77, v36
    v_dot2_f32_bf16 v37, v237, v237, v37
    v_dot2_f32_bf16 v36, v238, s77, v36
    v_dot2_f32_bf16 v37, v238, v238, v37
    v_dot2_f32_bf16 v36, v239, s77, v36
    v_dot2_f32_bf16 v37, v239, v239, v37
    s_nop 1
    v_add_f32_dpp v36, v36, v36 quad_perm:[1,0,3,2] row_mask:0xf bank_mask:0xf
    v_add_f32_dpp v37, v37, v37 quad_perm:[1,0,3,2] row_mask:0xf bank_mask:0xf
    s_nop 0
    v_add_f32_dpp v36, v36, v36 quad_perm:[2,3,0,1] row_mask:0xf bank_mask:0xf
    v_add_f32_dpp v37, v37, v37 quad_perm:[2,3,0,1] row_mask:0xf bank_mask:0xf
    s_nop 0
    v_add_f32_dpp v36, v36, v36 row_half_mirror row_mask:0xf bank_mask:0xf
    v_add_f32_dpp v37, v37, v37 row_half_mirror row_mask:0xf bank_mask:0xf
    v_mul_f32 v38, s81, v36
    v_mul_f32_e64 v39, v38, v38
    v_fma_f32 v39, v37, s81, -v39
    v_max_f32 v39, 0, v39
    v_add_f32 v39, s82, v39
    v_rsq_f32 v39, v39
    s_nop 0
    v_cvt_pk_bf16_f32 v40, v39, 0
    v_lshlrev_b32_e64 v41, 16, v40
    v_mul_f32 v42, -v38, v41
    ds_read_b64_tr_b16 v[20:21], v61 offset:4096
    ds_read_b64_tr_b16 v[22:23], v61 offset:4104
    ds_read_b64_tr_b16 v[24:25], v61 offset:4112
    ds_read_b64_tr_b16 v[26:27], v61 offset:4120
    v_dot2_f32_bf16 v64, v160, v40, v42
    v_dot2_f32_bf16 v65, v160, v41, v42
    v_dot2_f32_bf16 v66, v161, v40, v42
    v_dot2_f32_bf16 v67, v161, v41, v42
    v_dot2_f32_bf16 v68, v162, v40, v42
    v_dot2_f32_bf16 v69, v162, v41, v42
    v_dot2_f32_bf16 v70, v163, v40, v42
    v_dot2_f32_bf16 v71, v163, v41, v42
    v_cvt_pk_bf16_f32 v160, v64, v65
    v_cvt_pk_bf16_f32 v161, v66, v67
    v_cvt_pk_bf16_f32 v162, v68, v69
    v_cvt_pk_bf16_f32 v163, v70, v71
    buffer_load_dwordx4 v13, s[12:15], s59 offen offset:1024 lds
    s_add_u32 m0, s56, 2048
    s_add_u32 s59, s90, s57
    s_nop 0
    s_add_u32 s59, s59, 50176
    buffer_load_dwordx4 v12, s[12:15], s59 offen lds
    ds_write_b128 v4, v[160:163] offset:36864
    v_dot2_f32_bf16 v72, v164, v40, v42
    v_dot2_f32_bf16 v73, v164, v41, v42
    v_dot2_f32_bf16 v74, v165, v40, v42
    v_dot2_f32_bf16 v75, v165, v41, v42
    v_dot2_f32_bf16 v76, v166, v40, v42
    v_dot2_f32_bf16 v77, v166, v41, v42
    v_dot2_f32_bf16 v78, v167, v40, v42
    v_dot2_f32_bf16 v79, v167, v41, v42
    v_cvt_pk_bf16_f32 v164, v72, v73
    v_cvt_pk_bf16_f32 v165, v74, v75
    v_cvt_pk_bf16_f32 v166, v76, v77
    v_cvt_pk_bf16_f32 v167, v78, v79
    ds_write_b128 v4, v[164:167] offset:38912
    v_dot2_f32_bf16 v64, v168, v40, v42
    v_dot2_f32_bf16 v65, v168, v41, v42
    v_dot2_f32_bf16 v66, v169, v40, v42
    v_dot2_f32_bf16 v67, v169, v41, v42
    v_dot2_f32_bf16 v68, v170, v40, v42
    v_dot2_f32_bf16 v69, v170, v41, v42
    v_dot2_f32_bf16 v70, v171, v40, v42
    v_dot2_f32_bf16 v71, v171, v41, v42
    v_cvt_pk_bf16_f32 v168, v64, v65
    v_cvt_pk_bf16_f32 v169, v66, v67
    v_cvt_pk_bf16_f32 v170, v68, v69
    v_cvt_pk_bf16_f32 v171, v70, v71
    buffer_load_dwordx4 v13, s[12:15], s59 offen offset:1024 lds
    ds_write_b128 v63, v[168:171] offset:4096
    v_dot2_f32_bf16 v72, v172, v40, v42
    v_dot2_f32_bf16 v73, v172, v41, v42
    v_dot2_f32_bf16 v74, v173, v40, v42
    v_dot2_f32_bf16 v75, v173, v41, v42
    v_dot2_f32_bf16 v76, v174, v40, v42
    v_dot2_f32_bf16 v77, v174, v41, v42
    v_dot2_f32_bf16 v78, v175, v40, v42
    v_dot2_f32_bf16 v79, v175, v41, v42
    v_cvt_pk_bf16_f32 v172, v72, v73
    v_cvt_pk_bf16_f32 v173, v74, v75
    v_cvt_pk_bf16_f32 v174, v76, v77
    v_cvt_pk_bf16_f32 v175, v78, v79
    ds_write_b128 v63, v[172:175] offset:6144
    v_dot2_f32_bf16 v64, v224, v40, v42
    v_dot2_f32_bf16 v65, v224, v41, v42
    v_dot2_f32_bf16 v66, v225, v40, v42
    v_dot2_f32_bf16 v67, v225, v41, v42
    v_dot2_f32_bf16 v68, v226, v40, v42
    v_dot2_f32_bf16 v69, v226, v41, v42
    v_dot2_f32_bf16 v70, v227, v40, v42
    v_dot2_f32_bf16 v71, v227, v41, v42
    v_cvt_pk_bf16_f32 v224, v64, v65
    v_cvt_pk_bf16_f32 v225, v66, v67
    v_cvt_pk_bf16_f32 v226, v68, v69
    v_cvt_pk_bf16_f32 v227, v70, v71
    s_add_u32 m0, s56, 16384
    s_add_u32 s59, s91, s57
    s_nop 0
    s_add_u32 s59, s59, 1024
    buffer_load_dwordx4 v12, s[12:15], s59 offen lds
    ds_write_b128 v4, v[224:227] offset:4096
    v_dot2_f32_bf16 v72, v228, v40, v42
    v_dot2_f32_bf16 v73, v228, v41, v42
    v_dot2_f32_bf16 v74, v229, v40, v42
    v_dot2_f32_bf16 v75, v229, v41, v42
    v_dot2_f32_bf16 v76, v230, v40, v42
    v_dot2_f32_bf16 v77, v230, v41, v42
    v_dot2_f32_bf16 v78, v231, v40, v42
    v_dot2_f32_bf16 v79, v231, v41, v42
    v_cvt_pk_bf16_f32 v228, v72, v73
    v_cvt_pk_bf16_f32 v229, v74, v75
    v_cvt_pk_bf16_f32 v230, v76, v77
    v_cvt_pk_bf16_f32 v231, v78, v79
    ds_write_b128 v4, v[228:231] offset:6144
    v_dot2_f32_bf16 v64, v232, v40, v42
    v_dot2_f32_bf16 v65, v232, v41, v42
    v_dot2_f32_bf16 v66, v233, v40, v42
    v_dot2_f32_bf16 v67, v233, v41, v42
    v_dot2_f32_bf16 v68, v234, v40, v42
    v_dot2_f32_bf16 v69, v234, v41, v42
    v_dot2_f32_bf16 v70, v235, v40, v42
    v_dot2_f32_bf16 v71, v235, v41, v42
    v_cvt_pk_bf16_f32 v232, v64, v65
    v_cvt_pk_bf16_f32 v233, v66, v67
    v_cvt_pk_bf16_f32 v234, v68, v69
    v_cvt_pk_bf16_f32 v235, v70, v71
    buffer_load_dwordx4 v13, s[12:15], s59 offen offset:1024 lds
    s_add_u32 m0, s56, 18432
    s_add_u32 s59, s91, s57
    s_nop 0
    s_add_u32 s59, s59, 50176
    buffer_load_dwordx4 v12, s[12:15], s59 offen lds
    v_dot2_f32_bf16 v72, v236, v40, v42
    v_dot2_f32_bf16 v73, v236, v41, v42
    v_dot2_f32_bf16 v74, v237, v40, v42
    v_dot2_f32_bf16 v75, v237, v41, v42
    v_dot2_f32_bf16 v76, v238, v40, v42
    v_dot2_f32_bf16 v77, v238, v41, v42
    v_dot2_f32_bf16 v78, v239, v40, v42
    v_dot2_f32_bf16 v79, v239, v41, v42
    v_cvt_pk_bf16_f32 v236, v72, v73
    v_cvt_pk_bf16_f32 v237, v74, v75
    v_cvt_pk_bf16_f32 v238, v76, v77
    v_cvt_pk_bf16_f32 v239, v78, v79
    s_waitcnt vmcnt(11)
    s_nop 0
    buffer_load_dwordx4 v13, s[12:15], s59 offen offset:1024 lds
    v_dot2_f32_bf16 v44, v176, s77, 0
    v_dot2_f32_bf16 v45, v176, v176, 0
    v_dot2_f32_bf16 v44, v177, s77, v44
    v_dot2_f32_bf16 v45, v177, v177, v45
    v_dot2_f32_bf16 v44, v178, s77, v44
    v_dot2_f32_bf16 v45, v178, v178, v45
    v_dot2_f32_bf16 v44, v179, s77, v44
    v_dot2_f32_bf16 v45, v179, v179, v45
    v_dot2_f32_bf16 v44, v180, s77, v44
    v_dot2_f32_bf16 v45, v180, v180, v45
    v_dot2_f32_bf16 v44, v181, s77, v44
    v_dot2_f32_bf16 v45, v181, v181, v45
    v_dot2_f32_bf16 v44, v182, s77, v44
    v_dot2_f32_bf16 v45, v182, v182, v45
    v_dot2_f32_bf16 v44, v183, s77, v44
    v_dot2_f32_bf16 v45, v183, v183, v45
    v_dot2_f32_bf16 v44, v184, s77, v44
    v_dot2_f32_bf16 v45, v184, v184, v45
    v_dot2_f32_bf16 v44, v185, s77, v44
    v_dot2_f32_bf16 v45, v185, v185, v45
    v_dot2_f32_bf16 v44, v186, s77, v44
    v_dot2_f32_bf16 v45, v186, v186, v45
    v_dot2_f32_bf16 v44, v187, s77, v44
    v_dot2_f32_bf16 v45, v187, v187, v45
    v_dot2_f32_bf16 v44, v188, s77, v44
    v_dot2_f32_bf16 v45, v188, v188, v45
    v_dot2_f32_bf16 v44, v189, s77, v44
    v_dot2_f32_bf16 v45, v189, v189, v45
    v_dot2_f32_bf16 v44, v190, s77, v44
    v_dot2_f32_bf16 v45, v190, v190, v45
    v_dot2_f32_bf16 v44, v191, s77, v44
    v_dot2_f32_bf16 v45, v191, v191, v45
    s_waitcnt vmcnt(8)
    s_add_u32 m0, s56, 32768
    s_add_u32 s59, s90, s57
    s_add_u32 s59, s59, 2048
    buffer_load_dwordx4 v12, s[12:15], s59 offen lds
    v_dot2_f32_bf16 v44, v240, s77, v44
    v_dot2_f32_bf16 v45, v240, v240, v45
    v_dot2_f32_bf16 v44, v241, s77, v44
    v_dot2_f32_bf16 v45, v241, v241, v45
    v_dot2_f32_bf16 v44, v242, s77, v44
    v_dot2_f32_bf16 v45, v242, v242, v45
    v_dot2_f32_bf16 v44, v243, s77, v44
    v_dot2_f32_bf16 v45, v243, v243, v45
    v_dot2_f32_bf16 v44, v244, s77, v44
    v_dot2_f32_bf16 v45, v244, v244, v45
    v_dot2_f32_bf16 v44, v245, s77, v44
    v_dot2_f32_bf16 v45, v245, v245, v45
    v_dot2_f32_bf16 v44, v246, s77, v44
    v_dot2_f32_bf16 v45, v246, v246, v45
    v_dot2_f32_bf16 v44, v247, s77, v44
    v_dot2_f32_bf16 v45, v247, v247, v45
    v_dot2_f32_bf16 v44, v248, s77, v44
    v_dot2_f32_bf16 v45, v248, v248, v45
    v_dot2_f32_bf16 v44, v249, s77, v44
    v_dot2_f32_bf16 v45, v249, v249, v45
    v_dot2_f32_bf16 v44, v250, s77, v44
    v_dot2_f32_bf16 v45, v250, v250, v45
    v_dot2_f32_bf16 v44, v251, s77, v44
    v_dot2_f32_bf16 v45, v251, v251, v45
    v_dot2_f32_bf16 v44, v252, s77, v44
    v_dot2_f32_bf16 v45, v252, v252, v45
    v_dot2_f32_bf16 v44, v253, s77, v44
    v_dot2_f32_bf16 v45, v253, v253, v45
    v_dot2_f32_bf16 v44, v254, s77, v44
    v_dot2_f32_bf16 v45, v254, v254, v45
    v_dot2_f32_bf16 v44, v255, s77, v44
    v_dot2_f32_bf16 v45, v255, v255, v45
    s_nop 1
    v_add_f32_dpp v44, v44, v44 quad_perm:[1,0,3,2] row_mask:0xf bank_mask:0xf
    v_add_f32_dpp v45, v45, v45 quad_perm:[1,0,3,2] row_mask:0xf bank_mask:0xf
    s_nop 0
    v_add_f32_dpp v44, v44, v44 quad_perm:[2,3,0,1] row_mask:0xf bank_mask:0xf
    v_add_f32_dpp v45, v45, v45 quad_perm:[2,3,0,1] row_mask:0xf bank_mask:0xf
    s_nop 0
    v_add_f32_dpp v44, v44, v44 row_half_mirror row_mask:0xf bank_mask:0xf
    v_add_f32_dpp v45, v45, v45 row_half_mirror row_mask:0xf bank_mask:0xf
    v_mul_f32 v46, s81, v44
    v_mul_f32_e64 v47, v46, v46
    v_fma_f32 v47, v45, s81, -v47
    v_max_f32 v47, 0, v47
    v_add_f32 v47, s82, v47
    v_rsq_f32 v47, v47
    s_nop 0
    v_cvt_pk_bf16_f32 v48, v47, 0
    v_lshlrev_b32_e64 v49, 16, v48
    v_mul_f32 v50, -v46, v49
    v_dot2_f32_bf16 v64, v176, v48, v50
    v_dot2_f32_bf16 v65, v176, v49, v50
    v_dot2_f32_bf16 v66, v177, v48, v50
    v_dot2_f32_bf16 v67, v177, v49, v50
    v_dot2_f32_bf16 v68, v178, v48, v50
    v_dot2_f32_bf16 v69, v178, v49, v50
    v_dot2_f32_bf16 v70, v179, v48, v50
    v_dot2_f32_bf16 v71, v179, v49, v50
    v_cvt_pk_bf16_f32 v176, v64, v65
    v_cvt_pk_bf16_f32 v177, v66, v67
    v_cvt_pk_bf16_f32 v178, v68, v69
    v_cvt_pk_bf16_f32 v179, v70, v71
    buffer_load_dwordx4 v13, s[12:15], s59 offen offset:1024 lds
    s_add_u32 m0, s56, 34816
    s_add_u32 s59, s90, s57
    s_nop 0
    s_add_u32 s59, s59, 51200
    buffer_load_dwordx4 v12, s[12:15], s59 offen lds
    ds_write_b128 v4, v[176:179] offset:36992
    v_dot2_f32_bf16 v72, v180, v48, v50
    v_dot2_f32_bf16 v73, v180, v49, v50
    v_dot2_f32_bf16 v74, v181, v48, v50
    v_dot2_f32_bf16 v75, v181, v49, v50
    v_dot2_f32_bf16 v76, v182, v48, v50
    v_dot2_f32_bf16 v77, v182, v49, v50
    v_dot2_f32_bf16 v78, v183, v48, v50
    v_dot2_f32_bf16 v79, v183, v49, v50
    v_cvt_pk_bf16_f32 v180, v72, v73
    v_cvt_pk_bf16_f32 v181, v74, v75
    v_cvt_pk_bf16_f32 v182, v76, v77
    v_cvt_pk_bf16_f32 v183, v78, v79
    ds_write_b128 v4, v[180:183] offset:39040
    v_dot2_f32_bf16 v64, v184, v48, v50
    v_dot2_f32_bf16 v65, v184, v49, v50
    v_dot2_f32_bf16 v66, v185, v48, v50
    v_dot2_f32_bf16 v67, v185, v49, v50
    v_dot2_f32_bf16 v68, v186, v48, v50
    v_dot2_f32_bf16 v69, v186, v49, v50
    v_dot2_f32_bf16 v70, v187, v48, v50
    v_dot2_f32_bf16 v71, v187, v49, v50
    v_cvt_pk_bf16_f32 v184, v64, v65
    v_cvt_pk_bf16_f32 v185, v66, v67
    v_cvt_pk_bf16_f32 v186, v68, v69
    v_cvt_pk_bf16_f32 v187, v70, v71
    buffer_load_dwordx4 v13, s[12:15], s59 offen offset:1024 lds
    ds_write_b128 v63, v[184:187] offset:4224
    v_dot2_f32_bf16 v72, v188, v48, v50
    v_dot2_f32_bf16 v73, v188, v49, v50
    v_dot2_f32_bf16 v74, v189, v48, v50
    v_dot2_f32_bf16 v75, v189, v49, v50
    v_dot2_f32_bf16 v76, v190, v48, v50
    v_dot2_f32_bf16 v77, v190, v49, v50
    v_dot2_f32_bf16 v78, v191, v48, v50
    v_dot2_f32_bf16 v79, v191, v49, v50
    v_cvt_pk_bf16_f32 v188, v72, v73
    v_cvt_pk_bf16_f32 v189, v74, v75
    v_cvt_pk_bf16_f32 v190, v76, v77
    v_cvt_pk_bf16_f32 v191, v78, v79
    ds_write_b128 v63, v[188:191] offset:6272
    v_dot2_f32_bf16 v64, v240, v48, v50
    v_dot2_f32_bf16 v65, v240, v49, v50
    v_dot2_f32_bf16 v66, v241, v48, v50
    v_dot2_f32_bf16 v67, v241, v49, v50
    v_dot2_f32_bf16 v68, v242, v48, v50
    v_dot2_f32_bf16 v69, v242, v49, v50
    v_dot2_f32_bf16 v70, v243, v48, v50
    v_dot2_f32_bf16 v71, v243, v49, v50
    v_cvt_pk_bf16_f32 v240, v64, v65
    v_cvt_pk_bf16_f32 v241, v66, v67
    v_cvt_pk_bf16_f32 v242, v68, v69
    v_cvt_pk_bf16_f32 v243, v70, v71
    ds_write_b128 v4, v[240:243] offset:4224
    v_dot2_f32_bf16 v72, v244, v48, v50
    v_dot2_f32_bf16 v73, v244, v49, v50
    v_dot2_f32_bf16 v74, v245, v48, v50
    v_dot2_f32_bf16 v75, v245, v49, v50
    v_dot2_f32_bf16 v76, v246, v48, v50
    v_dot2_f32_bf16 v77, v246, v49, v50
    v_dot2_f32_bf16 v78, v247, v48, v50
    v_dot2_f32_bf16 v79, v247, v49, v50
    v_cvt_pk_bf16_f32 v244, v72, v73
    v_cvt_pk_bf16_f32 v245, v74, v75
    v_cvt_pk_bf16_f32 v246, v76, v77
    v_cvt_pk_bf16_f32 v247, v78, v79
    ds_write_b128 v4, v[244:247] offset:6272
    v_dot2_f32_bf16 v64, v248, v48, v50
    v_dot2_f32_bf16 v65, v248, v49, v50
    v_dot2_f32_bf16 v66, v249, v48, v50
    v_dot2_f32_bf16 v67, v249, v49, v50
    v_dot2_f32_bf16 v68, v250, v48, v50
    v_dot2_f32_bf16 v69, v250, v49, v50
    v_dot2_f32_bf16 v70, v251, v48, v50
    v_dot2_f32_bf16 v71, v251, v49, v50
    v_cvt_pk_bf16_f32 v248, v64, v65
    v_cvt_pk_bf16_f32 v249, v66, v67
    v_cvt_pk_bf16_f32 v250, v68, v69
    v_cvt_pk_bf16_f32 v251, v70, v71
    v_dot2_f32_bf16 v72, v252, v48, v50
    v_dot2_f32_bf16 v73, v252, v49, v50
    v_dot2_f32_bf16 v74, v253, v48, v50
    v_dot2_f32_bf16 v75, v253, v49, v50
    v_dot2_f32_bf16 v76, v254, v48, v50
    v_dot2_f32_bf16 v77, v254, v49, v50
    v_dot2_f32_bf16 v78, v255, v48, v50
    v_dot2_f32_bf16 v79, v255, v49, v50
    v_cvt_pk_bf16_f32 v252, v72, v73
    v_cvt_pk_bf16_f32 v253, v74, v75
    v_cvt_pk_bf16_f32 v254, v76, v77
    v_cvt_pk_bf16_f32 v255, v78, v79
    s_waitcnt vmcnt(8) lgkmcnt(0)
    s_barrier
    ds_read_b128 a[0:3], v6 offset:32768
    ds_read_b64_tr_b16 v[32:33], v8 offset:0
    ds_read_b64_tr_b16 v[34:35], v8 offset:512
    ds_read_b128 a[8:11], v7 offset:33792
    ds_read_b64_tr_b16 v[36:37], v8 offset:4096
    ds_read_b64_tr_b16 v[38:39], v8 offset:4608
    ds_read_b128 a[16:19], v6 offset:34816
    ds_read_b64_tr_b16 v[40:41], v8 offset:8192
    ds_read_b64_tr_b16 v[42:43], v8 offset:8704
    ds_read_b128 a[24:27], v7 offset:35840
    ds_read_b64_tr_b16 v[44:45], v8 offset:12288
    ds_read_b64_tr_b16 v[46:47], v8 offset:12800
    ds_read_b128 a[4:7], v6 offset:36864
    ds_read_b128 a[12:15], v7 offset:37888
    ds_read_b128 a[20:23], v6 offset:38912
    ds_read_b128 a[28:31], v7 offset:39936
    ds_read_b128 a[128:131], v6 offset:40960
    ds_read_b128 a[136:139], v7 offset:41984
    ds_read_b128 a[144:147], v6 offset:43008
    ds_read_b128 a[152:155], v7 offset:44032
    ds_read_b128 a[132:135], v6 offset:45056
    ds_read_b128 a[140:143], v7 offset:46080
    ds_read_b128 a[148:151], v6 offset:47104
    ds_read_b128 a[156:159], v7 offset:48128
    s_waitcnt lgkmcnt(14)
    v_mfma_f32_16x16x32_bf16 v[64:67], v[32:35], a[0:3], 0
    s_xor_b32 s60, s65, 2
    ds_read_b64_tr_b16 v[48:49], v10 offset:0
    ds_read_b128 a[32:35], v28 offset:0
    v_mfma_f32_16x16x32_bf16 v[64:67], v[36:39], a[8:11], v[64:67]
    s_mul_i32 s88, s60, 458752
    ds_read_b64_tr_b16 v[50:51], v10 offset:512
    ds_read_b128 a[40:43], v29 offset:1024
    v_mfma_f32_16x16x32_bf16 v[64:67], v[40:43], a[16:19], v[64:67]
    s_xor_b32 s60, s65, 3
    ds_read_b64_tr_b16 v[52:53], v10 offset:4096
    ds_read_b128 a[48:51], v28 offset:2048
    s_waitcnt lgkmcnt(14)
    v_mfma_f32_16x16x32_bf16 v[64:67], v[44:47], a[24:27], v[64:67]
    s_mul_i32 s93, s60, 393216
    ds_read_b64_tr_b16 v[54:55], v10 offset:4608
    ds_read_b128 a[56:59], v29 offset:3072
    v_mfma_f32_16x16x32_bf16 v[68:71], v[32:35], a[4:7], 0
    s_mul_i32 s89, s60, 458752
    ds_read_b64_tr_b16 v[56:57], v10 offset:8192
    ds_read_b128 a[36:39], v28 offset:4096
    v_mfma_f32_16x16x32_bf16 v[68:71], v[36:39], a[12:15], v[68:71]
    s_xor_b32 s60, s65, 1
    ds_read_b64_tr_b16 v[58:59], v10 offset:8704
    ds_read_b128 a[44:47], v29 offset:5120
    v_mfma_f32_16x16x32_bf16 v[68:71], v[40:43], a[20:23], v[68:71]
    s_add_u32 m0, s56, 49152
    ds_read_b64_tr_b16 v[60:61], v10 offset:12288
    ds_read_b128 a[52:55], v28 offset:6144
    v_mfma_f32_16x16x32_bf16 v[68:71], v[44:47], a[28:31], v[68:71]
    s_add_u32 s59, s92, s57
    ds_read_b64_tr_b16 v[62:63], v10 offset:12800
    ds_read_b128 a[60:63], v29 offset:7168
    s_waitcnt lgkmcnt(14)
    v_mfma_f32_16x16x32_bf16 v[72:75], v[32:35], a[128:131], 0
    s_add_u32 s59, s59, 1024
    buffer_load_dwordx4 v12, s[12:15], s59 offen lds
    ds_read_b128 a[160:163], v28 offset:8192
    v_mfma_f32_16x16x32_bf16 v[72:75], v[36:39], a[136:139], v[72:75]
    s_mul_i32 s87, s60, 458752
    ds_read_b128 a[168:171], v29 offset:9216
    ds_read_b128 a[176:179], v28 offset:10240
    v_mfma_f32_16x16x32_bf16 v[72:75], v[40:43], a[144:147], v[72:75]
    s_mov_b32 s22, 0x1c0000
    buffer_load_dwordx4 v13, s[12:15], s59 offen offset:1024 lds
    ds_read_b128 a[184:187], v29 offset:11264
    v_mfma_f32_16x16x32_bf16 v[72:75], v[44:47], a[152:155], v[72:75]
    s_add_u32 m0, s56, 51200
    s_add_u32 s59, s92, s57
    ds_read_b128 a[164:167], v28 offset:12288
    ds_read_b128 a[172:175], v29 offset:13312
    v_mfma_f32_16x16x32_bf16 v[76:79], v[32:35], a[132:135], 0
    s_add_u32 s59, s59, 50176
    buffer_load_dwordx4 v12, s[12:15], s59 offen lds
    ds_read_b128 a[180:183], v28 offset:14336
    v_mfma_f32_16x16x32_bf16 v[76:79], v[36:39], a[140:143], v[76:79]
    s_mov_b32 s23, 0x20000
    ds_read_b128 a[188:191], v29 offset:15360
    v_lshrrev_b32_e64 v190, 4, v1
    v_mfma_f32_16x16x32_bf16 v[76:79], v[40:43], a[148:151], v[76:79]
    s_mov_b32 s30, 0x80000
    buffer_load_dwordx4 v13, s[12:15], s59 offen offset:1024 lds
    v_mfma_f32_16x16x32_bf16 v[76:79], v[44:47], a[156:159], v[76:79]
    s_waitcnt vmcnt(8) lgkmcnt(7)
    s_barrier
    v_mfma_f32_16x16x32_bf16 v[80:83], v[48:51], a[0:3], 0
    s_mov_b32 s31, 0x20000
    ds_read_b64_tr_b16 v[32:33], v8 offset:16384
    v_and_b32_e64 v189, 15, v1
    v_mfma_f32_16x16x32_bf16 v[80:83], v[52:55], a[8:11], v[80:83]
    s_add_u32 m0, s56, 0
    ds_read_b64_tr_b16 v[34:35], v8 offset:16896
    v_lshlrev_b32 v191, 24, v190
    v_mfma_f32_16x16x32_bf16 v[80:83], v[56:59], a[16:19], v[80:83]
    s_add_u32 s59, s93, s57
    ds_read_b64_tr_b16 v[36:37], v8 offset:20480
    v_lshl_add_u32 v191, v189, 7, v191
    v_mfma_f32_16x16x32_bf16 v[80:83], v[60:63], a[24:27], v[80:83]
    s_add_u32 s59, s59, 1024
    buffer_load_dwordx4 v12, s[12:15], s59 offen lds
    ds_read_b64_tr_b16 v[38:39], v8 offset:20992
    v_mfma_f32_16x16x32_bf16 v[84:87], v[48:51], a[4:7], 0
    s_mov_b32 s26, 0x1c0000
    ds_read_b64_tr_b16 v[40:41], v8 offset:24576
    v_lshrrev_b32 v5, 8, v5
    v_mfma_f32_16x16x32_bf16 v[84:87], v[52:55], a[12:15], v[84:87]
    s_mov_b32 s27, 0x20000
    ds_read_b64_tr_b16 v[42:43], v8 offset:25088
    v_lshlrev_b32_e64 v5, 24, v5
    v_mfma_f32_16x16x32_bf16 v[84:87], v[56:59], a[20:23], v[84:87]
    s_add_u32 s48, s44, 0x900000
    s_addc_u32 s49, s45, 0
    buffer_load_dwordx4 v13, s[12:15], s59 offen offset:1024 lds
    ds_read_b64_tr_b16 v[44:45], v8 offset:28672
    v_mfma_f32_16x16x32_bf16 v[84:87], v[60:63], a[28:31], v[84:87]
    s_mov_b32 s50, 0x120000
    ds_read_b64_tr_b16 v[46:47], v8 offset:29184
    v_lshl_add_u32 v5, v189, 7, v5
    v_mfma_f32_16x16x32_bf16 v[88:91], v[48:51], a[128:131], 0
    s_mov_b32 s51, 0x20000
    ds_write_b128 v4, v[200:203] offset:32768
    v_mfma_f32_16x16x32_bf16 v[88:91], v[52:55], a[136:139], v[88:91]
    s_lshl_b32 s60, s2, 2
    v_lshlrev_b32_e64 v3, 2, v189
    v_add_u32 v9, 0x10000, v8
    v_mfma_f32_16x16x32_bf16 v[88:91], v[56:59], a[144:147], v[88:91]
    s_add_u32 s60, s60, s3
    v_add_u32 v11, 0x10000, v10
    v_lshlrev_b32 v190, 1, v190
    v_mfma_f32_16x16x32_bf16 v[88:91], v[60:63], a[152:155], v[88:91]
    s_lshl_b32 s60, s60, 11
    ds_write_b128 v4, v[204:207] offset:34816
    v_mfma_f32_16x16x32_bf16 v[92:95], v[48:51], a[132:135], 0
    s_mov_b32 s42, 0x100
    v_add_u32 v191, s60, v191
    v_and_b32_e64 v189, 7, v1
    v_mfma_f32_16x16x32_bf16 v[92:95], v[52:55], a[140:143], v[92:95]
    s_and_b32 s60, s64, 1
    v_xor_b32 v190, v190, v189
    v_lshlrev_b32_e64 v190, 4, v190
    v_mfma_f32_16x16x32_bf16 v[92:95], v[56:59], a[148:151], v[92:95]
    s_lshl_b32 s60, s60, 7
    v_xor_b32 v18, s60, v2
    v_lshrrev_b32_e64 v189, 3, v1
    v_mfma_f32_16x16x32_bf16 v[92:95], v[60:63], a[156:159], v[92:95]
    s_lshl_b32 s60, s3, 15
    v_lshl_add_u32 v190, v189, 10, v190
    v_add_u32 v16, s60, v190
    s_waitcnt lgkmcnt(2)
    v_mfma_f32_16x16x32_bf16 v[64:67], v[32:35], a[32:35], v[64:67]
    s_mov_b32 s43, 0x20000
    ds_read_b64_tr_b16 v[48:49], v10 offset:16384
    v_add_u32 v19, 7168, v16
    v_mfma_f32_16x16x32_bf16 v[64:67], v[36:39], a[40:43], v[64:67]
    s_add_u32 m0, s56, 2048
    ds_read_b64_tr_b16 v[50:51], v10 offset:16896
    v_mfma_f32_16x16x32_bf16 v[64:67], v[40:43], a[48:51], v[64:67]
    s_add_u32 s59, s93, s57
    ds_read_b64_tr_b16 v[52:53], v10 offset:20480
    v_mfma_f32_16x16x32_bf16 v[64:67], v[44:47], a[56:59], v[64:67]
    s_add_u32 s59, s59, 50176
    buffer_load_dwordx4 v12, s[12:15], s59 offen lds
    ds_read_b64_tr_b16 v[54:55], v10 offset:20992
    v_mfma_f32_16x16x32_bf16 v[68:71], v[32:35], a[36:39], v[68:71]
    s_mov_b32 s46, 0x900000
    ds_read_b64_tr_b16 v[56:57], v10 offset:24576
    v_mfma_f32_16x16x32_bf16 v[68:71], v[36:39], a[44:47], v[68:71]
    s_mov_b32 s47, 0x20000
    ds_read_b64_tr_b16 v[58:59], v10 offset:25088
    v_mfma_f32_16x16x32_bf16 v[68:71], v[40:43], a[52:55], v[68:71]
    s_mov_b32 s38, 0x200000
    buffer_load_dwordx4 v13, s[12:15], s59 offen offset:1024 lds
    ds_read_b64_tr_b16 v[60:61], v10 offset:28672
    v_mfma_f32_16x16x32_bf16 v[68:71], v[44:47], a[60:63], v[68:71]
    s_mov_b32 s39, 0x20000
    ds_read_b64_tr_b16 v[62:63], v10 offset:29184
    v_mfma_f32_16x16x32_bf16 v[72:75], v[32:35], a[160:163], v[72:75]
    s_and_b32 s7, s2, 7
    ds_write_b128 v4, v[216:219] offset:32896
    v_mfma_f32_16x16x32_bf16 v[72:75], v[36:39], a[168:171], v[72:75]
    s_lshr_b32 s58, s5, 1
    v_mfma_f32_16x16x32_bf16 v[72:75], v[40:43], a[176:179], v[72:75]
    s_lshl_b32 s58, s58, 7
    v_mfma_f32_16x16x32_bf16 v[72:75], v[44:47], a[184:187], v[72:75]
    s_and_b32 s65, s3, 1
    ds_write_b128 v4, v[220:223] offset:34944
    v_mfma_f32_16x16x32_bf16 v[76:79], v[32:35], a[164:167], v[76:79]
    s_lshl_b32 s66, s65, 12
    v_mfma_f32_16x16x32_bf16 v[76:79], v[36:39], a[172:175], v[76:79]
    s_lshr_b32 s60, s3, 1
    v_mfma_f32_16x16x32_bf16 v[76:79], v[40:43], a[180:183], v[76:79]
    s_lshl_b32 s61, s4, 1
    buffer_load_dword v17, v191, s[28:31], 0 offen
    v_mfma_f32_16x16x32_bf16 v[76:79], v[44:47], a[188:191], v[76:79]
    s_waitcnt vmcnt(9) lgkmcnt(2)
    s_barrier
    v_mfma_f32_16x16x32_bf16 v[80:83], v[48:51], a[32:35], v[80:83]
    s_add_u32 s60, s60, s61
    ds_read_b64_tr_b16 v[32:33], v8 offset:32768
    v_mfma_f32_16x16x32_bf16 v[80:83], v[52:55], a[40:43], v[80:83]
    s_add_u32 m0, s56, 16384
    ds_read_b64_tr_b16 v[34:35], v8 offset:33280
    v_mfma_f32_16x16x32_bf16 v[80:83], v[56:59], a[48:51], v[80:83]
    s_add_u32 s59, s91, s57
    ds_read_b64_tr_b16 v[36:37], v8 offset:36864
    v_mfma_f32_16x16x32_bf16 v[80:83], v[60:63], a[56:59], v[80:83]
    s_add_u32 s59, s59, 2048
    buffer_load_dwordx4 v12, s[12:15], s59 offen lds
    ds_read_b64_tr_b16 v[38:39], v8 offset:37376
    v_mfma_f32_16x16x32_bf16 v[84:87], v[48:51], a[36:39], v[84:87]
    s_mul_i32 s60, s60, 294912
    ds_read_b64_tr_b16 v[40:41], v8 offset:40960
    v_mfma_f32_16x16x32_bf16 v[84:87], v[52:55], a[44:47], v[84:87]
    s_add_u32 s60, s60, s66
    ds_read_b64_tr_b16 v[42:43], v8 offset:41472
    v_mfma_f32_16x16x32_bf16 v[84:87], v[56:59], a[52:55], v[84:87]
    s_and_b32 s61, s5, 1
    buffer_load_dwordx4 v13, s[12:15], s59 offen offset:1024 lds
    ds_read_b64_tr_b16 v[44:45], v8 offset:45056
    v_mfma_f32_16x16x32_bf16 v[84:87], v[60:63], a[60:63], v[84:87]
    s_lshl_b32 s61, s61, 11
    ds_read_b64_tr_b16 v[46:47], v8 offset:45568
    v_mfma_f32_16x16x32_bf16 v[88:91], v[48:51], a[160:163], v[88:91]
    s_add_u32 s70, s60, s61
    ds_write_b128 v4, v[232:235] offset:36864
    v_mfma_f32_16x16x32_bf16 v[88:91], v[52:55], a[168:171], v[88:91]
    s_xor_b32 s71, s70, 1024
    v_mfma_f32_16x16x32_bf16 v[88:91], v[56:59], a[176:179], v[88:91]
    s_xor_b32 s72, s70, 2048
    v_mfma_f32_16x16x32_bf16 v[88:91], v[60:63], a[184:187], v[88:91]
    s_xor_b32 s73, s70, 3072
    ds_write_b128 v4, v[236:239] offset:38912
    v_mfma_f32_16x16x32_bf16 v[92:95], v[48:51], a[164:167], v[92:95]
    s_lshl_b32 s69, s5, 2
    v_mfma_f32_16x16x32_bf16 v[92:95], v[52:55], a[172:175], v[92:95]
    s_lshl_b32 s65, s65, 1
    v_mfma_f32_16x16x32_bf16 v[92:95], v[56:59], a[180:183], v[92:95]
    s_add_u32 s69, s69, s65
    buffer_load_dword v17, v191, s[24:27], 0 offen
    v_mfma_f32_16x16x32_bf16 v[92:95], v[60:63], a[188:191], v[92:95]
    s_lshr_b32 s65, s3, 1
    s_waitcnt lgkmcnt(2)
    v_mfma_f32_16x16x32_bf16 v[96:99], a[0:3], v[32:35], 0
    s_add_u32 s69, s69, s65
    ds_read_b64_tr_b16 v[48:49], v10 offset:32768
    ds_read_b128 a[64:67], v6 offset:0
    v_mfma_f32_16x16x32_bf16 v[96:99], a[8:11], v[36:39], v[96:99]
    s_add_u32 m0, s56, 18432
    ds_read_b64_tr_b16 v[50:51], v10 offset:33280
    ds_read_b128 a[72:75], v7 offset:1024
    v_mfma_f32_16x16x32_bf16 v[96:99], a[16:19], v[40:43], v[96:99]
    s_add_u32 s59, s91, s57
    ds_read_b64_tr_b16 v[52:53], v10 offset:36864
    ds_read_b128 a[80:83], v6 offset:2048
    v_mfma_f32_16x16x32_bf16 v[96:99], a[24:27], v[44:47], v[96:99]
    s_add_u32 s59, s59, 51200
    buffer_load_dwordx4 v12, s[12:15], s59 offen lds
    ds_read_b64_tr_b16 v[54:55], v10 offset:37376
    v_mfma_f32_16x16x32_bf16 v[100:103], a[4:7], v[32:35], 0
    s_lshl_b32 s60, s5, 2
    ds_read_b64_tr_b16 v[56:57], v10 offset:40960
    ds_read_b128 a[88:91], v7 offset:3072
    v_mfma_f32_16x16x32_bf16 v[100:103], a[12:15], v[36:39], v[100:103]
    s_lshl_b32 s84, s4, 11
    ds_read_b64_tr_b16 v[58:59], v10 offset:41472
    ds_read_b128 a[68:71], v6 offset:4096
    v_mfma_f32_16x16x32_bf16 v[100:103], a[20:23], v[40:43], v[100:103]
    s_add_u32 s84, s84, s60
    buffer_load_dwordx4 v13, s[12:15], s59 offen offset:1024 lds
    ds_read_b64_tr_b16 v[60:61], v10 offset:45056
    v_mfma_f32_16x16x32_bf16 v[100:103], a[28:31], v[44:47], v[100:103]
    s_and_b32 s60, s6, 3
    ds_read_b64_tr_b16 v[62:63], v10 offset:45568
    ds_read_b128 a[76:79], v7 offset:5120
    v_mfma_f32_16x16x32_bf16 v[104:107], a[128:131], v[32:35], 0
    s_bfe_u32 s61, s6, 0x20002
    ds_write_b128 v4, v[248:251] offset:36992
    v_mfma_f32_16x16x32_bf16 v[104:107], a[136:139], v[36:39], v[104:107]
    s_lshl_b32 s61, s61, 1
    v_mfma_f32_16x16x32_bf16 v[104:107], a[144:147], v[40:43], v[104:107]
    s_and_b32 s65, s6, 1
    v_mfma_f32_16x16x32_bf16 v[104:107], a[152:155], v[44:47], v[104:107]
    s_add_u32 s61, s61, s65
    ds_write_b128 v4, v[252:255] offset:39040
    v_mfma_f32_16x16x32_bf16 v[108:111], a[132:135], v[32:35], 0
    s_lshl_b32 s62, s61, 7
    v_mfma_f32_16x16x32_bf16 v[108:111], a[140:143], v[36:39], v[108:111]
    s_lshl_b32 s63, s60, 2
    v_mfma_f32_16x16x32_bf16 v[108:111], a[148:151], v[40:43], v[108:111]
    s_lshl_b32 s65, s7, 4
    ds_read_b128 a[84:87], v6 offset:6144
    ds_read_b128 a[92:95], v7 offset:7168
    v_mfma_f32_16x16x32_bf16 v[108:111], a[156:159], v[44:47], v[108:111]
    s_waitcnt vmcnt(10) lgkmcnt(2)
    s_barrier
    v_mfma_f32_16x16x32_bf16 v[112:115], a[0:3], v[48:51], 0
    s_add_u32 s63, s63, s65
    ds_read_b64_tr_b16 v[32:33], v8 offset:49152
    v_lshrrev_b32 v28, 2, v1
    v_mfma_f32_16x16x32_bf16 v[112:115], a[8:11], v[52:55], v[112:115]
    s_mul_i32 s60, s60, 3
    ds_read_b64_tr_b16 v[34:35], v8 offset:49664
    v_lshlrev_b32 v28, 31, v28
    v_mfma_f32_16x16x32_bf16 v[112:115], a[16:19], v[56:59], v[112:115]
    s_add_u32 s0, s60, s61
    ds_read_b64_tr_b16 v[36:37], v8 offset:53248
    v_lshrrev_b32 v29, 16, v28
    v_mfma_f32_16x16x32_bf16 v[112:115], a[24:27], v[60:63], v[112:115]
    s_lshl_b32 s0, s0, 17
    ds_read_b64_tr_b16 v[38:39], v8 offset:53760
    v_or_b32 v28, v28, v29
    v_mfma_f32_16x16x32_bf16 v[116:119], a[4:7], v[48:51], 0
    s_add_u32 s0, s0, s62
    ds_read_b64_tr_b16 v[40:41], v8 offset:57344
    v_xor_b32 v20, v20, v28
    v_mfma_f32_16x16x32_bf16 v[116:119], a[12:15], v[52:55], v[116:119]
    s_and_b32 s6, s0, 0x7ffff
    ds_read_b64_tr_b16 v[42:43], v8 offset:57856
    v_xor_b32_e64 v21, v21, v28
    v_mfma_f32_16x16x32_bf16 v[116:119], a[20:23], v[56:59], v[116:119]
    s_and_b32 s7, s0, 0x3ffff
    ds_read_b64_tr_b16 v[44:45], v8 offset:61440
    v_xor_b32_e64 v22, v22, v28
    v_mfma_f32_16x16x32_bf16 v[116:119], a[28:31], v[60:63], v[116:119]
    s_and_b32 s0, s0, 0x7ffff
    ds_read_b64_tr_b16 v[46:47], v8 offset:61952
    v_xor_b32_e64 v23, v23, v28
    v_mfma_f32_16x16x32_bf16 v[120:123], a[128:131], v[48:51], 0
    s_add_u32 m0, s56, 32768
    ds_read_b128 a[192:195], v6 offset:8192
    v_xor_b32_e64 v24, v24, v28
    v_mfma_f32_16x16x32_bf16 v[120:123], a[136:139], v[52:55], v[120:123]
    s_add_u32 s59, s92, s57
    ds_read_b128 a[200:203], v7 offset:9216
    v_xor_b32 v25, v25, v28
    v_mfma_f32_16x16x32_bf16 v[120:123], a[144:147], v[56:59], v[120:123]
    s_add_u32 s59, s59, 2048
    buffer_load_dwordx4 v12, s[12:15], s59 offen lds
    v_mfma_f32_16x16x32_bf16 v[120:123], a[152:155], v[60:63], v[120:123]
    s_mov_b32 s74, 0x3fb8aa3b
    ds_read_b128 a[208:211], v6 offset:10240
    v_xor_b32_e64 v26, v26, v28
    v_mfma_f32_16x16x32_bf16 v[124:127], a[132:135], v[48:51], 0
    s_mov_b32 s76, 0xbfb8aa3b
    buffer_load_dwordx4 v13, s[12:15], s59 offen offset:1024 lds
    v_mfma_f32_16x16x32_bf16 v[124:127], a[140:143], v[52:55], v[124:127]
    s_mov_b32 s78, 0x00ff00ff
    ds_read_b128 a[216:219], v7 offset:11264
    v_xor_b32_e64 v27, v27, v28
    v_mfma_f32_16x16x32_bf16 v[124:127], a[148:151], v[56:59], v[124:127]
    s_mov_b32 s79, 0x00ff00ff
    ds_read_b128 a[196:199], v6 offset:12288
    v_cndmask_b32 v192, 0, v20, s[78:79]
    v_mfma_f32_16x16x32_bf16 v[124:127], a[156:159], v[60:63], v[124:127]
    s_waitcnt lgkmcnt(4)
    ds_read_b128 a[204:207], v7 offset:13312
    v_cndmask_b32 v194, v20, 0, s[78:79]
    v_mfma_f32_16x16x32_bf16 v[64:67], v[32:35], a[64:67], v[64:67]
    ds_read_b64_tr_b16 v[48:49], v10 offset:49152
    v_cndmask_b32 v193, 0, v21, s[78:79]
    v_mfma_f32_16x16x32_bf16 v[64:67], v[36:39], a[72:75], v[64:67]
    ds_read_b64_tr_b16 v[50:51], v10 offset:49664
    v_cndmask_b32 v195, v21, 0, s[78:79]
    v_mfma_f32_16x16x32_bf16 v[64:67], v[40:43], a[80:83], v[64:67]
    ds_read_b64_tr_b16 v[52:53], v10 offset:53248
    v_cndmask_b32 v196, 0, v22, s[78:79]
    v_mfma_f32_16x16x32_bf16 v[64:67], v[44:47], a[88:91], v[64:67]
    ds_read_b64_tr_b16 v[54:55], v10 offset:53760
    v_cndmask_b32 v198, v22, 0, s[78:79]
    v_mfma_f32_16x16x32_bf16 v[68:71], v[32:35], a[68:71], v[68:71]
    ds_read_b64_tr_b16 v[56:57], v10 offset:57344
    v_cndmask_b32 v197, 0, v23, s[78:79]
    v_mfma_f32_16x16x32_bf16 v[68:71], v[36:39], a[76:79], v[68:71]
    ds_read_b64_tr_b16 v[58:59], v10 offset:57856
    v_cndmask_b32 v199, v23, 0, s[78:79]
    v_mfma_f32_16x16x32_bf16 v[68:71], v[40:43], a[84:87], v[68:71]
    ds_read_b64_tr_b16 v[60:61], v10 offset:61440
    v_cndmask_b32 v200, 0, v24, s[78:79]
    v_mfma_f32_16x16x32_bf16 v[68:71], v[44:47], a[92:95], v[68:71]
    ds_read_b64_tr_b16 v[62:63], v10 offset:61952
    v_cndmask_b32 v202, v24, 0, s[78:79]
    v_mfma_f32_16x16x32_bf16 v[72:75], v[32:35], a[192:195], v[72:75]
    s_add_u32 m0, s56, 34816
    ds_read_b128 a[212:215], v6 offset:14336
    v_cndmask_b32 v201, 0, v25, s[78:79]
    s_waitcnt lgkmcnt(7)
    v_mfma_f32_16x16x32_bf16 v[72:75], v[36:39], a[200:203], v[72:75]
    s_add_u32 s59, s92, s57
    ds_read_b128 a[220:223], v7 offset:15360
    v_cndmask_b32 v203, v25, 0, s[78:79]
    v_mfma_f32_16x16x32_bf16 v[72:75], v[40:43], a[208:211], v[72:75]
    s_add_u32 s59, s59, 51200
    buffer_load_dwordx4 v12, s[12:15], s59 offen lds
    v_mfma_f32_16x16x32_bf16 v[72:75], v[44:47], a[216:219], v[72:75]
    ds_read_b128 a[96:99], v6 offset:32768
    v_cndmask_b32 v204, 0, v26, s[78:79]
    v_mfma_f32_16x16x32_bf16 v[76:79], v[32:35], a[196:199], v[76:79]
    buffer_load_dwordx4 v13, s[12:15], s59 offen offset:1024 lds
    v_mfma_f32_16x16x32_bf16 v[76:79], v[36:39], a[204:207], v[76:79]
    s_waitcnt lgkmcnt(2)
    ds_read_b128 a[104:107], v7 offset:33792
    v_cndmask_b32 v206, v26, 0, s[78:79]
    v_mfma_f32_16x16x32_bf16 v[76:79], v[40:43], a[212:215], v[76:79]
    s_waitcnt lgkmcnt(2)
    ds_read_b128 a[112:115], v6 offset:34816
    v_cndmask_b32 v205, 0, v27, s[78:79]
    v_mfma_f32_16x16x32_bf16 v[76:79], v[44:47], a[220:223], v[76:79]
    s_waitcnt vmcnt(10)
    s_barrier
    v_mfma_f32_16x16x32_bf16 v[80:83], v[48:51], a[64:67], v[80:83]
    ds_read_b64_tr_b16 v[32:33], v8 offset:0
    ds_read_b128 a[120:123], v7 offset:35840
    v_mfma_f32_16x16x32_bf16 v[80:83], v[52:55], a[72:75], v[80:83]
    ds_read_b64_tr_b16 v[34:35], v8 offset:512
    ds_read_b128 a[100:103], v6 offset:36864
    v_mfma_f32_16x16x32_bf16 v[80:83], v[56:59], a[80:83], v[80:83]
    ds_read_b64_tr_b16 v[36:37], v8 offset:4096
    ds_read_b128 a[108:111], v7 offset:37888
    v_mfma_f32_16x16x32_bf16 v[80:83], v[60:63], a[88:91], v[80:83]
    ds_read_b64_tr_b16 v[38:39], v8 offset:4608
    ds_read_b128 a[116:119], v6 offset:38912
    v_mfma_f32_16x16x32_bf16 v[84:87], v[48:51], a[68:71], v[84:87]
    ds_read_b64_tr_b16 v[40:41], v8 offset:8192
    ds_read_b128 a[124:127], v7 offset:39936
    v_mfma_f32_16x16x32_bf16 v[84:87], v[52:55], a[76:79], v[84:87]
    ds_read_b64_tr_b16 v[42:43], v8 offset:8704
    ds_read_b128 a[224:227], v6 offset:40960
    v_mfma_f32_16x16x32_bf16 v[84:87], v[56:59], a[84:87], v[84:87]
    s_add_u32 m0, s56, 49152
    ds_read_b64_tr_b16 v[44:45], v8 offset:12288
    ds_read_b128 a[232:235], v7 offset:41984
    v_mfma_f32_16x16x32_bf16 v[84:87], v[60:63], a[92:95], v[84:87]
    s_add_u32 s59, s93, s57
    ds_read_b64_tr_b16 v[46:47], v8 offset:12800
    ds_read_b128 a[240:243], v6 offset:43008
    v_mfma_f32_16x16x32_bf16 v[88:91], v[48:51], a[192:195], v[88:91]
    s_add_u32 s59, s59, 2048
    buffer_load_dwordx4 v12, s[12:15], s59 offen lds
    ds_read_b128 a[248:251], v7 offset:44032
    v_mfma_f32_16x16x32_bf16 v[88:91], v[52:55], a[200:203], v[88:91]
    ds_read_b128 a[228:231], v6 offset:45056
    ds_read_b128 a[236:239], v7 offset:46080
    v_mfma_f32_16x16x32_bf16 v[88:91], v[56:59], a[208:211], v[88:91]
    buffer_load_dwordx4 v13, s[12:15], s59 offen offset:1024 lds
    ds_read_b128 a[244:247], v6 offset:47104
    v_mfma_f32_16x16x32_bf16 v[88:91], v[60:63], a[216:219], v[88:91]
    s_add_u32 m0, s56, 51200
    s_add_u32 s59, s93, s57
    ds_read_b128 a[252:255], v7 offset:48128
    v_mfma_f32_16x16x32_bf16 v[92:95], v[48:51], a[196:199], v[92:95]
    s_add_u32 s59, s59, 51200
    buffer_load_dwordx4 v12, s[12:15], s59 offen lds
    v_mfma_f32_16x16x32_bf16 v[92:95], v[52:55], a[204:207], v[92:95]
    v_cndmask_b32 v207, v27, 0, s[78:79]
    v_mfma_f32_16x16x32_bf16 v[92:95], v[56:59], a[212:215], v[92:95]
    buffer_load_dwordx4 v13, s[12:15], s59 offen offset:1024 lds
    v_mfma_f32_16x16x32_bf16 v[92:95], v[60:63], a[220:223], v[92:95]
    s_waitcnt lgkmcnt(5)
    v_mfma_f32_16x16x32_bf16 v[64:67], v[32:35], a[96:99], v[64:67]
    s_and_b32 s60, s3, 1
    ds_read_b64_tr_b16 v[48:49], v10 offset:0
    v_and_b32 v30, 15, v1
    v_mfma_f32_16x16x32_bf16 v[64:67], v[36:39], a[104:107], v[64:67]
    s_lshl_b32 s60, s60, 12
    ds_read_b64_tr_b16 v[50:51], v10 offset:512
    v_lshrrev_b32 v31, 4, v1
    v_mfma_f32_16x16x32_bf16 v[64:67], v[40:43], a[112:115], v[64:67]
    s_add_u32 s60, s60, 98304
    ds_read_b64_tr_b16 v[52:53], v10 offset:4096
    v_lshlrev_b32_e64 v31, 1, v31
    v_mfma_f32_16x16x32_bf16 v[64:67], v[44:47], a[120:123], v[64:67]
    s_lshr_b32 s61, s3, 1
    ds_read_b64_tr_b16 v[54:55], v10 offset:4608
    v_and_b32 v29, 7, v1
    v_mfma_f32_16x16x32_bf16 v[68:71], v[32:35], a[100:103], v[68:71]
    s_lshl_b32 s61, s61, 6
    ds_read_b64_tr_b16 v[56:57], v10 offset:8192
    v_xor_b32 v31, v31, v29
    v_mfma_f32_16x16x32_bf16 v[68:71], v[36:39], a[108:111], v[68:71]
    s_lshl_b32 s80, s69, 4
    ds_read_b64_tr_b16 v[58:59], v10 offset:8704
    v_lshlrev_b32 v31, 4, v31
    v_mfma_f32_16x16x32_bf16 v[68:71], v[40:43], a[116:119], v[68:71]
    s_add_u32 m0, s56, 65536
    ds_read_b64_tr_b16 v[60:61], v10 offset:12288
    v_lshl_add_u32 v30, v30, 7, v31
    v_mfma_f32_16x16x32_bf16 v[68:71], v[44:47], a[124:127], v[68:71]
    s_add_u32 s59, s86, s57
    ds_read_b64_tr_b16 v[62:63], v10 offset:12800
    v_add_u32 v30, s56, v30
    v_mfma_f32_16x16x32_bf16 v[72:75], v[32:35], a[224:227], v[72:75]
    s_add_u32 s59, s59, 1024
    buffer_load_dwordx4 v14, s[16:19], s59 offen lds
    v_mfma_f32_16x16x32_bf16 v[72:75], v[36:39], a[232:235], v[72:75]
    s_add_u32 s80, s80, s4
    v_add_u32 v30, 98304, v30
    v_xor_b32 v31, 16, v30
    v_mfma_f32_16x16x32_bf16 v[72:75], v[40:43], a[240:243], v[72:75]
    s_lshl_b32 s81, s80, 7
    buffer_load_dwordx4 v15, s[16:19], s59 offen offset:1024 lds
    s_waitcnt lgkmcnt(4)
    v_mfma_f32_16x16x32_bf16 v[72:75], v[44:47], a[248:251], v[72:75]
    s_add_u32 m0, s56, 67584
    s_add_u32 s59, s86, s57
    v_lshrrev_b32 v218, 2, v1
    v_mfma_f32_16x16x32_bf16 v[76:79], v[32:35], a[228:231], v[76:79]
    s_add_u32 s59, s59, 58368
    buffer_load_dwordx4 v14, s[16:19], s59 offen lds
    v_mfma_f32_16x16x32_bf16 v[76:79], v[36:39], a[236:239], v[76:79]
    s_add_u32 s81, s81, 32768
    v_and_b32_e64 v219, 7, v218
    v_bfe_u32 v220, v1, 1, 1
    v_mfma_f32_16x16x32_bf16 v[76:79], v[40:43], a[244:247], v[76:79]
    s_lshl_b32 s80, s80, 10
    buffer_load_dwordx4 v15, s[16:19], s59 offen offset:1024 lds
    v_mfma_f32_16x16x32_bf16 v[76:79], v[44:47], a[252:255], v[76:79]
    s_waitcnt vmcnt(12) lgkmcnt(0)
    s_barrier
    v_mfma_f32_16x16x32_bf16 v[80:83], v[48:51], a[96:99], v[80:83]
    s_add_u32 s80, s80, 131072
    ds_read_b64_tr_b16 v[32:33], v8 offset:16384
    v_xor_b32 v219, v219, v220
    v_mfma_f32_16x16x32_bf16 v[80:83], v[52:55], a[104:107], v[80:83]
    s_lshl_b32 s82, s5, 11
    ds_read_b64_tr_b16 v[34:35], v8 offset:16896
    v_lshlrev_b32 v219, 4, v219
    v_mfma_f32_16x16x32_bf16 v[80:83], v[56:59], a[112:115], v[80:83]
    s_lshl_b32 s83, s4, 2
    ds_read_b64_tr_b16 v[36:37], v8 offset:20480
    v_lshl_add_u32 v218, v218, 7, v219
    v_mfma_f32_16x16x32_bf16 v[80:83], v[60:63], a[120:123], v[80:83]
    s_add_u32 s82, s82, s83
    ds_read_b64_tr_b16 v[38:39], v8 offset:20992
    v_and_b32_e64 v220, 1, v1
    v_mfma_f32_16x16x32_bf16 v[84:87], v[48:51], a[100:103], v[84:87]
    s_add_u32 s82, s82, 64
    ds_read_b64_tr_b16 v[40:41], v8 offset:24576
    v_lshl_add_u32 v218, v220, 3, v218
    v_mfma_f32_16x16x32_bf16 v[84:87], v[52:55], a[108:111], v[84:87]
    s_mov_b32 s78, 0xffff0000
    ds_read_b64_tr_b16 v[42:43], v8 offset:25088
    v_xor_b32 v218, s61, v218
    v_mfma_f32_16x16x32_bf16 v[84:87], v[56:59], a[116:119], v[84:87]
    s_add_u32 m0, s56, 81920
    ds_read_b64_tr_b16 v[44:45], v8 offset:28672
    v_add_u32_e64 v218, s60, v218
    v_mfma_f32_16x16x32_bf16 v[84:87], v[60:63], a[124:127], v[84:87]
    s_add_u32 s59, s86, s57
    ds_read_b64_tr_b16 v[46:47], v8 offset:29184
    v_xor_b32 v219, 32, v218
    v_mfma_f32_16x16x32_bf16 v[88:91], v[48:51], a[224:227], v[88:91]
    s_add_u32 s59, s59, 1024
    buffer_load_dwordx4 v14, s[20:23], s59 offen lds
    v_mfma_f32_16x16x32_bf16 v[88:91], v[52:55], a[232:235], v[88:91]
    s_lshl_b32 s61, s61, 5
    v_lshrrev_b32 v222, 5, v1
    v_lshlrev_b32_e64 v222, 24, v222
    v_mfma_f32_16x16x32_bf16 v[88:91], v[56:59], a[240:243], v[88:91]
    s_add_u32 s60, s60, s61
    buffer_load_dwordx4 v15, s[20:23], s59 offen offset:1024 lds
    v_mfma_f32_16x16x32_bf16 v[88:91], v[60:63], a[248:251], v[88:91]
    s_add_u32 m0, s56, 83968
    s_add_u32 s59, s86, s57
    v_lshl_add_u32 v222, v1, 2, v222
    v_mfma_f32_16x16x32_bf16 v[92:95], v[48:51], a[228:231], v[92:95]
    s_add_u32 s59, s59, 58368
    buffer_load_dwordx4 v14, s[20:23], s59 offen lds
    v_mfma_f32_16x16x32_bf16 v[92:95], v[52:55], a[236:239], v[92:95]
    s_add_u32 s60, s60, 32768
    v_add_u32 v220, s60, v2
    v_mov_b32 v20, s77
    v_mfma_f32_16x16x32_bf16 v[92:95], v[56:59], a[244:247], v[92:95]
    s_mov_b32 s79, 0xffff0000
    buffer_load_dwordx4 v15, s[20:23], s59 offen offset:1024 lds
    v_mfma_f32_16x16x32_bf16 v[92:95], v[60:63], a[252:255], v[92:95]
    s_waitcnt lgkmcnt(0)
    v_mov_b32 v21, s77
    v_mov_b32_e64 v22, s77
    v_mfma_f32_16x16x32_bf16 v[96:99], a[32:35], v[32:35], v[96:99]
    s_add_u32 m0, s56, 0
    ds_read_b64_tr_b16 v[48:49], v10 offset:16384
    v_mov_b32 v23, s77
    v_mfma_f32_16x16x32_bf16 v[96:99], a[40:43], v[36:39], v[96:99]
    s_add_u32 s59, s87, s57
    ds_read_b64_tr_b16 v[50:51], v10 offset:16896
    v_mfma_f32_16x16x32_bf16 v[96:99], a[48:51], v[40:43], v[96:99]
    s_add_u32 s59, s59, 1024
    buffer_load_dwordx4 v14, s[16:19], s59 offen lds
    ds_read_b64_tr_b16 v[52:53], v10 offset:20480
    v_mfma_f32_16x16x32_bf16 v[96:99], a[56:59], v[44:47], v[96:99]
    buffer_load_dwordx4 v15, s[16:19], s59 offen offset:1024 lds
    ds_read_b64_tr_b16 v[54:55], v10 offset:20992
    v_mfma_f32_16x16x32_bf16 v[100:103], a[36:39], v[32:35], v[100:103]
    ds_read_b64_tr_b16 v[56:57], v10 offset:24576
    v_cvt_pk_bf16_f32 v64, v64, v65
    v_cvt_pk_bf16_f32 v65, v66, v67
    v_mfma_f32_16x16x32_bf16 v[100:103], a[44:47], v[36:39], v[100:103]
    s_add_u32 m0, s56, 147456
    ds_read_b64_tr_b16 v[58:59], v10 offset:25088
    v_cvt_pk_bf16_f32 v66, v80, v81
    v_cvt_pk_bf16_f32 v67, v82, v83
    s_nop 1
    v_mfma_f32_16x16x32_bf16 v[224:227], v[192:195], v[64:67], 0
    v_cvt_pk_bf16_f32 v68, v68, v69
    v_cvt_pk_bf16_f32 v69, v70, v71
    v_cvt_pk_bf16_f32 v70, v84, v85
    v_mfma_f32_16x16x32_bf16 v[228:231], v[196:199], v[64:67], 0
    v_cvt_pk_bf16_f32 v71, v86, v87
    v_cvt_pk_bf16_f32 v72, v72, v73
    v_cvt_pk_bf16_f32 v73, v74, v75
    v_mfma_f32_16x16x32_bf16 v[232:235], v[200:203], v[64:67], 0
    v_cvt_pk_bf16_f32 v74, v88, v89
    v_cvt_pk_bf16_f32 v75, v90, v91
    v_mfma_f32_16x16x32_bf16 v[236:239], v[204:207], v[64:67], 0
    v_max3_f32 v208, v224, v225, v226
    v_mfma_f32_16x16x32_bf16 v[240:243], v[192:195], v[68:71], 0
    v_max3_f32 v209, v227, v228, v229
    v_mfma_f32_16x16x32_bf16 v[244:247], v[196:199], v[68:71], 0
    s_nop 0
    v_max3_f32 v210, v230, v231, v232
    v_max3_f32 v211, v233, v234, v235
    v_max3_f32 v208, v208, v209, v210
    v_mfma_f32_16x16x32_bf16 v[248:251], v[200:203], v[68:71], 0
    v_max3_f32 v212, v236, v237, v238
    v_max3_f32 v211, v211, v212, v239
    v_max_f32 v208, v208, v211
    v_mfma_f32_16x16x32_bf16 v[252:255], v[204:207], v[68:71], 0
    v_mul_f32_e64 v208, s76, v208
    v_fma_f32 v224, v224, s74, v208
    v_fma_f32 v225, v225, s74, v208
    v_mfma_f32_16x16x32_bf16 v[100:103], a[52:55], v[40:43], v[100:103]
    s_xor_b32 s59, s6, 393216
    buffer_load_dwordx4 v16, s[28:31], s59 offen lds
    ds_read_b64_tr_b16 v[60:61], v10 offset:28672
    v_mfma_f32_16x16x32_bf16 v[100:103], a[60:63], v[44:47], v[100:103]
    buffer_load_dwordx4 v19, s[28:31], s59 offen offset:1024 lds
    ds_read_b64_tr_b16 v[62:63], v10 offset:29184
    v_mfma_f32_16x16x32_bf16 v[104:107], a[160:163], v[32:35], v[104:107]
    v_exp_f32_e64 v224, v224
    v_fma_f32 v226, v226, s74, v208
    v_mfma_f32_16x16x32_bf16 v[104:107], a[168:171], v[36:39], v[104:107]
    v_exp_f32_e64 v225, v225
    v_fma_f32 v227, v227, s74, v208
    v_mfma_f32_16x16x32_bf16 v[104:107], a[176:179], v[40:43], v[104:107]
    v_exp_f32 v226, v226
    v_add_f32 v209, v224, v225
    v_mfma_f32_16x16x32_bf16 v[104:107], a[184:187], v[44:47], v[104:107]
    v_exp_f32 v227, v227
    v_add_f32 v209, v209, v226
    v_mfma_f32_16x16x32_bf16 v[108:111], a[164:167], v[32:35], v[108:111]
    v_add_f32_e64 v209, v209, v227
    v_fma_f32 v228, v228, s74, v208
    v_fma_f32 v229, v229, s74, v208
    v_mfma_f32_16x16x32_bf16 v[108:111], a[172:175], v[36:39], v[108:111]
    v_exp_f32_e64 v228, v228
    v_fma_f32 v230, v230, s74, v208
    v_mfma_f32_16x16x32_bf16 v[108:111], a[180:183], v[40:43], v[108:111]
    v_exp_f32 v229, v229
    v_add_f32 v209, v209, v228
    v_mfma_f32_16x16x32_bf16 v[108:111], a[188:191], v[44:47], v[108:111]
    s_waitcnt vmcnt(16) lgkmcnt(0)
    s_barrier
    v_mfma_f32_16x16x32_bf16 v[112:115], a[32:35], v[48:51], v[112:115]
    s_add_u32 m0, s56, 2048
    ds_read_b64_tr_b16 v[32:33], v8 offset:32768
    v_exp_f32_e64 v230, v230
    v_mfma_f32_16x16x32_bf16 v[112:115], a[40:43], v[52:55], v[112:115]
    s_add_u32 s59, s87, s57
    ds_read_b64_tr_b16 v[34:35], v8 offset:33280
    v_add_f32 v209, v209, v229
    v_add_f32_e64 v209, v209, v230
    v_mfma_f32_16x16x32_bf16 v[112:115], a[48:51], v[56:59], v[112:115]
    s_add_u32 s59, s59, 58368
    buffer_load_dwordx4 v14, s[16:19], s59 offen lds
    ds_read_b64_tr_b16 v[36:37], v8 offset:36864
    v_mfma_f32_16x16x32_bf16 v[112:115], a[56:59], v[60:63], v[112:115]
    buffer_load_dwordx4 v15, s[16:19], s59 offen offset:1024 lds
    ds_read_b64_tr_b16 v[38:39], v8 offset:37376
    v_mfma_f32_16x16x32_bf16 v[116:119], a[36:39], v[48:51], v[116:119]
    s_add_u32 m0, s56, 16384
    ds_read_b64_tr_b16 v[40:41], v8 offset:40960
    v_fma_f32 v231, v231, s74, v208
    v_fma_f32 v232, v232, s74, v208
    v_mfma_f32_16x16x32_bf16 v[116:119], a[44:47], v[52:55], v[116:119]
    s_add_u32 s59, s87, s57
    ds_read_b64_tr_b16 v[42:43], v8 offset:41472
    v_exp_f32 v231, v231
    v_mfma_f32_16x16x32_bf16 v[116:119], a[52:55], v[56:59], v[116:119]
    s_add_u32 s59, s59, 1024
    buffer_load_dwordx4 v14, s[20:23], s59 offen lds
    ds_read_b64_tr_b16 v[44:45], v8 offset:45056
    v_mfma_f32_16x16x32_bf16 v[116:119], a[60:63], v[60:63], v[116:119]
    buffer_load_dwordx4 v15, s[20:23], s59 offen offset:1024 lds
    ds_read_b64_tr_b16 v[46:47], v8 offset:45568
    v_mfma_f32_16x16x32_bf16 v[120:123], a[160:163], v[48:51], v[120:123]
    v_exp_f32 v232, v232
    v_add_f32 v209, v209, v231
    v_mfma_f32_16x16x32_bf16 v[120:123], a[168:171], v[52:55], v[120:123]
    v_add_f32_e64 v209, v209, v232
    v_fma_f32 v233, v233, s74, v208
    v_fma_f32 v234, v234, s74, v208
    v_mfma_f32_16x16x32_bf16 v[120:123], a[176:179], v[56:59], v[120:123]
    v_exp_f32_e64 v233, v233
    v_fma_f32 v235, v235, s74, v208
    v_mfma_f32_16x16x32_bf16 v[120:123], a[184:187], v[60:63], v[120:123]
    v_exp_f32 v234, v234
    v_add_f32 v209, v209, v233
    v_mfma_f32_16x16x32_bf16 v[124:127], a[164:167], v[48:51], v[124:127]
    v_exp_f32 v235, v235
    v_add_f32 v209, v209, v234
    v_mfma_f32_16x16x32_bf16 v[124:127], a[172:175], v[52:55], v[124:127]
    v_add_f32_e64 v209, v209, v235
    v_fma_f32 v236, v236, s74, v208
    v_fma_f32 v237, v237, s74, v208
    v_mfma_f32_16x16x32_bf16 v[124:127], a[180:183], v[56:59], v[124:127]
    v_exp_f32_e64 v236, v236
    v_fma_f32 v238, v238, s74, v208
    v_mfma_f32_16x16x32_bf16 v[124:127], a[188:191], v[60:63], v[124:127]
    s_waitcnt lgkmcnt(0)
    v_exp_f32 v237, v237
    v_add_f32_e64 v209, v209, v236
    v_mfma_f32_16x16x32_bf16 v[96:99], a[64:67], v[32:35], v[96:99]
    s_add_u32 m0, s56, 18432
    ds_read_b64_tr_b16 v[48:49], v10 offset:32768
    v_add_f32_e64 v209, v209, v237
    v_mfma_f32_16x16x32_bf16 v[96:99], a[72:75], v[36:39], v[96:99]
    s_add_u32 s59, s87, s57
    ds_read_b64_tr_b16 v[50:51], v10 offset:33280
    v_fma_f32 v239, v239, s74, v208
    v_mfma_f32_16x16x32_bf16 v[96:99], a[80:83], v[40:43], v[96:99]
    s_add_u32 s59, s59, 58368
    buffer_load_dwordx4 v14, s[20:23], s59 offen lds
    ds_read_b64_tr_b16 v[52:53], v10 offset:36864
    v_mfma_f32_16x16x32_bf16 v[96:99], a[88:91], v[44:47], v[96:99]
    buffer_load_dwordx4 v15, s[20:23], s59 offen offset:1024 lds
    ds_read_b64_tr_b16 v[54:55], v10 offset:37376
    v_mfma_f32_16x16x32_bf16 v[100:103], a[68:71], v[32:35], v[100:103]
    ds_read_b64_tr_b16 v[56:57], v10 offset:40960
    v_max3_f32 v213, v240, v241, v242
    v_mfma_f32_16x16x32_bf16 v[100:103], a[76:79], v[36:39], v[100:103]
    s_add_u32 m0, s56, 149504
    ds_read_b64_tr_b16 v[58:59], v10 offset:41472
    v_max3_f32 v214, v243, v244, v245
    v_mfma_f32_16x16x32_bf16 v[100:103], a[84:87], v[40:43], v[100:103]
    s_xor_b32 s59, s6, 409600
    buffer_load_dwordx4 v16, s[28:31], s59 offen lds
    ds_read_b64_tr_b16 v[60:61], v10 offset:45056
    v_mfma_f32_16x16x32_bf16 v[100:103], a[92:95], v[44:47], v[100:103]
    buffer_load_dwordx4 v19, s[28:31], s59 offen offset:1024 lds
    ds_read_b64_tr_b16 v[62:63], v10 offset:45568
    v_mfma_f32_16x16x32_bf16 v[104:107], a[192:195], v[32:35], v[104:107]
    v_exp_f32 v238, v238
    v_mfma_f32_16x16x32_bf16 v[104:107], a[200:203], v[36:39], v[104:107]
    v_exp_f32_e64 v239, v239
    v_mfma_f32_16x16x32_bf16 v[104:107], a[208:211], v[40:43], v[104:107]
    v_add_f32 v209, v209, v238
    v_add_f32 v209, v209, v239
    v_mfma_f32_16x16x32_bf16 v[104:107], a[216:219], v[44:47], v[104:107]
    v_rcp_f32_e64 v209, v209
    v_mfma_f32_16x16x32_bf16 v[108:111], a[196:199], v[32:35], v[108:111]
    v_mul_f32 v224, v224, v209
    v_mul_f32 v225, v225, v209
    v_mfma_f32_16x16x32_bf16 v[108:111], a[204:207], v[36:39], v[108:111]
    v_cvt_pk_bf16_f32 v64, v224, v225
    v_mul_f32_e64 v226, v226, v209
    v_mfma_f32_16x16x32_bf16 v[108:111], a[212:215], v[40:43], v[108:111]
    v_mul_f32_e64 v227, v227, v209
    v_cvt_pk_bf16_f32 v65, v226, v227
    v_mfma_f32_16x16x32_bf16 v[224:227], v[192:195], v[72:75], 0
    v_mul_f32 v228, v228, v209
    v_mul_f32 v229, v229, v209
    v_mfma_f32_16x16x32_bf16 v[108:111], a[220:223], v[44:47], v[108:111]
    s_waitcnt vmcnt(20) lgkmcnt(0)
    s_barrier
    v_mfma_f32_16x16x32_bf16 v[112:115], a[64:67], v[48:51], v[112:115]
    ds_read_b64_tr_b16 v[32:33], v8 offset:49152
    v_cvt_pk_bf16_f32 v66, v228, v229
    v_mul_f32_e64 v230, v230, v209
    v_mfma_f32_16x16x32_bf16 v[112:115], a[72:75], v[52:55], v[112:115]
    s_add_u32 m0, s56, 32768
    ds_read_b64_tr_b16 v[34:35], v8 offset:49664
    v_mul_f32_e64 v231, v231, v209
    v_cvt_pk_bf16_f32 v67, v230, v231
    v_mfma_f32_16x16x32_bf16 v[228:231], v[196:199], v[72:75], 0
    v_mul_f32 v232, v232, v209
    v_mul_f32 v233, v233, v209
    v_cvt_pk_bf16_f32 v80, v232, v233
    v_mfma_f32_16x16x32_bf16 v[112:115], a[80:83], v[56:59], v[112:115]
    s_add_u32 s59, s88, s57
    ds_read_b64_tr_b16 v[36:37], v8 offset:53248
    v_mul_f32 v234, v234, v209
    v_mul_f32_e64 v235, v235, v209
    v_mfma_f32_16x16x32_bf16 v[112:115], a[88:91], v[60:63], v[112:115]
    s_add_u32 s59, s59, 1024
    buffer_load_dwordx4 v14, s[16:19], s59 offen lds
    ds_read_b64_tr_b16 v[38:39], v8 offset:53760
    v_mfma_f32_16x16x32_bf16 v[116:119], a[68:71], v[48:51], v[116:119]
    ds_read_b64_tr_b16 v[40:41], v8 offset:57344
    v_cvt_pk_bf16_f32 v81, v234, v235
    v_mul_f32_e64 v236, v236, v209
    v_mfma_f32_16x16x32_bf16 v[232:235], v[200:203], v[72:75], 0
    v_mul_f32_e64 v237, v237, v209
    v_cvt_pk_bf16_f32 v82, v236, v237
    v_mul_f32_e64 v238, v238, v209
    v_mfma_f32_16x16x32_bf16 v[116:119], a[76:79], v[52:55], v[116:119]
    ds_read_b64_tr_b16 v[42:43], v8 offset:57856
    v_mul_f32_e64 v239, v239, v209
    v_cvt_pk_bf16_f32 v83, v238, v239
    v_mfma_f32_16x16x32_bf16 v[236:239], v[204:207], v[72:75], 0
    v_max3_f32 v215, v246, v247, v248
    v_max3_f32 v216, v249, v250, v251
    v_max3_f32 v217, v252, v253, v254
    v_mfma_f32_16x16x32_bf16 v[116:119], a[84:87], v[56:59], v[116:119]
    buffer_load_dwordx4 v15, s[16:19], s59 offen offset:1024 lds
    ds_read_b64_tr_b16 v[44:45], v8 offset:61440
    v_mfma_f32_16x16x32_bf16 v[116:119], a[92:95], v[60:63], v[116:119]
    ds_read_b64_tr_b16 v[46:47], v8 offset:61952
    v_max3_f32 v213, v213, v214, v215
    v_max3_f32 v216, v216, v217, v255
    v_mfma_f32_16x16x32_bf16 v[120:123], a[192:195], v[48:51], v[120:123]
    ds_write_b128 v30, v[64:67] offset:0
    v_mfma_f32_16x16x32_bf16 v[120:123], a[200:203], v[52:55], v[120:123]
    v_max_f32 v213, v213, v216
    v_mul_f32 v213, s76, v213
    v_fma_f32 v240, v240, s74, v213
    v_mfma_f32_16x16x32_bf16 v[120:123], a[208:211], v[56:59], v[120:123]
    v_exp_f32_e64 v240, v240
    v_fma_f32 v241, v241, s74, v213
    v_mfma_f32_16x16x32_bf16 v[120:123], a[216:219], v[60:63], v[120:123]
    ds_write_b128 v31, v[80:83] offset:0
    v_mfma_f32_16x16x32_bf16 v[124:127], a[196:199], v[48:51], v[124:127]
    v_exp_f32_e64 v241, v241
    v_fma_f32 v242, v242, s74, v213
    v_mfma_f32_16x16x32_bf16 v[124:127], a[204:207], v[52:55], v[124:127]
    v_exp_f32 v242, v242
    v_add_f32 v214, v240, v241
    v_mfma_f32_16x16x32_bf16 v[124:127], a[212:215], v[56:59], v[124:127]
    v_add_f32_e64 v214, v214, v242
    v_fma_f32 v243, v243, s74, v213
    v_fma_f32 v244, v244, s74, v213
    v_mfma_f32_16x16x32_bf16 v[124:127], a[220:223], v[60:63], v[124:127]
    s_waitcnt lgkmcnt(2)
    v_exp_f32 v243, v243
    v_fma_f32 v245, v245, s74, v213
    v_mfma_f32_16x16x32_bf16 v[96:99], a[96:99], v[32:35], v[96:99]
    ds_read_b64_tr_b16 v[48:49], v10 offset:49152
    v_exp_f32_e64 v244, v244
    v_mfma_f32_16x16x32_bf16 v[96:99], a[104:107], v[36:39], v[96:99]
    s_add_u32 m0, s56, 34816
    ds_read_b64_tr_b16 v[50:51], v10 offset:49664
    v_exp_f32_e64 v245, v245
    v_mfma_f32_16x16x32_bf16 v[96:99], a[112:115], v[40:43], v[96:99]
    s_add_u32 s59, s88, s57
    ds_read_b64_tr_b16 v[52:53], v10 offset:53248
    v_add_f32 v214, v214, v243
    v_add_f32_e64 v214, v214, v244
    v_mfma_f32_16x16x32_bf16 v[96:99], a[120:123], v[44:47], v[96:99]
    s_add_u32 s59, s59, 58368
    buffer_load_dwordx4 v14, s[16:19], s59 offen lds
    ds_read_b64_tr_b16 v[54:55], v10 offset:53760
    v_mfma_f32_16x16x32_bf16 v[100:103], a[100:103], v[32:35], v[100:103]
    ds_read_b64_tr_b16 v[56:57], v10 offset:57344
    v_add_f32_e64 v214, v214, v245
    v_fma_f32 v246, v246, s74, v213
    v_mfma_f32_16x16x32_bf16 v[100:103], a[108:111], v[36:39], v[100:103]
    ds_read_b64_tr_b16 v[58:59], v10 offset:57856
    v_exp_f32_e64 v246, v246
    v_mfma_f32_16x16x32_bf16 v[100:103], a[116:119], v[40:43], v[100:103]
    buffer_load_dwordx4 v15, s[16:19], s59 offen offset:1024 lds
    ds_read_b64_tr_b16 v[60:61], v10 offset:61440
    v_mfma_f32_16x16x32_bf16 v[100:103], a[124:127], v[44:47], v[100:103]
    ds_read_b64_tr_b16 v[62:63], v10 offset:61952
    v_add_f32_e64 v214, v214, v246
    v_fma_f32 v247, v247, s74, v213
    v_mfma_f32_16x16x32_bf16 v[104:107], a[224:227], v[32:35], v[104:107]
    v_exp_f32_e64 v247, v247
    v_fma_f32 v248, v248, s74, v213
    v_mfma_f32_16x16x32_bf16 v[104:107], a[232:235], v[36:39], v[104:107]
    v_exp_f32 v248, v248
    v_add_f32 v214, v214, v247
    v_mfma_f32_16x16x32_bf16 v[104:107], a[240:243], v[40:43], v[104:107]
    v_add_f32_e64 v214, v214, v248
    v_fma_f32 v249, v249, s74, v213
    v_fma_f32 v250, v250, s74, v213
    v_mfma_f32_16x16x32_bf16 v[104:107], a[248:251], v[44:47], v[104:107]
    v_exp_f32_e64 v249, v249
    v_fma_f32 v251, v251, s74, v213
    v_mfma_f32_16x16x32_bf16 v[108:111], a[228:231], v[32:35], v[108:111]
    v_exp_f32 v250, v250
    v_add_f32 v214, v214, v249
    v_mfma_f32_16x16x32_bf16 v[108:111], a[236:239], v[36:39], v[108:111]
    v_exp_f32 v251, v251
    v_add_f32 v214, v214, v250
    v_mfma_f32_16x16x32_bf16 v[108:111], a[244:247], v[40:43], v[108:111]
    v_add_f32_e64 v214, v214, v251
    v_fma_f32 v252, v252, s74, v213
    v_fma_f32 v253, v253, s74, v213
    v_mfma_f32_16x16x32_bf16 v[108:111], a[252:255], v[44:47], v[108:111]
    s_waitcnt vmcnt(20) lgkmcnt(0)
    s_barrier
    v_mfma_f32_16x16x32_bf16 v[112:115], a[96:99], v[48:51], v[112:115]
    ds_read_b64_tr_b16 v[32:33], v9 offset:0
    v_fma_f32 v254, v254, s74, v213
    v_mfma_f32_16x16x32_bf16 v[112:115], a[104:107], v[52:55], v[112:115]
    s_add_u32 m0, s56, 49152
    ds_read_b64_tr_b16 v[34:35], v9 offset:512
    v_fma_f32 v255, v255, s74, v213
    v_mfma_f32_16x16x32_bf16 v[112:115], a[112:115], v[56:59], v[112:115]
    s_add_u32 s59, s88, s57
    ds_read_b64_tr_b16 v[36:37], v9 offset:4096
    v_cvt_pk_bf16_f32 v76, v76, v77
    v_mfma_f32_16x16x32_bf16 v[112:115], a[120:123], v[60:63], v[112:115]
    s_add_u32 s59, s59, 1024
    buffer_load_dwordx4 v14, s[20:23], s59 offen lds
    ds_read_b64_tr_b16 v[38:39], v9 offset:4608
    v_mfma_f32_16x16x32_bf16 v[116:119], a[100:103], v[48:51], v[116:119]
    ds_read_b64_tr_b16 v[40:41], v9 offset:8192
    v_cvt_pk_bf16_f32 v77, v78, v79
    v_mfma_f32_16x16x32_bf16 v[116:119], a[108:111], v[52:55], v[116:119]
    ds_read_b64_tr_b16 v[42:43], v9 offset:8704
    v_cvt_pk_bf16_f32 v78, v92, v93
    v_mfma_f32_16x16x32_bf16 v[116:119], a[116:119], v[56:59], v[116:119]
    buffer_load_dwordx4 v15, s[20:23], s59 offen offset:1024 lds
    ds_read_b64_tr_b16 v[44:45], v9 offset:12288
    v_mfma_f32_16x16x32_bf16 v[116:119], a[124:127], v[60:63], v[116:119]
    ds_read_b64_tr_b16 v[46:47], v9 offset:12800
    v_cvt_pk_bf16_f32 v79, v94, v95
    v_mfma_f32_16x16x32_bf16 v[120:123], a[224:227], v[48:51], v[120:123]
    v_exp_f32 v252, v252
    v_mfma_f32_16x16x32_bf16 v[120:123], a[232:235], v[52:55], v[120:123]
    v_exp_f32_e64 v253, v253
    v_mfma_f32_16x16x32_bf16 v[120:123], a[240:243], v[56:59], v[120:123]
    v_exp_f32_e64 v254, v254
    v_mfma_f32_16x16x32_bf16 v[120:123], a[248:251], v[60:63], v[120:123]
    v_exp_f32_e64 v255, v255
    v_mfma_f32_16x16x32_bf16 v[124:127], a[228:231], v[48:51], v[124:127]
    v_add_f32 v214, v214, v252
    v_add_f32 v214, v214, v253
    v_mfma_f32_16x16x32_bf16 v[124:127], a[236:239], v[52:55], v[124:127]
    v_add_f32 v214, v214, v254
    v_add_f32 v214, v214, v255
    v_mfma_f32_16x16x32_bf16 v[124:127], a[244:247], v[56:59], v[124:127]
    v_rcp_f32_e64 v214, v214
    v_mfma_f32_16x16x32_bf16 v[124:127], a[252:255], v[60:63], v[124:127]
    s_waitcnt lgkmcnt(0)
    v_mul_f32 v240, v240, v214
    v_mul_f32 v241, v241, v214
    v_mfma_f32_16x16x32_bf16 v[128:131], v[32:35], a[0:3], 0
    ds_read_b64_tr_b16 v[48:49], v11 offset:0
    v_cvt_pk_bf16_f32 v68, v240, v241
    v_mul_f32 v242, v242, v214
    v_mfma_f32_16x16x32_bf16 v[128:131], v[36:39], a[8:11], v[128:131]
    s_add_u32 m0, s56, 51200
    ds_read_b64_tr_b16 v[50:51], v11 offset:512
    v_mul_f32_e64 v243, v243, v214
    v_cvt_pk_bf16_f32 v69, v242, v243
    v_mfma_f32_16x16x32_bf16 v[240:243], v[192:195], v[76:79], 0
    v_mul_f32 v244, v244, v214
    v_mul_f32 v245, v245, v214
    v_cvt_pk_bf16_f32 v70, v244, v245
    v_mfma_f32_16x16x32_bf16 v[128:131], v[40:43], a[16:19], v[128:131]
    s_add_u32 s59, s88, s57
    ds_read_b64_tr_b16 v[52:53], v11 offset:4096
    v_add_u32 v29, s56, v2
    v_add_u32 v29, 131072, v29
    v_mfma_f32_16x16x32_bf16 v[128:131], v[44:47], a[24:27], v[128:131]
    s_add_u32 s59, s59, 58368
    buffer_load_dwordx4 v14, s[20:23], s59 offen lds
    ds_read_b64_tr_b16 v[54:55], v11 offset:4608
    v_mfma_f32_16x16x32_bf16 v[132:135], v[32:35], a[4:7], 0
    ds_read_b64_tr_b16 v[56:57], v11 offset:8192
    v_cvt_pk_bf16_f32 v96, v96, v97
    v_cvt_pk_bf16_f32 v97, v98, v99
    v_mfma_f32_16x16x32_bf16 v[132:135], v[36:39], a[12:15], v[132:135]
    ds_read_b64_tr_b16 v[58:59], v11 offset:8704
    v_cvt_pk_bf16_f32 v98, v100, v101
    v_cvt_pk_bf16_f32 v99, v102, v103
    v_mfma_f32_16x16x32_bf16 v[132:135], v[40:43], a[20:23], v[132:135]
    buffer_load_dwordx4 v15, s[20:23], s59 offen offset:1024 lds
    ds_read_b64_tr_b16 v[60:61], v11 offset:12288
    v_mfma_f32_16x16x32_bf16 v[132:135], v[44:47], a[28:31], v[132:135]
    ds_read_b64_tr_b16 v[62:63], v11 offset:12800
    v_cvt_pk_bf16_f32 v104, v104, v105
    v_cvt_pk_bf16_f32 v105, v106, v107
    v_mfma_f32_16x16x32_bf16 v[136:139], v[32:35], a[128:131], 0
    ds_write_b128 v29, v[96:99] offset:0
    v_mfma_f32_16x16x32_bf16 v[136:139], v[36:39], a[136:139], v[136:139]
    v_cvt_pk_bf16_f32 v106, v108, v109
    v_cvt_pk_bf16_f32 v107, v110, v111
    v_cvt_pk_bf16_f32 v112, v112, v113
    v_mfma_f32_16x16x32_bf16 v[136:139], v[40:43], a[144:147], v[136:139]
    v_cvt_pk_bf16_f32 v113, v114, v115
    v_cvt_pk_bf16_f32 v114, v116, v117
    v_cvt_pk_bf16_f32 v115, v118, v119
    v_mfma_f32_16x16x32_bf16 v[136:139], v[44:47], a[152:155], v[136:139]
    ds_write_b128 v29, v[104:107] offset:1024
    v_mfma_f32_16x16x32_bf16 v[140:143], v[32:35], a[132:135], 0
    v_cvt_pk_bf16_f32 v120, v120, v121
    v_cvt_pk_bf16_f32 v121, v122, v123
    v_cvt_pk_bf16_f32 v122, v124, v125
    v_mfma_f32_16x16x32_bf16 v[140:143], v[36:39], a[140:143], v[140:143]
    v_cvt_pk_bf16_f32 v123, v126, v127
    v_mul_f32 v246, v246, v214
    v_mul_f32 v247, v247, v214
    v_mfma_f32_16x16x32_bf16 v[140:143], v[40:43], a[148:151], v[140:143]
    v_cvt_pk_bf16_f32 v71, v246, v247
    v_mul_f32 v248, v248, v214
    v_mul_f32 v249, v249, v214
    v_mfma_f32_16x16x32_bf16 v[244:247], v[196:199], v[76:79], 0
    v_cvt_pk_bf16_f32 v84, v248, v249
    v_mul_f32 v250, v250, v214
    v_mul_f32 v251, v251, v214
    v_mfma_f32_16x16x32_bf16 v[140:143], v[44:47], a[156:159], v[140:143]
    s_waitcnt vmcnt(20) lgkmcnt(2)
    s_barrier
    v_mfma_f32_16x16x32_bf16 v[144:147], v[48:51], a[0:3], 0
    ds_read_b64_tr_b16 v[32:33], v9 offset:16384
    v_cvt_pk_bf16_f32 v85, v250, v251
    v_mul_f32_e64 v252, v252, v214
    v_mfma_f32_16x16x32_bf16 v[248:251], v[200:203], v[76:79], 0
    v_mul_f32_e64 v253, v253, v214
    v_cvt_pk_bf16_f32 v86, v252, v253
    v_mul_f32_e64 v254, v254, v214
    v_mfma_f32_16x16x32_bf16 v[144:147], v[52:55], a[8:11], v[144:147]
    s_add_u32 m0, s56, 65536
    ds_read_b64_tr_b16 v[34:35], v9 offset:16896
    v_mul_f32_e64 v255, v255, v214
    v_cvt_pk_bf16_f32 v87, v254, v255
    v_mfma_f32_16x16x32_bf16 v[252:255], v[204:207], v[76:79], 0
    v_max3_f32 v208, v224, v225, v226
    v_max3_f32 v209, v227, v228, v229
    v_max3_f32 v210, v230, v231, v232
    v_mfma_f32_16x16x32_bf16 v[144:147], v[56:59], a[16:19], v[144:147]
    s_add_u32 s59, s89, s57
    ds_read_b64_tr_b16 v[36:37], v9 offset:20480
    v_max3_f32 v211, v233, v234, v235
    v_max3_f32 v212, v236, v237, v238
    v_mfma_f32_16x16x32_bf16 v[144:147], v[60:63], a[24:27], v[144:147]
    s_add_u32 s59, s59, 1024
    buffer_load_dwordx4 v14, s[16:19], s59 offen lds
    ds_read_b64_tr_b16 v[38:39], v9 offset:20992
    v_mfma_f32_16x16x32_bf16 v[148:151], v[48:51], a[4:7], 0
    ds_read_b64_tr_b16 v[40:41], v9 offset:24576
    v_max3_f32 v208, v208, v209, v210
    v_max3_f32 v211, v211, v212, v239
    v_mfma_f32_16x16x32_bf16 v[148:151], v[52:55], a[12:15], v[148:151]
    ds_read_b64_tr_b16 v[42:43], v9 offset:25088
    v_max_f32 v208, v208, v211
    v_mul_f32_e64 v208, s76, v208
    v_mfma_f32_16x16x32_bf16 v[148:151], v[56:59], a[20:23], v[148:151]
    buffer_load_dwordx4 v15, s[16:19], s59 offen offset:1024 lds
    ds_read_b64_tr_b16 v[44:45], v9 offset:28672
    v_mfma_f32_16x16x32_bf16 v[148:151], v[60:63], a[28:31], v[148:151]
    ds_read_b64_tr_b16 v[46:47], v9 offset:29184
    v_fma_f32 v224, v224, s74, v208
    v_fma_f32 v225, v225, s74, v208
    v_mfma_f32_16x16x32_bf16 v[152:155], v[48:51], a[128:131], 0
    ds_write_b128 v29, v[112:115] offset:2048
    v_mfma_f32_16x16x32_bf16 v[152:155], v[52:55], a[136:139], v[152:155]
    v_exp_f32_e64 v224, v224
    v_fma_f32 v226, v226, s74, v208
    v_mfma_f32_16x16x32_bf16 v[152:155], v[56:59], a[144:147], v[152:155]
    v_exp_f32_e64 v225, v225
    v_fma_f32 v227, v227, s74, v208
    v_mfma_f32_16x16x32_bf16 v[152:155], v[60:63], a[152:155], v[152:155]
    ds_write_b128 v29, v[120:123] offset:3072
    v_mfma_f32_16x16x32_bf16 v[156:159], v[48:51], a[132:135], 0
    v_exp_f32 v226, v226
    v_add_f32 v209, v224, v225
    v_mfma_f32_16x16x32_bf16 v[156:159], v[52:55], a[140:143], v[156:159]
    v_exp_f32 v227, v227
    v_add_f32 v209, v209, v226
    v_mfma_f32_16x16x32_bf16 v[156:159], v[56:59], a[148:151], v[156:159]
    v_add_f32_e64 v209, v209, v227
    v_fma_f32 v228, v228, s74, v208
    v_fma_f32 v229, v229, s74, v208
    v_mfma_f32_16x16x32_bf16 v[156:159], v[60:63], a[156:159], v[156:159]
    s_waitcnt lgkmcnt(2)
    v_exp_f32 v228, v228
    v_fma_f32 v230, v230, s74, v208
    buffer_load_dword v17, v3, s[40:43], 0 offen sc1
    v_mfma_f32_16x16x32_bf16 v[160:163], v[32:35], a[0:3], 0
    ds_read_b64_tr_b16 v[48:49], v11 offset:16384
    v_exp_f32_e64 v229, v229
    v_mfma_f32_16x16x32_bf16 v[160:163], v[36:39], a[8:11], v[160:163]
    s_add_u32 m0, s56, 67584
    ds_read_b64_tr_b16 v[50:51], v11 offset:16896
    v_exp_f32_e64 v230, v230
    v_mfma_f32_16x16x32_bf16 v[160:163], v[40:43], a[16:19], v[160:163]
    s_add_u32 s59, s89, s57
    ds_read_b64_tr_b16 v[52:53], v11 offset:20480
    v_add_f32 v209, v209, v228
    v_add_f32_e64 v209, v209, v229
    v_mfma_f32_16x16x32_bf16 v[160:163], v[44:47], a[24:27], v[160:163]
    s_add_u32 s59, s59, 58368
    buffer_load_dwordx4 v14, s[16:19], s59 offen lds
    ds_read_b64_tr_b16 v[54:55], v11 offset:20992
    v_mfma_f32_16x16x32_bf16 v[164:167], v[32:35], a[4:7], 0
    ds_read_b64_tr_b16 v[56:57], v11 offset:24576
    v_add_f32_e64 v209, v209, v230
    v_fma_f32 v231, v231, s74, v208
    v_mfma_f32_16x16x32_bf16 v[164:167], v[36:39], a[12:15], v[164:167]
    ds_read_b64_tr_b16 v[58:59], v11 offset:25088
    v_exp_f32_e64 v231, v231
    v_mfma_f32_16x16x32_bf16 v[164:167], v[40:43], a[20:23], v[164:167]
    buffer_load_dwordx4 v15, s[16:19], s59 offen offset:1024 lds
    ds_read_b64_tr_b16 v[60:61], v11 offset:28672
    v_mfma_f32_16x16x32_bf16 v[164:167], v[44:47], a[28:31], v[164:167]
    ds_read_b64_tr_b16 v[62:63], v11 offset:29184
    v_add_f32_e64 v209, v209, v231
    v_fma_f32 v232, v232, s74, v208
    v_mfma_f32_16x16x32_bf16 v[168:171], v[32:35], a[128:131], 0
    ds_write_b128 v30, v[68:71] offset:2048
    v_mfma_f32_16x16x32_bf16 v[168:171], v[36:39], a[136:139], v[168:171]
    v_exp_f32_e64 v232, v232
    v_fma_f32 v233, v233, s74, v208
    v_mfma_f32_16x16x32_bf16 v[168:171], v[40:43], a[144:147], v[168:171]
    v_exp_f32 v233, v233
    v_add_f32 v209, v209, v232
    v_mfma_f32_16x16x32_bf16 v[168:171], v[44:47], a[152:155], v[168:171]
    ds_write_b128 v31, v[84:87] offset:2048
    v_mfma_f32_16x16x32_bf16 v[172:175], v[32:35], a[132:135], 0
    v_add_f32_e64 v209, v209, v233
    v_fma_f32 v234, v234, s74, v208
    v_fma_f32 v235, v235, s74, v208
    v_mfma_f32_16x16x32_bf16 v[172:175], v[36:39], a[140:143], v[172:175]
    v_exp_f32_e64 v234, v234
    v_fma_f32 v236, v236, s74, v208
    v_mfma_f32_16x16x32_bf16 v[172:175], v[40:43], a[148:151], v[172:175]
    v_exp_f32 v235, v235
    v_add_f32 v209, v209, v234
    v_mfma_f32_16x16x32_bf16 v[172:175], v[44:47], a[156:159], v[172:175]
    s_waitcnt vmcnt(19) lgkmcnt(2)
    s_barrier
    v_mfma_f32_16x16x32_bf16 v[176:179], v[48:51], a[0:3], 0
    ds_read_b64_tr_b16 v[32:33], v8 offset:0
    v_exp_f32_e64 v236, v236
    v_mfma_f32_16x16x32_bf16 v[176:179], v[52:55], a[8:11], v[176:179]
    s_add_u32 m0, s56, 81920
    ds_read_b64_tr_b16 v[34:35], v8 offset:512
    v_add_f32 v209, v209, v235
    v_add_f32 v209, v209, v236
    v_mfma_f32_16x16x32_bf16 v[176:179], v[56:59], a[16:19], v[176:179]
    s_add_u32 s59, s89, s57
    ds_read_b64_tr_b16 v[36:37], v8 offset:4096
    v_fma_f32 v237, v237, s74, v208
    v_fma_f32 v238, v238, s74, v208
    v_mfma_f32_16x16x32_bf16 v[176:179], v[60:63], a[24:27], v[176:179]
    s_add_u32 s59, s59, 1024
    buffer_load_dwordx4 v14, s[20:23], s59 offen lds
    ds_read_b64_tr_b16 v[38:39], v8 offset:4608
    v_mfma_f32_16x16x32_bf16 v[180:183], v[48:51], a[4:7], 0
    ds_read_b64_tr_b16 v[40:41], v8 offset:8192
    v_exp_f32 v237, v237
    v_mfma_f32_16x16x32_bf16 v[180:183], v[52:55], a[12:15], v[180:183]
    ds_read_b64_tr_b16 v[42:43], v8 offset:8704
    v_exp_f32_e64 v238, v238
    v_mfma_f32_16x16x32_bf16 v[180:183], v[56:59], a[20:23], v[180:183]
    buffer_load_dwordx4 v15, s[20:23], s59 offen offset:1024 lds
    ds_read_b64_tr_b16 v[44:45], v8 offset:12288
    v_mfma_f32_16x16x32_bf16 v[180:183], v[60:63], a[28:31], v[180:183]
    ds_read_b64_tr_b16 v[46:47], v8 offset:12800
    v_add_f32 v209, v209, v237
    v_add_f32 v209, v209, v238
    v_mfma_f32_16x16x32_bf16 v[184:187], v[48:51], a[128:131], 0
    v_fma_f32 v239, v239, s74, v208
    v_exp_f32_e64 v239, v239
    v_mfma_f32_16x16x32_bf16 v[184:187], v[52:55], a[136:139], v[184:187]
    v_add_f32 v209, v209, v239
    v_rcp_f32 v209, v209
    v_mfma_f32_16x16x32_bf16 v[184:187], v[56:59], a[144:147], v[184:187]
    v_mul_f32 v224, v224, v209
    v_mul_f32 v225, v225, v209
    v_cvt_pk_bf16_f32 v72, v224, v225
    v_mfma_f32_16x16x32_bf16 v[184:187], v[60:63], a[152:155], v[184:187]
    v_mul_f32 v226, v226, v209
    v_mul_f32 v227, v227, v209
    v_cvt_pk_bf16_f32 v73, v226, v227
    v_mfma_f32_16x16x32_bf16 v[188:191], v[48:51], a[132:135], 0
    v_mul_f32 v228, v228, v209
    v_mul_f32 v229, v229, v209
    v_cvt_pk_bf16_f32 v74, v228, v229
    v_mfma_f32_16x16x32_bf16 v[188:191], v[52:55], a[140:143], v[188:191]
    v_mul_f32 v230, v230, v209
    v_mul_f32 v231, v231, v209
    v_cvt_pk_bf16_f32 v75, v230, v231
    v_mfma_f32_16x16x32_bf16 v[188:191], v[56:59], a[148:151], v[188:191]
    v_mul_f32 v232, v232, v209
    v_mul_f32 v233, v233, v209
    v_cvt_pk_bf16_f32 v88, v232, v233
    v_mfma_f32_16x16x32_bf16 v[188:191], v[60:63], a[156:159], v[188:191]
    s_waitcnt lgkmcnt(0)
    v_mul_f32 v234, v234, v209
    v_mul_f32_e64 v235, v235, v209
    v_cvt_pk_bf16_f32 v89, v234, v235
    v_mfma_f32_16x16x32_bf16 v[128:131], v[32:35], a[32:35], v[128:131]
    ds_read_b64_tr_b16 v[48:49], v10 offset:0
    v_mul_f32_e64 v236, v236, v209
    v_mfma_f32_16x16x32_bf16 v[128:131], v[36:39], a[40:43], v[128:131]
    s_add_u32 m0, s56, 83968
    ds_read_b64_tr_b16 v[50:51], v10 offset:512
    v_mul_f32_e64 v237, v237, v209
    v_mfma_f32_16x16x32_bf16 v[128:131], v[40:43], a[48:51], v[128:131]
    s_add_u32 s59, s89, s57
    ds_read_b64_tr_b16 v[52:53], v10 offset:4096
    v_cvt_pk_bf16_f32 v90, v236, v237
    v_mfma_f32_16x16x32_bf16 v[128:131], v[44:47], a[56:59], v[128:131]
    s_add_u32 s59, s59, 58368
    buffer_load_dwordx4 v14, s[20:23], s59 offen lds
    ds_read_b64_tr_b16 v[54:55], v10 offset:4608
    v_mfma_f32_16x16x32_bf16 v[132:135], v[32:35], a[36:39], v[132:135]
    ds_read_b64_tr_b16 v[56:57], v10 offset:8192
    v_mul_f32 v238, v238, v209
    v_mfma_f32_16x16x32_bf16 v[132:135], v[36:39], a[44:47], v[132:135]
    ds_read_b64_tr_b16 v[58:59], v10 offset:8704
    v_mul_f32_e64 v239, v239, v209
    v_mfma_f32_16x16x32_bf16 v[132:135], v[40:43], a[52:55], v[132:135]
    buffer_load_dwordx4 v15, s[20:23], s59 offen offset:1024 lds
    ds_read_b64_tr_b16 v[60:61], v10 offset:12288
    v_mfma_f32_16x16x32_bf16 v[132:135], v[44:47], a[60:63], v[132:135]
    ds_read_b64_tr_b16 v[62:63], v10 offset:12800
    v_cvt_pk_bf16_f32 v91, v238, v239
    v_mfma_f32_16x16x32_bf16 v[136:139], v[32:35], a[160:163], v[136:139]
    ds_write_b128 v30, v[72:75] offset:16384
    v_mfma_f32_16x16x32_bf16 v[136:139], v[36:39], a[168:171], v[136:139]
    v_max3_f32 v213, v240, v241, v242
    v_max3_f32 v214, v243, v244, v245
    v_mfma_f32_16x16x32_bf16 v[136:139], v[40:43], a[176:179], v[136:139]
    v_max3_f32 v215, v246, v247, v248
    v_max3_f32 v216, v249, v250, v251
    v_mfma_f32_16x16x32_bf16 v[136:139], v[44:47], a[184:187], v[136:139]
    ds_write_b128 v31, v[88:91] offset:16384
    v_mfma_f32_16x16x32_bf16 v[140:143], v[32:35], a[164:167], v[140:143]
    v_max3_f32 v217, v252, v253, v254
    v_max3_f32 v213, v213, v214, v215
    v_mfma_f32_16x16x32_bf16 v[140:143], v[36:39], a[172:175], v[140:143]
    v_max3_f32 v216, v216, v217, v255
    v_max_f32_e64 v213, v213, v216
    v_mfma_f32_16x16x32_bf16 v[140:143], v[40:43], a[180:183], v[140:143]
    v_mul_f32_e64 v213, s76, v213
    v_fma_f32 v240, v240, s74, v213
    v_mfma_f32_16x16x32_bf16 v[140:143], v[44:47], a[188:191], v[140:143]
    s_waitcnt vmcnt(19) lgkmcnt(2)
    s_barrier
    v_mfma_f32_16x16x32_bf16 v[144:147], v[48:51], a[32:35], v[144:147]
    ds_read_b64_tr_b16 v[32:33], v8 offset:16384
    v_exp_f32_e64 v240, v240
    v_mfma_f32_16x16x32_bf16 v[144:147], v[52:55], a[40:43], v[144:147]
    s_add_u32 m0, s56, 0
    ds_read_b64_tr_b16 v[34:35], v8 offset:16896
    v_fma_f32 v241, v241, s74, v213
    v_fma_f32 v242, v242, s74, v213
    v_mfma_f32_16x16x32_bf16 v[144:147], v[56:59], a[48:51], v[144:147]
    s_add_u32 s59, s86, s58
    ds_read_b64_tr_b16 v[36:37], v8 offset:20480
    v_exp_f32_e64 v241, v241
    v_mfma_f32_16x16x32_bf16 v[144:147], v[60:63], a[56:59], v[144:147]
    s_add_u32 s59, s59, 3072
    buffer_load_dwordx4 v14, s[16:19], s59 offen lds
    ds_read_b64_tr_b16 v[38:39], v8 offset:20992
    v_mfma_f32_16x16x32_bf16 v[148:151], v[48:51], a[36:39], v[148:151]
    ds_read_b64_tr_b16 v[40:41], v8 offset:24576
    v_exp_f32_e64 v242, v242
    v_mfma_f32_16x16x32_bf16 v[148:151], v[52:55], a[44:47], v[148:151]
    ds_read_b64_tr_b16 v[42:43], v8 offset:25088
    v_add_f32 v214, v240, v241
    v_add_f32 v214, v214, v242
    v_mfma_f32_16x16x32_bf16 v[148:151], v[56:59], a[52:55], v[148:151]
    buffer_load_dwordx4 v15, s[16:19], s59 offen offset:1024 lds
    ds_read_b64_tr_b16 v[44:45], v8 offset:28672
    v_mfma_f32_16x16x32_bf16 v[148:151], v[60:63], a[60:63], v[148:151]
    ds_read_b64_tr_b16 v[46:47], v8 offset:29184
    v_fma_f32 v243, v243, s74, v213
    v_fma_f32 v244, v244, s74, v213
    v_mfma_f32_16x16x32_bf16 v[152:155], v[48:51], a[160:163], v[152:155]
    v_exp_f32_e64 v243, v243
    v_fma_f32 v245, v245, s74, v213
    v_mfma_f32_16x16x32_bf16 v[152:155], v[52:55], a[168:171], v[152:155]
    v_exp_f32 v244, v244
    v_add_f32 v214, v214, v243
    v_mfma_f32_16x16x32_bf16 v[152:155], v[56:59], a[176:179], v[152:155]
    v_exp_f32 v245, v245
    v_add_f32 v214, v214, v244
    v_mfma_f32_16x16x32_bf16 v[152:155], v[60:63], a[184:187], v[152:155]
    v_add_f32_e64 v214, v214, v245
    v_fma_f32 v246, v246, s74, v213
    v_fma_f32 v247, v247, s74, v213
    v_mfma_f32_16x16x32_bf16 v[156:159], v[48:51], a[164:167], v[156:159]
    v_exp_f32_e64 v246, v246
    v_fma_f32 v248, v248, s74, v213
    v_mfma_f32_16x16x32_bf16 v[156:159], v[52:55], a[172:175], v[156:159]
    v_exp_f32 v247, v247
    v_add_f32 v214, v214, v246
    v_mfma_f32_16x16x32_bf16 v[156:159], v[56:59], a[180:183], v[156:159]
    v_exp_f32 v248, v248
    v_add_f32 v214, v214, v247
    v_mfma_f32_16x16x32_bf16 v[156:159], v[60:63], a[188:191], v[156:159]
    s_waitcnt lgkmcnt(0)
    v_add_f32 v214, v214, v248
    v_fma_f32 v249, v249, s74, v213
    v_fma_f32 v250, v250, s74, v213
    v_mfma_f32_16x16x32_bf16 v[160:163], v[32:35], a[32:35], v[160:163]
    ds_read_b64_tr_b16 v[48:49], v10 offset:16384
    v_exp_f32_e64 v249, v249
    v_mfma_f32_16x16x32_bf16 v[160:163], v[36:39], a[40:43], v[160:163]
    s_add_u32 m0, s56, 2048
    ds_read_b64_tr_b16 v[50:51], v10 offset:16896
    v_exp_f32_e64 v250, v250
    v_mfma_f32_16x16x32_bf16 v[160:163], v[40:43], a[48:51], v[160:163]
    s_add_u32 s59, s86, s58
    ds_read_b64_tr_b16 v[52:53], v10 offset:20480
    v_add_f32 v214, v214, v249
    v_add_f32_e64 v214, v214, v250
    v_mfma_f32_16x16x32_bf16 v[160:163], v[44:47], a[56:59], v[160:163]
    s_add_u32 s59, s59, 60416
    buffer_load_dwordx4 v14, s[16:19], s59 offen lds
    ds_read_b64_tr_b16 v[54:55], v10 offset:20992
    v_mfma_f32_16x16x32_bf16 v[164:167], v[32:35], a[36:39], v[164:167]
    ds_read_b64_tr_b16 v[56:57], v10 offset:24576
    v_fma_f32 v251, v251, s74, v213
    v_fma_f32 v252, v252, s74, v213
    v_mfma_f32_16x16x32_bf16 v[164:167], v[36:39], a[44:47], v[164:167]
    ds_read_b64_tr_b16 v[58:59], v10 offset:25088
    v_exp_f32_e64 v251, v251
    v_mfma_f32_16x16x32_bf16 v[164:167], v[40:43], a[52:55], v[164:167]
    buffer_load_dwordx4 v15, s[16:19], s59 offen offset:1024 lds
    ds_read_b64_tr_b16 v[60:61], v10 offset:28672
    v_mfma_f32_16x16x32_bf16 v[164:167], v[44:47], a[60:63], v[164:167]
    ds_read_b64_tr_b16 v[62:63], v10 offset:29184
    v_exp_f32_e64 v252, v252
    v_mfma_f32_16x16x32_bf16 v[168:171], v[32:35], a[160:163], v[168:171]
    v_add_f32 v214, v214, v251
    v_add_f32 v214, v214, v252
    v_fma_f32 v253, v253, s74, v213
    v_mfma_f32_16x16x32_bf16 v[168:171], v[36:39], a[168:171], v[168:171]
    v_exp_f32_e64 v253, v253
    v_fma_f32 v254, v254, s74, v213
    v_mfma_f32_16x16x32_bf16 v[168:171], v[40:43], a[176:179], v[168:171]
    v_exp_f32 v254, v254
    v_add_f32 v214, v214, v253
    v_mfma_f32_16x16x32_bf16 v[168:171], v[44:47], a[184:187], v[168:171]
    v_add_f32_e64 v214, v214, v254
    v_fma_f32 v255, v255, s74, v213
    v_mfma_f32_16x16x32_bf16 v[172:175], v[32:35], a[164:167], v[172:175]
    v_exp_f32_e64 v255, v255
    v_mfma_f32_16x16x32_bf16 v[172:175], v[36:39], a[172:175], v[172:175]
    v_add_f32 v214, v214, v255
    v_rcp_f32 v214, v214
    v_mfma_f32_16x16x32_bf16 v[172:175], v[40:43], a[180:183], v[172:175]
    v_mul_f32 v240, v240, v214
    v_mul_f32 v241, v241, v214
    v_cvt_pk_bf16_f32 v76, v240, v241
    v_mfma_f32_16x16x32_bf16 v[172:175], v[44:47], a[188:191], v[172:175]
    s_waitcnt vmcnt(17) lgkmcnt(0)
    s_barrier
    v_mfma_f32_16x16x32_bf16 v[176:179], v[48:51], a[32:35], v[176:179]
    ds_read_b64_tr_b16 v[32:33], v8 offset:32768
    v_mul_f32_e64 v242, v242, v214
    v_mfma_f32_16x16x32_bf16 v[176:179], v[52:55], a[40:43], v[176:179]
    s_add_u32 m0, s56, 16384
    ds_read_b64_tr_b16 v[34:35], v8 offset:33280
    v_mul_f32_e64 v243, v243, v214
    v_mfma_f32_16x16x32_bf16 v[176:179], v[56:59], a[48:51], v[176:179]
    s_add_u32 s59, s86, s58
    ds_read_b64_tr_b16 v[36:37], v8 offset:36864
    v_cvt_pk_bf16_f32 v77, v242, v243
    v_mfma_f32_16x16x32_bf16 v[176:179], v[60:63], a[56:59], v[176:179]
    s_add_u32 s59, s59, 3072
    buffer_load_dwordx4 v14, s[20:23], s59 offen lds
    ds_read_b64_tr_b16 v[38:39], v8 offset:37376
    v_mfma_f32_16x16x32_bf16 v[180:183], v[48:51], a[36:39], v[180:183]
    ds_read_b64_tr_b16 v[40:41], v8 offset:40960
    v_mul_f32 v244, v244, v214
    v_mfma_f32_16x16x32_bf16 v[180:183], v[52:55], a[44:47], v[180:183]
    ds_read_b64_tr_b16 v[42:43], v8 offset:41472
    v_mul_f32_e64 v245, v245, v214
    v_mfma_f32_16x16x32_bf16 v[180:183], v[56:59], a[52:55], v[180:183]
    buffer_load_dwordx4 v15, s[20:23], s59 offen offset:1024 lds
    ds_read_b64_tr_b16 v[44:45], v8 offset:45056
    v_mfma_f32_16x16x32_bf16 v[180:183], v[60:63], a[60:63], v[180:183]
    ds_read_b64_tr_b16 v[46:47], v8 offset:45568
    v_cvt_pk_bf16_f32 v78, v244, v245
    v_mfma_f32_16x16x32_bf16 v[184:187], v[48:51], a[160:163], v[184:187]
    v_mul_f32 v246, v246, v214
    v_mul_f32 v247, v247, v214
    v_mfma_f32_16x16x32_bf16 v[184:187], v[52:55], a[168:171], v[184:187]
    v_cvt_pk_bf16_f32 v79, v246, v247
    v_mul_f32_e64 v248, v248, v214
    v_mfma_f32_16x16x32_bf16 v[184:187], v[56:59], a[176:179], v[184:187]
    ds_write_b128 v30, v[76:79] offset:18432
    v_mfma_f32_16x16x32_bf16 v[184:187], v[60:63], a[184:187], v[184:187]
    v_mul_f32_e64 v249, v249, v214
    v_cvt_pk_bf16_f32 v92, v248, v249
    v_mfma_f32_16x16x32_bf16 v[188:191], v[48:51], a[164:167], v[188:191]
    v_mul_f32 v250, v250, v214
    v_mul_f32 v251, v251, v214
    v_mfma_f32_16x16x32_bf16 v[188:191], v[52:55], a[172:175], v[188:191]
    v_cvt_pk_bf16_f32 v93, v250, v251
    v_mul_f32_e64 v252, v252, v214
    v_mfma_f32_16x16x32_bf16 v[188:191], v[56:59], a[180:183], v[188:191]
    v_mul_f32_e64 v253, v253, v214
    v_cvt_pk_bf16_f32 v94, v252, v253
    v_mfma_f32_16x16x32_bf16 v[188:191], v[60:63], a[188:191], v[188:191]
    s_waitcnt vmcnt(12)
    v_mul_f32 v254, v254, v214
    v_mul_f32 v255, v255, v214
    v_cmp_gt_u32 vcc, 1, v17
    s_nop 0
    s_and_b32 vcc_lo, vcc_lo, 0xff
    s_cbranch_scc1 L_k_retry0
L_k_back0:
    s_waitcnt lgkmcnt(1)
    v_mfma_f32_16x16x32_bf16 v[128:131], v[32:35], a[64:67], v[128:131]
    ds_read_b64_tr_b16 v[48:49], v10 offset:32768
    v_cvt_pk_bf16_f32 v95, v254, v255
    v_mfma_f32_16x16x32_bf16 v[128:131], v[36:39], a[72:75], v[128:131]
    s_add_u32 m0, s56, 18432
    ds_read_b64_tr_b16 v[50:51], v10 offset:33280
    v_mfma_f32_16x16x32_bf16 v[128:131], v[40:43], a[80:83], v[128:131]
    s_add_u32 s59, s86, s58
    ds_read_b64_tr_b16 v[52:53], v10 offset:36864
    v_mfma_f32_16x16x32_bf16 v[128:131], v[44:47], a[88:91], v[128:131]
    s_add_u32 s59, s59, 60416
    buffer_load_dwordx4 v14, s[20:23], s59 offen lds
    ds_read_b64_tr_b16 v[54:55], v10 offset:37376
    v_mfma_f32_16x16x32_bf16 v[132:135], v[32:35], a[68:71], v[132:135]
    ds_read_b64_tr_b16 v[56:57], v10 offset:40960
    v_mfma_f32_16x16x32_bf16 v[132:135], v[36:39], a[76:79], v[132:135]
    ds_read_b64_tr_b16 v[58:59], v10 offset:41472
    v_mfma_f32_16x16x32_bf16 v[132:135], v[40:43], a[84:87], v[132:135]
    buffer_load_dwordx4 v15, s[20:23], s59 offen offset:1024 lds
    ds_read_b64_tr_b16 v[60:61], v10 offset:45056
    v_mfma_f32_16x16x32_bf16 v[132:135], v[44:47], a[92:95], v[132:135]
    ds_read_b64_tr_b16 v[62:63], v10 offset:45568
    v_mfma_f32_16x16x32_bf16 v[136:139], v[32:35], a[192:195], v[136:139]
    ds_write_b128 v31, v[92:95] offset:18432
    v_mfma_f32_16x16x32_bf16 v[136:139], v[36:39], a[200:203], v[136:139]
    v_mfma_f32_16x16x32_bf16 v[136:139], v[40:43], a[208:211], v[136:139]
    v_mfma_f32_16x16x32_bf16 v[136:139], v[44:47], a[216:219], v[136:139]
    v_mfma_f32_16x16x32_bf16 v[140:143], v[32:35], a[196:199], v[140:143]
    v_mfma_f32_16x16x32_bf16 v[140:143], v[36:39], a[204:207], v[140:143]
    v_mfma_f32_16x16x32_bf16 v[140:143], v[40:43], a[212:215], v[140:143]
    v_mfma_f32_16x16x32_bf16 v[140:143], v[44:47], a[220:223], v[140:143]
    s_waitcnt lgkmcnt(0)
    s_barrier
    v_mfma_f32_16x16x32_bf16 v[144:147], v[48:51], a[64:67], v[144:147]
    s_lshr_b32 s91, s62, 8
    ds_read_b64_tr_b16 v[32:33], v8 offset:49152
    ds_read_b128 v[96:99], v220 offset:0
    v_mfma_f32_16x16x32_bf16 v[144:147], v[52:55], a[72:75], v[144:147]
    s_and_b32 s91, s91, 3
    ds_read_b64_tr_b16 v[34:35], v8 offset:49664
    ds_read_b128 v[100:103], v220 offset:1024
    v_mfma_f32_16x16x32_bf16 v[144:147], v[56:59], a[80:83], v[144:147]
    s_xor_b32 s91, s91, s3
    ds_read_b64_tr_b16 v[36:37], v8 offset:53248
    ds_read_b128 v[104:107], v220 offset:8192
    v_mfma_f32_16x16x32_bf16 v[144:147], v[60:63], a[88:91], v[144:147]
    s_lshl_b32 s68, s91, 10
    ds_read_b64_tr_b16 v[38:39], v8 offset:53760
    ds_read_b128 v[108:111], v220 offset:9216
    v_mfma_f32_16x16x32_bf16 v[148:151], v[48:51], a[68:71], v[148:151]
    s_lshr_b32 s67, s0, 17
    ds_read_b64_tr_b16 v[40:41], v8 offset:57344
    ds_read_b64_tr_b16 v[224:225], v218 offset:0
    v_mfma_f32_16x16x32_bf16 v[148:151], v[52:55], a[76:79], v[148:151]
    s_lshl_b32 s67, s67, 14
    ds_read_b64_tr_b16 v[42:43], v8 offset:57856
    ds_read_b64_tr_b16 v[226:227], v218 offset:2048
    v_mfma_f32_16x16x32_bf16 v[148:151], v[56:59], a[84:87], v[148:151]
    s_lshr_b32 s65, s6, 17
    ds_read_b64_tr_b16 v[44:45], v8 offset:61440
    ds_read_b64_tr_b16 v[228:229], v218 offset:16384
    v_mfma_f32_16x16x32_bf16 v[148:151], v[60:63], a[92:95], v[148:151]
    s_lshl_b32 s65, s65, 14
    ds_read_b64_tr_b16 v[46:47], v8 offset:61952
    ds_read_b64_tr_b16 v[230:231], v218 offset:18432
    v_mfma_f32_16x16x32_bf16 v[152:155], v[48:51], a[192:195], v[152:155]
    s_add_u32 m0, s56, 32768
    ds_read_b64_tr_b16 v[232:233], v218 offset:8192
    ds_read_b64_tr_b16 v[234:235], v218 offset:10240
    v_mfma_f32_16x16x32_bf16 v[152:155], v[52:55], a[200:203], v[152:155]
    s_add_u32 s59, s87, s58
    ds_read_b64_tr_b16 v[236:237], v218 offset:24576
    ds_read_b64_tr_b16 v[238:239], v218 offset:26624
    v_mfma_f32_16x16x32_bf16 v[152:155], v[56:59], a[208:211], v[152:155]
    s_add_u32 s59, s59, 3072
    buffer_load_dwordx4 v14, s[16:19], s59 offen lds
    ds_read_b64_tr_b16 v[240:241], v219 offset:0
    v_mfma_f32_16x16x32_bf16 v[152:155], v[60:63], a[216:219], v[152:155]
    s_lshr_b32 s66, s7, 17
    ds_read_b64_tr_b16 v[242:243], v219 offset:2048
    ds_read_b64_tr_b16 v[244:245], v219 offset:16384
    s_waitcnt lgkmcnt(11)
    v_mfma_f32_16x16x32_bf16 v[112:115], v[224:227], v[96:99], 0
    s_lshl_b32 s66, s66, 14
    ds_read_b64_tr_b16 v[246:247], v219 offset:18432
    ds_read_b64_tr_b16 v[248:249], v219 offset:8192
    v_mfma_f32_16x16x32_bf16 v[120:123], v[20:23], v[224:227], 0
    s_lshl_b32 s90, s63, 8
    ds_read_b64_tr_b16 v[250:251], v219 offset:10240
    ds_read_b64_tr_b16 v[252:253], v219 offset:24576
    s_waitcnt lgkmcnt(11)
    v_mfma_f32_16x16x32_bf16 v[112:115], v[228:231], v[100:103], v[112:115]
    s_add_u32 s90, s90, s62
    ds_read_b64_tr_b16 v[254:255], v219 offset:26624
    v_mov_b32 v13, 1
    s_waitcnt lgkmcnt(10)
    v_mfma_f32_16x16x32_bf16 v[112:115], v[232:235], v[104:107], v[112:115]
    s_add_u32 s91, s63, s91
    v_lshrrev_b32 v28, 2, v1
    v_lshlrev_b32 v28, 7, v28
    s_waitcnt lgkmcnt(8)
    v_mfma_f32_16x16x32_bf16 v[112:115], v[236:239], v[108:111], v[112:115]
    s_lshl_b32 s91, s91, 14
    v_and_b32_e64 v29, 3, v1
    v_lshl_add_u32 v28, v29, 3, v28
    v_mfma_f32_16x16x32_bf16 v[120:123], v[20:23], v[228:231], v[120:123]
    s_add_u32 s91, s91, s62
    v_bfe_u32 v29, v1, 3, 2
    v_lshl_add_u32 v28, v29, 5, v28
    v_mfma_f32_16x16x32_bf16 v[120:123], v[20:23], v[232:235], v[120:123]
    v_add_u32 v4, s68, v2
    v_xor_b32 v6, 1024, v4
    v_mfma_f32_16x16x32_bf16 v[120:123], v[20:23], v[236:239], v[120:123]
    s_lshr_b32 s68, s63, 2
    v_cvt_pk_bf16_f32 v112, v112, v113
    v_cvt_pk_bf16_f32 v113, v114, v115
    s_waitcnt lgkmcnt(3)
    v_mfma_f32_16x16x32_bf16 v[116:119], v[240:243], v[96:99], 0
    s_mul_i32 s68, s68, 294912
    v_xor_b32 v7, 2048, v4
    v_xor_b32 v12, 3072, v4
    v_mfma_f32_16x16x32_bf16 v[116:119], v[244:247], v[100:103], v[116:119]
    s_add_u32 s64, s68, s56
    s_waitcnt lgkmcnt(1)
    v_mfma_f32_16x16x32_bf16 v[116:119], v[248:251], v[104:107], v[116:119]
    s_add_u32 s68, s68, 229376
    s_waitcnt lgkmcnt(0)
    v_mfma_f32_16x16x32_bf16 v[116:119], v[252:255], v[108:111], v[116:119]
    v_mfma_f32_16x16x32_bf16 v[124:127], v[20:23], v[240:243], 0
    v_mfma_f32_16x16x32_bf16 v[124:127], v[20:23], v[244:247], v[124:127]
    v_mfma_f32_16x16x32_bf16 v[124:127], v[20:23], v[248:251], v[124:127]
    s_nop 4
    v_cvt_pk_bf16_f32 v114, v116, v117
    v_cvt_pk_bf16_f32 v115, v118, v119
    v_mfma_f32_16x16x32_bf16 v[124:127], v[20:23], v[252:255], v[124:127]
    buffer_store_dwordx4 v[112:115], v2, s[48:51], s80 offen sc1
    v_mfma_f32_16x16x32_bf16 v[156:159], v[48:51], a[196:199], v[156:159]
    buffer_load_dwordx4 v15, s[16:19], s59 offen offset:1024 lds
    v_mfma_f32_16x16x32_bf16 v[156:159], v[52:55], a[204:207], v[156:159]
    v_add_u32_e64 v20, s56, v28
    v_add_u32 v28, 98304, v28
    v_mfma_f32_16x16x32_bf16 v[156:159], v[56:59], a[212:215], v[156:159]
    s_nop 0
    v_cndmask_b32 v120, v120, v124, s[78:79]
    v_xor_b32 v21, 32, v20
    v_mfma_f32_16x16x32_bf16 v[156:159], v[60:63], a[220:223], v[156:159]
    buffer_store_dword v120, v222, s[48:51], s81 offen sc1
    v_mfma_f32_16x16x32_bf16 v[160:163], v[32:35], a[64:67], v[160:163]
    ds_read_b64_tr_b16 v[48:49], v10 offset:49152
    v_xor_b32_e64 v29, 32, v28
    v_mfma_f32_16x16x32_bf16 v[160:163], v[36:39], a[72:75], v[160:163]
    ds_read_b64_tr_b16 v[50:51], v10 offset:49664
    v_xor_b32_e64 v22, 64, v20
    v_mfma_f32_16x16x32_bf16 v[160:163], v[40:43], a[80:83], v[160:163]
    ds_read_b64_tr_b16 v[52:53], v10 offset:53248
    v_xor_b32_e64 v30, 64, v28
    v_mfma_f32_16x16x32_bf16 v[160:163], v[44:47], a[88:91], v[160:163]
    ds_read_b64_tr_b16 v[54:55], v10 offset:53760
    v_xor_b32 v23, 96, v20
    v_mfma_f32_16x16x32_bf16 v[164:167], v[32:35], a[68:71], v[164:167]
    ds_read_b64_tr_b16 v[56:57], v10 offset:57344
    v_xor_b32 v31, 96, v28
    v_mfma_f32_16x16x32_bf16 v[164:167], v[36:39], a[76:79], v[164:167]
    ds_read_b64_tr_b16 v[58:59], v10 offset:57856
    v_add_u32 v24, 0x10000, v20
    v_mfma_f32_16x16x32_bf16 v[164:167], v[40:43], a[84:87], v[164:167]
    ds_read_b64_tr_b16 v[60:61], v10 offset:61440
    v_add_u32 v25, 0x10000, v21
    v_mfma_f32_16x16x32_bf16 v[164:167], v[44:47], a[92:95], v[164:167]
    ds_read_b64_tr_b16 v[62:63], v10 offset:61952
    v_add_u32 v26, 0x10000, v22
    v_mfma_f32_16x16x32_bf16 v[168:171], v[32:35], a[192:195], v[168:171]
    s_add_u32 m0, s56, 34816
    v_add_u32 v27, 0x10000, v23
    v_mfma_f32_16x16x32_bf16 v[168:171], v[36:39], a[200:203], v[168:171]
    s_add_u32 s59, s87, s58
    v_mfma_f32_16x16x32_bf16 v[168:171], v[40:43], a[208:211], v[168:171]
    s_add_u32 s59, s59, 60416
    buffer_load_dwordx4 v14, s[16:19], s59 offen lds
    v_mfma_f32_16x16x32_bf16 v[168:171], v[44:47], a[216:219], v[168:171]
    v_mfma_f32_16x16x32_bf16 v[172:175], v[32:35], a[196:199], v[172:175]
    buffer_load_dwordx4 v15, s[16:19], s59 offen offset:1024 lds
    v_mfma_f32_16x16x32_bf16 v[172:175], v[36:39], a[204:207], v[172:175]
    v_mfma_f32_16x16x32_bf16 v[172:175], v[40:43], a[212:215], v[172:175]
    v_mfma_f32_16x16x32_bf16 v[172:175], v[44:47], a[220:223], v[172:175]
    s_waitcnt vmcnt(18) lgkmcnt(0)
    s_barrier
    v_mfma_f32_16x16x32_bf16 v[176:179], v[48:51], a[64:67], v[176:179]
    ds_read_b64_tr_b16 v[32:33], v9 offset:0
    v_mfma_f32_16x16x32_bf16 v[176:179], v[52:55], a[72:75], v[176:179]
    ds_read_b64_tr_b16 v[34:35], v9 offset:512
    v_mfma_f32_16x16x32_bf16 v[176:179], v[56:59], a[80:83], v[176:179]
    ds_read_b64_tr_b16 v[36:37], v9 offset:4096
    v_mfma_f32_16x16x32_bf16 v[176:179], v[60:63], a[88:91], v[176:179]
    ds_read_b64_tr_b16 v[38:39], v9 offset:4608
    v_mfma_f32_16x16x32_bf16 v[180:183], v[48:51], a[68:71], v[180:183]
    ds_read_b64_tr_b16 v[40:41], v9 offset:8192
    v_mfma_f32_16x16x32_bf16 v[180:183], v[52:55], a[76:79], v[180:183]
    ds_read_b64_tr_b16 v[42:43], v9 offset:8704
    v_mfma_f32_16x16x32_bf16 v[180:183], v[56:59], a[84:87], v[180:183]
    s_add_u32 m0, s56, 49152
    ds_read_b64_tr_b16 v[44:45], v9 offset:12288
    v_mfma_f32_16x16x32_bf16 v[180:183], v[60:63], a[92:95], v[180:183]
    s_add_u32 s59, s87, s58
    ds_read_b64_tr_b16 v[46:47], v9 offset:12800
    v_mfma_f32_16x16x32_bf16 v[184:187], v[48:51], a[192:195], v[184:187]
    s_add_u32 s59, s59, 3072
    buffer_load_dwordx4 v14, s[20:23], s59 offen lds
    v_mfma_f32_16x16x32_bf16 v[184:187], v[52:55], a[200:203], v[184:187]
    v_mfma_f32_16x16x32_bf16 v[184:187], v[56:59], a[208:211], v[184:187]
    buffer_load_dwordx4 v15, s[20:23], s59 offen offset:1024 lds
    v_mfma_f32_16x16x32_bf16 v[184:187], v[60:63], a[216:219], v[184:187]
    s_add_u32 m0, s56, 98304
    v_mfma_f32_16x16x32_bf16 v[188:191], v[48:51], a[196:199], v[188:191]
    s_xor_b32 s59, s0, 0
    buffer_load_dwordx4 v16, s[24:27], s59 offen lds
    v_mfma_f32_16x16x32_bf16 v[188:191], v[52:55], a[204:207], v[188:191]
    v_mfma_f32_16x16x32_bf16 v[188:191], v[56:59], a[212:215], v[188:191]
    buffer_load_dwordx4 v19, s[24:27], s59 offen offset:1024 lds
    v_mfma_f32_16x16x32_bf16 v[188:191], v[60:63], a[220:223], v[188:191]
    s_waitcnt vmcnt(6)
    s_barrier
    buffer_store_dword v13, v5, s[48:51], s82 offen sc1
    s_waitcnt lgkmcnt(0)
    v_mfma_f32_16x16x32_bf16 v[128:131], v[32:35], a[96:99], v[128:131]
    ds_read_b64_tr_b16 v[48:49], v11 offset:0
    v_mfma_f32_16x16x32_bf16 v[128:131], v[36:39], a[104:107], v[128:131]
    ds_read_b64_tr_b16 v[50:51], v11 offset:512
    v_mfma_f32_16x16x32_bf16 v[128:131], v[40:43], a[112:115], v[128:131]
    ds_read_b64_tr_b16 v[52:53], v11 offset:4096
    v_mfma_f32_16x16x32_bf16 v[128:131], v[44:47], a[120:123], v[128:131]
    ds_read_b64_tr_b16 v[54:55], v11 offset:4608
    v_mfma_f32_16x16x32_bf16 v[132:135], v[32:35], a[100:103], v[132:135]
    ds_read_b64_tr_b16 v[56:57], v11 offset:8192
    v_mfma_f32_16x16x32_bf16 v[132:135], v[36:39], a[108:111], v[132:135]
    ds_read_b64_tr_b16 v[58:59], v11 offset:8704
    v_mfma_f32_16x16x32_bf16 v[132:135], v[40:43], a[116:119], v[132:135]
    s_add_u32 m0, s56, 51200
    ds_read_b64_tr_b16 v[60:61], v11 offset:12288
    v_mfma_f32_16x16x32_bf16 v[132:135], v[44:47], a[124:127], v[132:135]
    s_add_u32 s59, s87, s58
    ds_read_b64_tr_b16 v[62:63], v11 offset:12800
    v_mfma_f32_16x16x32_bf16 v[136:139], v[32:35], a[224:227], v[136:139]
    s_add_u32 s59, s59, 60416
    buffer_load_dwordx4 v14, s[20:23], s59 offen lds
    v_mfma_f32_16x16x32_bf16 v[136:139], v[36:39], a[232:235], v[136:139]
    v_mfma_f32_16x16x32_bf16 v[136:139], v[40:43], a[240:243], v[136:139]
    buffer_load_dwordx4 v15, s[20:23], s59 offen offset:1024 lds
    v_mfma_f32_16x16x32_bf16 v[136:139], v[44:47], a[248:251], v[136:139]
    s_add_u32 m0, s56, 100352
    v_mfma_f32_16x16x32_bf16 v[140:143], v[32:35], a[228:231], v[140:143]
    s_xor_b32 s59, s0, 16384
    buffer_load_dwordx4 v16, s[24:27], s59 offen lds
    v_mfma_f32_16x16x32_bf16 v[140:143], v[36:39], a[236:239], v[140:143]
    v_mfma_f32_16x16x32_bf16 v[140:143], v[40:43], a[244:247], v[140:143]
    buffer_load_dwordx4 v19, s[24:27], s59 offen offset:1024 lds
    v_mfma_f32_16x16x32_bf16 v[140:143], v[44:47], a[252:255], v[140:143]
    s_waitcnt lgkmcnt(0)
    s_barrier
    v_mfma_f32_16x16x32_bf16 v[144:147], v[48:51], a[96:99], v[144:147]
    ds_read_b64_tr_b16 v[32:33], v9 offset:16384
    v_mfma_f32_16x16x32_bf16 v[144:147], v[52:55], a[104:107], v[144:147]
    ds_read_b64_tr_b16 v[34:35], v9 offset:16896
    v_mfma_f32_16x16x32_bf16 v[144:147], v[56:59], a[112:115], v[144:147]
    ds_read_b64_tr_b16 v[36:37], v9 offset:20480
    v_mfma_f32_16x16x32_bf16 v[144:147], v[60:63], a[120:123], v[144:147]
    ds_read_b64_tr_b16 v[38:39], v9 offset:20992
    v_mfma_f32_16x16x32_bf16 v[148:151], v[48:51], a[100:103], v[148:151]
    ds_read_b64_tr_b16 v[40:41], v9 offset:24576
    v_mfma_f32_16x16x32_bf16 v[148:151], v[52:55], a[108:111], v[148:151]
    ds_read_b64_tr_b16 v[42:43], v9 offset:25088
    v_mfma_f32_16x16x32_bf16 v[148:151], v[56:59], a[116:119], v[148:151]
    s_add_u32 m0, s56, 65536
    ds_read_b64_tr_b16 v[44:45], v9 offset:28672
    v_mfma_f32_16x16x32_bf16 v[148:151], v[60:63], a[124:127], v[148:151]
    s_add_u32 s59, s88, s58
    ds_read_b64_tr_b16 v[46:47], v9 offset:29184
    v_mfma_f32_16x16x32_bf16 v[152:155], v[48:51], a[224:227], v[152:155]
    s_add_u32 s59, s59, 3072
    buffer_load_dwordx4 v14, s[16:19], s59 offen lds
    v_mfma_f32_16x16x32_bf16 v[152:155], v[52:55], a[232:235], v[152:155]
    v_mfma_f32_16x16x32_bf16 v[152:155], v[56:59], a[240:243], v[152:155]
    buffer_load_dwordx4 v15, s[16:19], s59 offen offset:1024 lds
    v_mfma_f32_16x16x32_bf16 v[152:155], v[60:63], a[248:251], v[152:155]
    s_add_u32 m0, s56, 114688
    v_mfma_f32_16x16x32_bf16 v[156:159], v[48:51], a[228:231], v[156:159]
    s_xor_b32 s59, s0, 131072
    buffer_load_dwordx4 v16, s[24:27], s59 offen lds
    v_mfma_f32_16x16x32_bf16 v[156:159], v[52:55], a[236:239], v[156:159]
    v_mfma_f32_16x16x32_bf16 v[156:159], v[56:59], a[244:247], v[156:159]
    buffer_load_dwordx4 v19, s[24:27], s59 offen offset:1024 lds
    v_mfma_f32_16x16x32_bf16 v[156:159], v[60:63], a[252:255], v[156:159]
    s_waitcnt lgkmcnt(0)
    v_mfma_f32_16x16x32_bf16 v[160:163], v[32:35], a[96:99], v[160:163]
    ds_read_b64_tr_b16 v[48:49], v11 offset:16384
    v_mfma_f32_16x16x32_bf16 v[160:163], v[36:39], a[104:107], v[160:163]
    ds_read_b64_tr_b16 v[50:51], v11 offset:16896
    v_mfma_f32_16x16x32_bf16 v[160:163], v[40:43], a[112:115], v[160:163]
    ds_read_b64_tr_b16 v[52:53], v11 offset:20480
    v_mfma_f32_16x16x32_bf16 v[160:163], v[44:47], a[120:123], v[160:163]
    ds_read_b64_tr_b16 v[54:55], v11 offset:20992
    v_mfma_f32_16x16x32_bf16 v[164:167], v[32:35], a[100:103], v[164:167]
    ds_read_b64_tr_b16 v[56:57], v11 offset:24576
    v_mfma_f32_16x16x32_bf16 v[164:167], v[36:39], a[108:111], v[164:167]
    ds_read_b64_tr_b16 v[58:59], v11 offset:25088
    v_mfma_f32_16x16x32_bf16 v[164:167], v[40:43], a[116:119], v[164:167]
    s_add_u32 m0, s56, 67584
    ds_read_b64_tr_b16 v[60:61], v11 offset:28672
    v_mfma_f32_16x16x32_bf16 v[164:167], v[44:47], a[124:127], v[164:167]
    s_add_u32 s59, s88, s58
    ds_read_b64_tr_b16 v[62:63], v11 offset:29184
    v_mfma_f32_16x16x32_bf16 v[168:171], v[32:35], a[224:227], v[168:171]
    s_add_u32 s59, s59, 60416
    buffer_load_dwordx4 v14, s[16:19], s59 offen lds
    v_mfma_f32_16x16x32_bf16 v[168:171], v[36:39], a[232:235], v[168:171]
    v_mfma_f32_16x16x32_bf16 v[168:171], v[40:43], a[240:243], v[168:171]
    buffer_load_dwordx4 v15, s[16:19], s59 offen offset:1024 lds
    v_mfma_f32_16x16x32_bf16 v[168:171], v[44:47], a[248:251], v[168:171]
    s_add_u32 m0, s56, 116736
    v_mfma_f32_16x16x32_bf16 v[172:175], v[32:35], a[228:231], v[172:175]
    s_xor_b32 s59, s0, 147456
    buffer_load_dwordx4 v16, s[24:27], s59 offen lds
    v_mfma_f32_16x16x32_bf16 v[172:175], v[36:39], a[236:239], v[172:175]
    v_mfma_f32_16x16x32_bf16 v[172:175], v[40:43], a[244:247], v[172:175]
    buffer_load_dwordx4 v19, s[24:27], s59 offen offset:1024 lds
    v_mfma_f32_16x16x32_bf16 v[172:175], v[44:47], a[252:255], v[172:175]
    s_waitcnt lgkmcnt(0)
    s_barrier
    v_mfma_f32_16x16x32_bf16 v[176:179], v[48:51], a[96:99], v[176:179]
    ds_read_b64_tr_b16 v[32:33], v8 offset:0
    v_mfma_f32_16x16x32_bf16 v[176:179], v[52:55], a[104:107], v[176:179]
    ds_read_b64_tr_b16 v[34:35], v8 offset:512
    v_mfma_f32_16x16x32_bf16 v[176:179], v[56:59], a[112:115], v[176:179]
    ds_read_b64_tr_b16 v[36:37], v8 offset:4096
    v_mfma_f32_16x16x32_bf16 v[176:179], v[60:63], a[120:123], v[176:179]
    ds_read_b64_tr_b16 v[38:39], v8 offset:4608
    v_mfma_f32_16x16x32_bf16 v[180:183], v[48:51], a[100:103], v[180:183]
    ds_read_b64_tr_b16 v[40:41], v8 offset:8192
    v_mfma_f32_16x16x32_bf16 v[180:183], v[52:55], a[108:111], v[180:183]
    ds_read_b64_tr_b16 v[42:43], v8 offset:8704
    v_mfma_f32_16x16x32_bf16 v[180:183], v[56:59], a[116:119], v[180:183]
    s_add_u32 m0, s56, 81920
    ds_read_b64_tr_b16 v[44:45], v8 offset:12288
    v_mfma_f32_16x16x32_bf16 v[180:183], v[60:63], a[124:127], v[180:183]
    s_add_u32 s59, s88, s58
    ds_read_b64_tr_b16 v[46:47], v8 offset:12800
    v_mfma_f32_16x16x32_bf16 v[184:187], v[48:51], a[224:227], v[184:187]
    s_add_u32 s59, s59, 3072
    buffer_load_dwordx4 v14, s[20:23], s59 offen lds
    v_mfma_f32_16x16x32_bf16 v[184:187], v[52:55], a[232:235], v[184:187]
    v_mfma_f32_16x16x32_bf16 v[184:187], v[56:59], a[240:243], v[184:187]
    buffer_load_dwordx4 v15, s[20:23], s59 offen offset:1024 lds
    v_mfma_f32_16x16x32_bf16 v[184:187], v[60:63], a[248:251], v[184:187]
    s_add_u32 m0, s56, 131072
    v_mfma_f32_16x16x32_bf16 v[188:191], v[48:51], a[228:231], v[188:191]
    s_xor_b32 s59, s6, 262144
    buffer_load_dwordx4 v16, s[28:31], s59 offen lds
    v_mfma_f32_16x16x32_bf16 v[188:191], v[52:55], a[236:239], v[188:191]
    v_mfma_f32_16x16x32_bf16 v[188:191], v[56:59], a[244:247], v[188:191]
    buffer_load_dwordx4 v19, s[28:31], s59 offen offset:1024 lds
    v_mfma_f32_16x16x32_bf16 v[188:191], v[60:63], a[252:255], v[188:191]
    s_nop 0
    ds_read_b64_tr_b16 v[48:49], v10 offset:0
    ds_read_b64_tr_b16 v[50:51], v10 offset:512
    ds_read_b64_tr_b16 v[52:53], v10 offset:4096
    ds_read_b64_tr_b16 v[54:55], v10 offset:4608
    ds_read_b64_tr_b16 v[56:57], v10 offset:8192
    ds_read_b64_tr_b16 v[58:59], v10 offset:8704
    ds_read_b64_tr_b16 v[60:61], v10 offset:12288
    ds_read_b64_tr_b16 v[62:63], v10 offset:12800
    s_barrier
    s_waitcnt lgkmcnt(8)
    v_mfma_f32_16x16x32_bf16 v[64:67], v[32:35], a[0:3], 0
    s_waitcnt vmcnt(4)
    s_add_u32 m0, s56, 83968
    ds_read_b64_tr_b16 v[96:97], v8 offset:16384
    ds_read_b64_tr_b16 v[98:99], v8 offset:16896
    v_mfma_f32_16x16x32_bf16 v[64:67], v[36:39], a[8:11], v[64:67]
    s_add_u32 s59, s88, s58
    ds_read_b64_tr_b16 v[100:101], v8 offset:20480
    ds_read_b64_tr_b16 v[102:103], v8 offset:20992
    v_mfma_f32_16x16x32_bf16 v[64:67], v[40:43], a[16:19], v[64:67]
    s_add_u32 s59, s59, 60416
    buffer_load_dwordx4 v14, s[20:23], s59 offen lds
    ds_read_b64_tr_b16 v[104:105], v8 offset:24576
    v_mfma_f32_16x16x32_bf16 v[64:67], v[44:47], a[24:27], v[64:67]
    s_lshl_b32 s75, s57, 6
    ds_read_b64_tr_b16 v[106:107], v8 offset:25088
    ds_read_b64_tr_b16 v[108:109], v8 offset:28672
    v_mul_f32 v160, v128, v160
    v_mul_f32 v161, v129, v161
    v_mul_f32 v162, v130, v162
    v_mul_f32_e64 v163, v131, v163
    v_mfma_f32_16x16x32_bf16 v[68:71], v[32:35], a[4:7], 0
    s_add_u32 s75, s75, 65536
    buffer_load_dwordx4 v15, s[20:23], s59 offen offset:1024 lds
    ds_read_b64_tr_b16 v[110:111], v8 offset:29184
    v_mul_f32 v176, v144, v176
    v_mul_f32 v177, v145, v177
    v_mul_f32_e64 v178, v146, v178
    v_mfma_f32_16x16x32_bf16 v[68:71], v[36:39], a[12:15], v[68:71]
    ds_read_b64_tr_b16 v[112:113], v10 offset:16384
    ds_read_b64_tr_b16 v[114:115], v10 offset:16896
    v_mul_f32 v179, v147, v179
    v_mul_f32 v164, v132, v164
    v_mul_f32 v165, v133, v165
    v_mul_f32 v166, v134, v166
    v_mfma_f32_16x16x32_bf16 v[68:71], v[40:43], a[20:23], v[68:71]
    s_add_u32 m0, s56, 133120
    ds_read_b64_tr_b16 v[116:117], v10 offset:20480
    ds_read_b64_tr_b16 v[118:119], v10 offset:20992
    v_mul_f32 v167, v135, v167
    v_mul_f32 v180, v148, v180
    v_mul_f32 v181, v149, v181
    v_mul_f32 v182, v150, v182
    v_mfma_f32_16x16x32_bf16 v[68:71], v[44:47], a[28:31], v[68:71]
    s_xor_b32 s59, s6, 278528
    buffer_load_dwordx4 v16, s[28:31], s59 offen lds
    ds_read_b64_tr_b16 v[120:121], v10 offset:24576
    v_mul_f32 v183, v151, v183
    v_mul_f32 v168, v136, v168
    v_mul_f32 v169, v137, v169
    s_waitcnt lgkmcnt(6)
    v_mfma_f32_16x16x32_bf16 v[72:75], v[48:51], a[0:3], 0
    ds_read_b64_tr_b16 v[122:123], v10 offset:25088
    ds_read_b64_tr_b16 v[124:125], v10 offset:28672
    v_mul_f32 v170, v138, v170
    v_mul_f32 v171, v139, v171
    v_mul_f32 v184, v152, v184
    v_mul_f32 v185, v153, v185
    v_mfma_f32_16x16x32_bf16 v[72:75], v[52:55], a[8:11], v[72:75]
    buffer_load_dwordx4 v19, s[28:31], s59 offen offset:1024 lds
    ds_read_b64_tr_b16 v[126:127], v10 offset:29184
    v_mul_f32 v186, v154, v186
    v_mul_f32 v187, v155, v187
    v_mul_f32_e64 v172, v140, v172
    v_mfma_f32_16x16x32_bf16 v[72:75], v[56:59], a[16:19], v[72:75]
    ds_read_b64_tr_b16 a[128:129], v24 offset:32768
    v_mul_f32 v173, v141, v173
    v_mul_f32 v174, v142, v174
    v_mul_f32 v175, v143, v175
    v_mul_f32 v188, v156, v188
    v_mul_f32_e64 v189, v157, v189
    v_mfma_f32_16x16x32_bf16 v[72:75], v[60:63], a[24:27], v[72:75]
    ds_read_b64_tr_b16 a[130:131], v24 offset:34816
    v_mul_f32 v190, v158, v190
    v_mul_f32 v191, v159, v191
    v_cvt_pk_bf16_f32 v160, v160, v161
    v_cvt_pk_bf16_f32 v161, v162, v163
    v_cvt_pk_bf16_f32 v162, v176, v177
    v_mfma_f32_16x16x32_bf16 v[76:79], v[48:51], a[4:7], 0
    ds_read_b64_tr_b16 a[132:133], v25 offset:32768
    v_cvt_pk_bf16_f32 v163, v178, v179
    v_cvt_pk_bf16_f32 v164, v164, v165
    v_cvt_pk_bf16_f32 v165, v166, v167
    v_cvt_pk_bf16_f32 v166, v180, v181
    v_cvt_pk_bf16_f32 v167, v182, v183
    v_mfma_f32_16x16x32_bf16 v[76:79], v[52:55], a[12:15], v[76:79]
    s_add_u32 s60, s75, s70
    buffer_store_dwordx4 v[160:163], v18, s[44:47], s60 offen sc1
    v_cvt_pk_bf16_f32 v168, v168, v169
    v_cvt_pk_bf16_f32 v169, v170, v171
    v_cvt_pk_bf16_f32 v170, v184, v185
    v_cvt_pk_bf16_f32 v171, v186, v187
    v_mfma_f32_16x16x32_bf16 v[76:79], v[56:59], a[20:23], v[76:79]
    v_cvt_pk_bf16_f32 v172, v172, v173
    v_cvt_pk_bf16_f32 v173, v174, v175
    v_cvt_pk_bf16_f32 v174, v188, v189
    v_cvt_pk_bf16_f32 v175, v190, v191
    v_mfma_f32_16x16x32_bf16 v[76:79], v[60:63], a[28:31], v[76:79]
    s_barrier
    buffer_load_dword v17, v3, s[48:51], s90 offen sc1
    v_mfma_f32_16x16x32_bf16 v[80:83], v[96:99], a[0:3], 0
    s_add_u32 m0, s56, 0
    ds_read_b64_tr_b16 v[32:33], v8 offset:32768
    ds_read_b64_tr_b16 v[34:35], v8 offset:33280
    v_mfma_f32_16x16x32_bf16 v[80:83], v[100:103], a[8:11], v[80:83]
    s_add_u32 s59, s89, s58
    ds_read_b64_tr_b16 v[36:37], v8 offset:36864
    ds_read_b64_tr_b16 v[38:39], v8 offset:37376
    v_mfma_f32_16x16x32_bf16 v[80:83], v[104:107], a[16:19], v[80:83]
    s_add_u32 s59, s59, 3072
    buffer_load_dwordx4 v14, s[16:19], s59 offen lds
    ds_read_b64_tr_b16 v[40:41], v8 offset:40960
    s_waitcnt lgkmcnt(5)
    v_mfma_f32_16x16x32_bf16 v[80:83], v[108:111], a[24:27], v[80:83]
    ds_read_b64_tr_b16 v[42:43], v8 offset:41472
    ds_read_b64_tr_b16 v[44:45], v8 offset:45056
    v_mfma_f32_16x16x32_bf16 v[84:87], v[96:99], a[4:7], 0
    buffer_load_dwordx4 v15, s[16:19], s59 offen offset:1024 lds
    ds_read_b64_tr_b16 v[46:47], v8 offset:45568
    v_mfma_f32_16x16x32_bf16 v[84:87], v[100:103], a[12:15], v[84:87]
    s_add_u32 m0, s56, 2048
    ds_read_b64_tr_b16 v[48:49], v10 offset:32768
    ds_read_b64_tr_b16 v[50:51], v10 offset:33280
    v_mfma_f32_16x16x32_bf16 v[84:87], v[104:107], a[20:23], v[84:87]
    s_add_u32 s59, s89, s58
    ds_read_b64_tr_b16 v[52:53], v10 offset:36864
    ds_read_b64_tr_b16 v[54:55], v10 offset:37376
    v_mfma_f32_16x16x32_bf16 v[84:87], v[108:111], a[28:31], v[84:87]
    s_add_u32 s59, s59, 60416
    buffer_load_dwordx4 v14, s[16:19], s59 offen lds
    ds_read_b64_tr_b16 v[56:57], v10 offset:40960
    v_mfma_f32_16x16x32_bf16 v[88:91], v[112:115], a[0:3], 0
    ds_read_b64_tr_b16 v[58:59], v10 offset:41472
    ds_read_b64_tr_b16 v[60:61], v10 offset:45056
    v_mfma_f32_16x16x32_bf16 v[88:91], v[116:119], a[8:11], v[88:91]
    buffer_load_dwordx4 v15, s[16:19], s59 offen offset:1024 lds
    ds_read_b64_tr_b16 v[62:63], v10 offset:45568
    v_mfma_f32_16x16x32_bf16 v[88:91], v[120:123], a[16:19], v[88:91]
    s_add_u32 s60, s75, s71
    buffer_store_dwordx4 v[164:167], v18, s[44:47], s60 offen sc1
    v_mfma_f32_16x16x32_bf16 v[88:91], v[124:127], a[24:27], v[88:91]
    v_mfma_f32_16x16x32_bf16 v[92:95], v[112:115], a[4:7], 0
    v_mfma_f32_16x16x32_bf16 v[92:95], v[116:119], a[12:15], v[92:95]
    s_add_u32 s60, s75, s72
    buffer_store_dwordx4 v[168:171], v18, s[44:47], s60 offen sc1
    v_mfma_f32_16x16x32_bf16 v[92:95], v[120:123], a[20:23], v[92:95]
    v_mfma_f32_16x16x32_bf16 v[92:95], v[124:127], a[28:31], v[92:95]
    s_barrier
    s_waitcnt lgkmcnt(2)
    v_mfma_f32_16x16x32_bf16 v[64:67], v[32:35], a[32:35], v[64:67]
    s_add_u32 m0, s56, 16384
    ds_read_b64_tr_b16 v[96:97], v8 offset:49152
    ds_read_b64_tr_b16 v[98:99], v8 offset:49664
    v_mfma_f32_16x16x32_bf16 v[64:67], v[36:39], a[40:43], v[64:67]
    s_add_u32 s59, s89, s58
    ds_read_b64_tr_b16 v[100:101], v8 offset:53248
    ds_read_b64_tr_b16 v[102:103], v8 offset:53760
    v_mfma_f32_16x16x32_bf16 v[64:67], v[40:43], a[48:51], v[64:67]
    s_add_u32 s59, s59, 3072
    buffer_load_dwordx4 v14, s[20:23], s59 offen lds
    ds_read_b64_tr_b16 v[104:105], v8 offset:57344
    v_mfma_f32_16x16x32_bf16 v[64:67], v[44:47], a[56:59], v[64:67]
    ds_read_b64_tr_b16 v[106:107], v8 offset:57856
    ds_read_b64_tr_b16 v[108:109], v8 offset:61440
    v_mfma_f32_16x16x32_bf16 v[68:71], v[32:35], a[36:39], v[68:71]
    buffer_load_dwordx4 v15, s[20:23], s59 offen offset:1024 lds
    ds_read_b64_tr_b16 v[110:111], v8 offset:61952
    v_mfma_f32_16x16x32_bf16 v[68:71], v[36:39], a[44:47], v[68:71]
    s_add_u32 m0, s56, 18432
    ds_read_b64_tr_b16 v[112:113], v10 offset:49152
    ds_read_b64_tr_b16 v[114:115], v10 offset:49664
    v_mfma_f32_16x16x32_bf16 v[68:71], v[40:43], a[52:55], v[68:71]
    s_add_u32 s59, s89, s58
    ds_read_b64_tr_b16 v[116:117], v10 offset:53248
    ds_read_b64_tr_b16 v[118:119], v10 offset:53760
    v_mfma_f32_16x16x32_bf16 v[68:71], v[44:47], a[60:63], v[68:71]
    s_add_u32 s59, s59, 60416
    buffer_load_dwordx4 v14, s[20:23], s59 offen lds
    ds_read_b64_tr_b16 v[120:121], v10 offset:57344
    v_mfma_f32_16x16x32_bf16 v[72:75], v[48:51], a[32:35], v[72:75]
    ds_read_b64_tr_b16 v[122:123], v10 offset:57856
    ds_read_b64_tr_b16 v[124:125], v10 offset:61440
    v_mfma_f32_16x16x32_bf16 v[72:75], v[52:55], a[40:43], v[72:75]
    buffer_load_dwordx4 v15, s[20:23], s59 offen offset:1024 lds
    ds_read_b64_tr_b16 v[126:127], v10 offset:61952
    v_mfma_f32_16x16x32_bf16 v[72:75], v[56:59], a[48:51], v[72:75]
    s_add_u32 s60, s75, s73
    buffer_store_dwordx4 v[172:175], v18, s[44:47], s60 offen sc1
    s_waitcnt lgkmcnt(9)
    v_mfma_f32_16x16x32_bf16 v[72:75], v[60:63], a[56:59], v[72:75]
    v_mfma_f32_16x16x32_bf16 v[76:79], v[48:51], a[36:39], v[76:79]
    v_mfma_f32_16x16x32_bf16 v[76:79], v[52:55], a[44:47], v[76:79]
    ds_read_b64_tr_b16 a[134:135], v25 offset:34816
    v_mfma_f32_16x16x32_bf16 v[76:79], v[56:59], a[52:55], v[76:79]
    ds_read_b64_tr_b16 a[136:137], v26 offset:32768
    v_mfma_f32_16x16x32_bf16 v[76:79], v[60:63], a[60:63], v[76:79]
    s_barrier
    v_mfma_f32_16x16x32_bf16 v[80:83], v[96:99], a[32:35], v[80:83]
    ds_read_b64_tr_b16 v[32:33], v9 offset:0
    ds_read_b64_tr_b16 a[138:139], v26 offset:34816
    v_mfma_f32_16x16x32_bf16 v[80:83], v[100:103], a[40:43], v[80:83]
    ds_read_b64_tr_b16 v[34:35], v9 offset:512
    ds_read_b64_tr_b16 a[140:141], v27 offset:32768
    v_mfma_f32_16x16x32_bf16 v[80:83], v[104:107], a[48:51], v[80:83]
    s_waitcnt vmcnt(11)
    v_cmp_gt_u32 vcc, 1, v17
    s_nop 0
    s_and_b32 vcc_lo, vcc_lo, 0xff00
    s_cbranch_scc1 L_k_retry1
L_k_back1:
    s_xor_b32 s92, s67, 0
    s_add_u32 s92, s92, s64
    buffer_load_dwordx4 v[192:195], v6, s[44:47], s92 offen sc1
    ds_read_b64_tr_b16 v[36:37], v9 offset:4096
    s_waitcnt lgkmcnt(7)
    v_mfma_f32_16x16x32_bf16 v[80:83], v[108:111], a[56:59], v[80:83]
    s_xor_b32 s93, s67, 16384
    ds_read_b64_tr_b16 v[38:39], v9 offset:4608
    ds_read_b64_tr_b16 a[142:143], v27 offset:34816
    v_mfma_f32_16x16x32_bf16 v[84:87], v[96:99], a[36:39], v[84:87]
    s_add_u32 s93, s93, s64
    buffer_load_dwordx4 v[196:199], v6, s[44:47], s93 offen sc1
    ds_read_b64_tr_b16 v[40:41], v9 offset:8192
    v_mfma_f32_16x16x32_bf16 v[84:87], v[100:103], a[44:47], v[84:87]
    ds_read_b64_tr_b16 v[42:43], v9 offset:8704
    ds_read_b64_tr_b16 a[144:145], v24 offset:49152
    v_mfma_f32_16x16x32_bf16 v[84:87], v[104:107], a[52:55], v[84:87]
    ds_read_b64_tr_b16 v[44:45], v9 offset:12288
    ds_read_b64_tr_b16 a[146:147], v24 offset:51200
    v_mfma_f32_16x16x32_bf16 v[84:87], v[108:111], a[60:63], v[84:87]
    buffer_load_dwordx4 v[200:203], v7, s[44:47], s92 offen sc1
    ds_read_b64_tr_b16 v[46:47], v9 offset:12800
    v_mfma_f32_16x16x32_bf16 v[88:91], v[112:115], a[32:35], v[88:91]
    ds_read_b64_tr_b16 v[48:49], v11 offset:0
    ds_read_b64_tr_b16 a[148:149], v25 offset:49152
    v_mfma_f32_16x16x32_bf16 v[88:91], v[116:119], a[40:43], v[88:91]
    buffer_load_dwordx4 v[204:207], v7, s[44:47], s93 offen sc1
    ds_read_b64_tr_b16 v[50:51], v11 offset:512
    v_mfma_f32_16x16x32_bf16 v[88:91], v[120:123], a[48:51], v[88:91]
    ds_read_b64_tr_b16 v[52:53], v11 offset:4096
    ds_read_b64_tr_b16 a[150:151], v25 offset:51200
    v_mfma_f32_16x16x32_bf16 v[88:91], v[124:127], a[56:59], v[88:91]
    ds_read_b64_tr_b16 v[54:55], v11 offset:4608
    ds_read_b64_tr_b16 a[152:153], v26 offset:49152
    v_mfma_f32_16x16x32_bf16 v[92:95], v[112:115], a[36:39], v[92:95]
    buffer_load_dwordx4 v[208:211], v12, s[44:47], s92 offen sc1
    ds_read_b64_tr_b16 v[56:57], v11 offset:8192
    v_mfma_f32_16x16x32_bf16 v[92:95], v[116:119], a[44:47], v[92:95]
    ds_read_b64_tr_b16 v[58:59], v11 offset:8704
    ds_read_b64_tr_b16 a[154:155], v26 offset:51200
    v_mfma_f32_16x16x32_bf16 v[92:95], v[120:123], a[52:55], v[92:95]
    buffer_load_dwordx4 v[212:215], v12, s[44:47], s93 offen sc1
    ds_read_b64_tr_b16 v[60:61], v11 offset:12288
    v_mfma_f32_16x16x32_bf16 v[92:95], v[124:127], a[60:63], v[92:95]
    ds_read_b64_tr_b16 v[62:63], v11 offset:12800
    s_barrier
    s_waitcnt lgkmcnt(10)
    v_mfma_f32_16x16x32_bf16 v[64:67], v[32:35], a[64:67], v[64:67]
    ds_read_b64_tr_b16 v[96:97], v9 offset:16384
    ds_read_b64_tr_b16 a[156:157], v27 offset:49152
    v_mfma_f32_16x16x32_bf16 v[64:67], v[36:39], a[72:75], v[64:67]
    ds_read_b64_tr_b16 v[98:99], v9 offset:16896
    ds_read_b64_tr_b16 a[158:159], v27 offset:51200
    v_mfma_f32_16x16x32_bf16 v[64:67], v[40:43], a[80:83], v[64:67]
    buffer_load_dwordx4 v[216:219], v4, s[44:47], s92 offen sc1
    ds_read_b64_tr_b16 v[100:101], v9 offset:20480
    v_mfma_f32_16x16x32_bf16 v[64:67], v[44:47], a[88:91], v[64:67]
    ds_read_b64_tr_b16 v[102:103], v9 offset:20992
    v_mfma_f32_16x16x32_bf16 v[68:71], v[32:35], a[68:71], v[68:71]
    buffer_load_dwordx4 v[220:223], v4, s[44:47], s93 offen sc1
    ds_read_b64_tr_b16 v[104:105], v9 offset:24576
    v_mfma_f32_16x16x32_bf16 v[68:71], v[36:39], a[76:79], v[68:71]
    ds_read_b64_tr_b16 v[106:107], v9 offset:25088
    v_mfma_f32_16x16x32_bf16 v[68:71], v[40:43], a[84:87], v[68:71]
    s_xor_b32 s92, s67, 32768
    ds_read_b64_tr_b16 v[108:109], v9 offset:28672
    v_mfma_f32_16x16x32_bf16 v[68:71], v[44:47], a[92:95], v[68:71]
    s_add_u32 s92, s92, s64
    buffer_load_dwordx4 v[224:227], v6, s[44:47], s92 offen sc1
    ds_read_b64_tr_b16 v[110:111], v9 offset:29184
    s_waitcnt lgkmcnt(8)
    v_mfma_f32_16x16x32_bf16 v[72:75], v[48:51], a[64:67], v[72:75]
    s_xor_b32 s93, s67, 49152
    ds_read_b64_tr_b16 v[112:113], v11 offset:16384
    v_mfma_f32_16x16x32_bf16 v[72:75], v[52:55], a[72:75], v[72:75]
    s_add_u32 s93, s93, s64
    buffer_load_dwordx4 v[228:231], v6, s[44:47], s93 offen sc1
    ds_read_b64_tr_b16 v[114:115], v11 offset:16896
    v_mfma_f32_16x16x32_bf16 v[72:75], v[56:59], a[80:83], v[72:75]
    ds_read_b64_tr_b16 v[116:117], v11 offset:20480
    v_mfma_f32_16x16x32_bf16 v[72:75], v[60:63], a[88:91], v[72:75]
    ds_read_b64_tr_b16 v[118:119], v11 offset:20992
    v_mfma_f32_16x16x32_bf16 v[76:79], v[48:51], a[68:71], v[76:79]
    buffer_load_dwordx4 v[232:235], v7, s[44:47], s92 offen sc1
    ds_read_b64_tr_b16 v[120:121], v11 offset:24576
    v_mfma_f32_16x16x32_bf16 v[76:79], v[52:55], a[76:79], v[76:79]
    ds_read_b64_tr_b16 v[122:123], v11 offset:25088
    v_mfma_f32_16x16x32_bf16 v[76:79], v[56:59], a[84:87], v[76:79]
    buffer_load_dwordx4 v[236:239], v7, s[44:47], s93 offen sc1
    ds_read_b64_tr_b16 v[124:125], v11 offset:28672
    v_mfma_f32_16x16x32_bf16 v[76:79], v[60:63], a[92:95], v[76:79]
    s_waitcnt vmcnt(12)
    ds_read_b64_tr_b16 v[126:127], v11 offset:29184
    s_barrier
    buffer_store_dword v13, v5, s[48:51], s84 offen sc1
    s_waitcnt lgkmcnt(7)
    v_mfma_f32_16x16x32_bf16 v[80:83], v[96:99], a[64:67], v[80:83]
    ds_read_b64_tr_b16 v[32:33], v8 offset:0
    v_mfma_f32_16x16x32_bf16 v[80:83], v[100:103], a[72:75], v[80:83]
    s_add_u32 m0, s56, 32768
    ds_read_b64_tr_b16 v[34:35], v8 offset:512
    v_mfma_f32_16x16x32_bf16 v[80:83], v[104:107], a[80:83], v[80:83]
    s_xor_b32 s59, s0, 262144
    buffer_load_dwordx4 v16, s[24:27], s59 offen lds
    ds_read_b64_tr_b16 v[36:37], v8 offset:4096
    v_mfma_f32_16x16x32_bf16 v[80:83], v[108:111], a[88:91], v[80:83]
    ds_read_b64_tr_b16 v[38:39], v8 offset:4608
    v_mfma_f32_16x16x32_bf16 v[84:87], v[96:99], a[68:71], v[84:87]
    buffer_load_dwordx4 v19, s[24:27], s59 offen offset:1024 lds
    ds_read_b64_tr_b16 v[40:41], v8 offset:8192
    v_mfma_f32_16x16x32_bf16 v[84:87], v[100:103], a[76:79], v[84:87]
    ds_read_b64_tr_b16 v[42:43], v8 offset:8704
    v_mfma_f32_16x16x32_bf16 v[84:87], v[104:107], a[84:87], v[84:87]
    s_add_u32 m0, s56, 34816
    ds_read_b64_tr_b16 v[44:45], v8 offset:12288
    v_mfma_f32_16x16x32_bf16 v[84:87], v[108:111], a[92:95], v[84:87]
    s_xor_b32 s59, s0, 278528
    buffer_load_dwordx4 v16, s[24:27], s59 offen lds
    ds_read_b64_tr_b16 v[46:47], v8 offset:12800
    s_waitcnt lgkmcnt(7)
    v_mfma_f32_16x16x32_bf16 v[88:91], v[112:115], a[64:67], v[88:91]
    ds_read_b64_tr_b16 v[48:49], v10 offset:0
    v_mfma_f32_16x16x32_bf16 v[88:91], v[116:119], a[72:75], v[88:91]
    buffer_load_dwordx4 v19, s[24:27], s59 offen offset:1024 lds
    ds_read_b64_tr_b16 v[50:51], v10 offset:512
    v_mfma_f32_16x16x32_bf16 v[88:91], v[120:123], a[80:83], v[88:91]
    ds_read_b64_tr_b16 v[52:53], v10 offset:4096
    v_mfma_f32_16x16x32_bf16 v[88:91], v[124:127], a[88:91], v[88:91]
    s_add_u32 m0, s56, 49152
    ds_read_b64_tr_b16 v[54:55], v10 offset:4608
    v_mfma_f32_16x16x32_bf16 v[92:95], v[112:115], a[68:71], v[92:95]
    s_xor_b32 s59, s0, 393216
    buffer_load_dwordx4 v16, s[24:27], s59 offen lds
    ds_read_b64_tr_b16 v[56:57], v10 offset:8192
    v_mfma_f32_16x16x32_bf16 v[92:95], v[116:119], a[76:79], v[92:95]
    ds_read_b64_tr_b16 v[58:59], v10 offset:8704
    v_mfma_f32_16x16x32_bf16 v[92:95], v[120:123], a[84:87], v[92:95]
    buffer_load_dwordx4 v19, s[24:27], s59 offen offset:1024 lds
    ds_read_b64_tr_b16 v[60:61], v10 offset:12288
    v_mfma_f32_16x16x32_bf16 v[92:95], v[124:127], a[92:95], v[92:95]
    ds_read_b64_tr_b16 v[62:63], v10 offset:12800
    s_barrier
    s_waitcnt lgkmcnt(7)
    v_mfma_f32_16x16x32_bf16 v[64:67], v[32:35], a[96:99], v[64:67]
    ds_read_b64_tr_b16 v[96:97], v8 offset:16384
    v_mfma_f32_16x16x32_bf16 v[64:67], v[36:39], a[104:107], v[64:67]
    s_add_u32 m0, s56, 51200
    ds_read_b64_tr_b16 v[98:99], v8 offset:16896
    v_mfma_f32_16x16x32_bf16 v[64:67], v[40:43], a[112:115], v[64:67]
    s_xor_b32 s59, s0, 409600
    buffer_load_dwordx4 v16, s[24:27], s59 offen lds
    ds_read_b64_tr_b16 v[100:101], v8 offset:20480
    v_mfma_f32_16x16x32_bf16 v[64:67], v[44:47], a[120:123], v[64:67]
    ds_read_b64_tr_b16 v[102:103], v8 offset:20992
    v_mfma_f32_16x16x32_bf16 v[68:71], v[32:35], a[100:103], v[68:71]
    buffer_load_dwordx4 v19, s[24:27], s59 offen offset:1024 lds
    ds_read_b64_tr_b16 v[104:105], v8 offset:24576
    v_mfma_f32_16x16x32_bf16 v[68:71], v[36:39], a[108:111], v[68:71]
    ds_read_b64_tr_b16 v[106:107], v8 offset:25088
    v_mfma_f32_16x16x32_bf16 v[68:71], v[40:43], a[116:119], v[68:71]
    s_add_u32 m0, s56, 65536
    ds_read_b64_tr_b16 v[108:109], v8 offset:28672
    v_mfma_f32_16x16x32_bf16 v[68:71], v[44:47], a[124:127], v[68:71]
    s_xor_b32 s59, s0, 524288
    buffer_load_dwordx4 v16, s[24:27], s59 offen lds
    ds_read_b64_tr_b16 v[110:111], v8 offset:29184
    s_waitcnt lgkmcnt(7)
    v_mfma_f32_16x16x32_bf16 v[72:75], v[48:51], a[96:99], v[72:75]
    ds_read_b64_tr_b16 v[112:113], v10 offset:16384
    v_mfma_f32_16x16x32_bf16 v[72:75], v[52:55], a[104:107], v[72:75]
    buffer_load_dwordx4 v19, s[24:27], s59 offen offset:1024 lds
    ds_read_b64_tr_b16 v[114:115], v10 offset:16896
    v_mfma_f32_16x16x32_bf16 v[72:75], v[56:59], a[112:115], v[72:75]
    ds_read_b64_tr_b16 v[116:117], v10 offset:20480
    v_mfma_f32_16x16x32_bf16 v[72:75], v[60:63], a[120:123], v[72:75]
    s_add_u32 m0, s56, 67584
    ds_read_b64_tr_b16 v[118:119], v10 offset:20992
    v_mfma_f32_16x16x32_bf16 v[76:79], v[48:51], a[100:103], v[76:79]
    s_xor_b32 s59, s0, 540672
    buffer_load_dwordx4 v16, s[24:27], s59 offen lds
    ds_read_b64_tr_b16 v[120:121], v10 offset:24576
    v_mfma_f32_16x16x32_bf16 v[76:79], v[52:55], a[108:111], v[76:79]
    ds_read_b64_tr_b16 v[122:123], v10 offset:25088
    v_mfma_f32_16x16x32_bf16 v[76:79], v[56:59], a[116:119], v[76:79]
    buffer_load_dwordx4 v19, s[24:27], s59 offen offset:1024 lds
    ds_read_b64_tr_b16 v[124:125], v10 offset:28672
    v_mfma_f32_16x16x32_bf16 v[76:79], v[60:63], a[124:127], v[76:79]
    ds_read_b64_tr_b16 v[126:127], v10 offset:29184
    s_barrier
    s_waitcnt lgkmcnt(7)
    v_mfma_f32_16x16x32_bf16 v[80:83], v[96:99], a[96:99], v[80:83]
    v_mfma_f32_16x16x32_bf16 v[80:83], v[100:103], a[104:107], v[80:83]
    s_add_u32 m0, s56, 81920
    v_mfma_f32_16x16x32_bf16 v[80:83], v[104:107], a[112:115], v[80:83]
    s_xor_b32 s59, s0, 655360
    buffer_load_dwordx4 v16, s[24:27], s59 offen lds
    v_mfma_f32_16x16x32_bf16 v[80:83], v[108:111], a[120:123], v[80:83]
    v_mfma_f32_16x16x32_bf16 v[84:87], v[96:99], a[100:103], v[84:87]
    buffer_load_dwordx4 v19, s[24:27], s59 offen offset:1024 lds
    v_mfma_f32_16x16x32_bf16 v[84:87], v[100:103], a[108:111], v[84:87]
    v_mfma_f32_16x16x32_bf16 v[84:87], v[104:107], a[116:119], v[84:87]
    s_add_u32 m0, s56, 83968
    v_mfma_f32_16x16x32_bf16 v[84:87], v[108:111], a[124:127], v[84:87]
    s_xor_b32 s59, s0, 671744
    buffer_load_dwordx4 v16, s[24:27], s59 offen lds
    s_waitcnt lgkmcnt(0)
    v_mfma_f32_16x16x32_bf16 v[88:91], v[112:115], a[96:99], v[88:91]
    v_mfma_f32_16x16x32_bf16 v[88:91], v[116:119], a[104:107], v[88:91]
    buffer_load_dwordx4 v19, s[24:27], s59 offen offset:1024 lds
    v_mfma_f32_16x16x32_bf16 v[88:91], v[120:123], a[112:115], v[88:91]
    v_mfma_f32_16x16x32_bf16 v[88:91], v[124:127], a[120:123], v[88:91]
    s_add_u32 m0, s56, 0
    v_mfma_f32_16x16x32_bf16 v[92:95], v[112:115], a[100:103], v[92:95]
    s_xor_b32 s59, s0, 786432
    buffer_load_dwordx4 v16, s[24:27], s59 offen lds
    v_mfma_f32_16x16x32_bf16 v[92:95], v[116:119], a[108:111], v[92:95]
    v_mfma_f32_16x16x32_bf16 v[92:95], v[120:123], a[116:119], v[92:95]
    buffer_load_dwordx4 v19, s[24:27], s59 offen offset:1024 lds
    v_mfma_f32_16x16x32_bf16 v[92:95], v[124:127], a[124:127], v[92:95]
    s_lshl_b32 s75, s58, 6
    s_add_u32 s75, s75, 196608
    v_pk_mul_f32 v[80:81], v[64:65], v[80:81]
    v_pk_mul_f32 v[82:83], v[66:67], v[82:83]
    v_pk_mul_f32 v[88:89], v[72:73], v[88:89]
    v_pk_mul_f32 v[90:91], v[74:75], v[90:91]
    v_cvt_pk_bf16_f32 v80, v80, v81
    v_cvt_pk_bf16_f32 v81, v82, v83
    v_cvt_pk_bf16_f32 v82, v88, v89
    v_cvt_pk_bf16_f32 v83, v90, v91
    v_pk_mul_f32 v[84:85], v[68:69], v[84:85]
    v_pk_mul_f32 v[86:87], v[70:71], v[86:87]
    s_add_u32 s60, s75, s70
    s_nop 0
    buffer_store_dwordx4 v[80:83], v18, s[44:47], s60 offen sc1
    v_pk_mul_f32 v[92:93], v[76:77], v[92:93]
    v_pk_mul_f32 v[94:95], v[78:79], v[94:95]
    v_cvt_pk_bf16_f32 v84, v84, v85
    v_cvt_pk_bf16_f32 v85, v86, v87
    v_cvt_pk_bf16_f32 v86, v92, v93
    v_cvt_pk_bf16_f32 v87, v94, v95
    s_add_u32 s60, s75, s71
    buffer_store_dwordx4 v[84:87], v18, s[44:47], s60 offen sc1
    v_mov_b32 v59, 2
    s_waitcnt vmcnt(16)
    s_nop 0
    ds_read_b64_tr_b16 a[160:161], v20 offset:32768
    ds_read_b64_tr_b16 a[162:163], v20 offset:34816
    ds_read_b64_tr_b16 a[164:165], v21 offset:32768
    ds_read_b64_tr_b16 a[166:167], v21 offset:34816
    ds_read_b64_tr_b16 a[168:169], v22 offset:32768
    ds_read_b64_tr_b16 a[170:171], v22 offset:34816
    ds_read_b64_tr_b16 a[172:173], v23 offset:32768
    ds_read_b64_tr_b16 a[174:175], v23 offset:34816
    s_waitcnt vmcnt(12)
    s_nop 0
    ds_read_b64_tr_b16 a[176:177], v20 offset:49152
    ds_read_b64_tr_b16 a[178:179], v20 offset:51200
    ds_read_b64_tr_b16 a[180:181], v21 offset:49152
    ds_read_b64_tr_b16 a[182:183], v21 offset:51200
    ds_read_b64_tr_b16 a[184:185], v22 offset:49152
    ds_read_b64_tr_b16 a[186:187], v22 offset:51200
    ds_read_b64_tr_b16 a[188:189], v23 offset:49152
    ds_read_b64_tr_b16 a[190:191], v23 offset:51200
    v_mfma_f32_16x16x32_bf16 v[80:83], a[128:131], v[192:195], 0
    buffer_load_dwordx4 v[240:243], v12, s[44:47], s92 offen sc1
    v_mfma_f32_16x16x32_bf16 v[80:83], a[144:147], v[196:199], v[80:83]
    buffer_load_dwordx4 v[244:247], v12, s[44:47], s93 offen sc1
    buffer_load_dwordx4 v[248:251], v4, s[44:47], s92 offen sc1
    v_mfma_f32_16x16x32_bf16 v[84:87], a[132:135], v[192:195], 0
    s_waitcnt vmcnt(11)
    buffer_load_dwordx4 v[252:255], v4, s[44:47], s93 offen sc1
    ds_read_b64_tr_b16 a[192:193], v24 offset:0
    v_mfma_f32_16x16x32_bf16 v[84:87], a[148:151], v[196:199], v[84:87]
    ds_read_b64_tr_b16 a[194:195], v24 offset:2048
    ds_read_b64_tr_b16 a[196:197], v25 offset:0
    v_mfma_f32_16x16x32_bf16 v[88:91], a[136:139], v[192:195], 0
    ds_read_b64_tr_b16 a[198:199], v25 offset:2048
    v_mfma_f32_16x16x32_bf16 v[88:91], a[152:155], v[196:199], v[88:91]
    ds_read_b64_tr_b16 a[200:201], v26 offset:0
    ds_read_b64_tr_b16 a[202:203], v26 offset:2048
    v_mfma_f32_16x16x32_bf16 v[92:95], a[140:143], v[192:195], 0
    ds_read_b64_tr_b16 a[204:205], v27 offset:0
    ds_read_b64_tr_b16 a[206:207], v27 offset:2048
    v_mfma_f32_16x16x32_bf16 v[92:95], a[156:159], v[196:199], v[92:95]
    s_add_u32 m0, s56, 2048
    s_xor_b32 s59, s0, 802816
    buffer_load_dwordx4 v16, s[24:27], s59 offen lds
    buffer_load_dwordx4 v19, s[24:27], s59 offen offset:1024 lds
    v_mfma_f32_16x16x32_bf16 v[96:99], a[128:131], v[200:203], 0
    s_waitcnt lgkmcnt(8)
    s_add_u32 m0, s56, 32768
    s_xor_b32 s59, s0, 917504
    buffer_load_dwordx4 v16, s[24:27], s59 offen lds
    v_mfma_f32_16x16x32_bf16 v[96:99], a[144:147], v[204:207], v[96:99]
    s_waitcnt vmcnt(11)
    buffer_load_dwordx4 v19, s[24:27], s59 offen offset:1024 lds
    ds_read_b64_tr_b16 a[208:209], v24 offset:16384
    v_mfma_f32_16x16x32_bf16 v[100:103], a[132:135], v[200:203], 0
    ds_read_b64_tr_b16 a[210:211], v24 offset:18432
    ds_read_b64_tr_b16 a[212:213], v25 offset:16384
    v_mfma_f32_16x16x32_bf16 v[100:103], a[148:151], v[204:207], v[100:103]
    ds_read_b64_tr_b16 a[214:215], v25 offset:18432
    ds_read_b64_tr_b16 a[216:217], v26 offset:16384
    v_mfma_f32_16x16x32_bf16 v[104:107], a[136:139], v[200:203], 0
    ds_read_b64_tr_b16 a[218:219], v26 offset:18432
    v_mfma_f32_16x16x32_bf16 v[104:107], a[152:155], v[204:207], v[104:107]
    ds_read_b64_tr_b16 a[220:221], v27 offset:16384
    ds_read_b64_tr_b16 a[222:223], v27 offset:18432
    v_mfma_f32_16x16x32_bf16 v[108:111], a[140:143], v[200:203], 0
    s_add_u32 m0, s56, 34816
    s_xor_b32 s59, s0, 933888
    buffer_load_dwordx4 v16, s[24:27], s59 offen lds
    buffer_load_dwordx4 v19, s[24:27], s59 offen offset:1024 lds
    v_mfma_f32_16x16x32_bf16 v[108:111], a[156:159], v[204:207], v[108:111]
    s_add_u32 m0, s56, 98304
    s_xor_b32 s59, s6, 0
    buffer_load_dwordx4 v16, s[28:31], s59 offen lds
    buffer_load_dwordx4 v19, s[28:31], s59 offen offset:1024 lds
    s_waitcnt vmcnt(12)
    s_barrier
    buffer_store_dword v59, v5, s[48:51], s84 offen sc1
    v_mfma_f32_16x16x32_bf16 v[112:115], a[128:131], v[208:211], 0
    buffer_load_dword v17, v3, s[48:51], s90 offen sc1
    v_mfma_f32_16x16x32_bf16 v[112:115], a[144:147], v[212:215], v[112:115]
    s_add_u32 m0, s56, 100352
    s_xor_b32 s59, s6, 16384
    buffer_load_dwordx4 v16, s[28:31], s59 offen lds
    buffer_load_dwordx4 v19, s[28:31], s59 offen offset:1024 lds
    v_mfma_f32_16x16x32_bf16 v[116:119], a[132:135], v[208:211], 0
    s_add_u32 m0, s56, 114688
    s_xor_b32 s59, s6, 131072
    buffer_load_dwordx4 v16, s[28:31], s59 offen lds
    buffer_load_dwordx4 v19, s[28:31], s59 offen offset:1024 lds
    v_mfma_f32_16x16x32_bf16 v[116:119], a[148:151], v[212:215], v[116:119]
    s_waitcnt vmcnt(12)
    ds_read_b64_tr_b16 a[224:225], v20 offset:0
    ds_read_b64_tr_b16 a[226:227], v20 offset:2048
    v_mfma_f32_16x16x32_bf16 v[120:123], a[136:139], v[208:211], 0
    ds_read_b64_tr_b16 a[228:229], v21 offset:0
    ds_read_b64_tr_b16 a[230:231], v21 offset:2048
    v_mfma_f32_16x16x32_bf16 v[120:123], a[152:155], v[212:215], v[120:123]
    ds_read_b64_tr_b16 a[232:233], v22 offset:0
    ds_read_b64_tr_b16 a[234:235], v22 offset:2048
    v_mfma_f32_16x16x32_bf16 v[124:127], a[140:143], v[208:211], 0
    ds_read_b64_tr_b16 a[236:237], v23 offset:0
    ds_read_b64_tr_b16 a[238:239], v23 offset:2048
    v_mfma_f32_16x16x32_bf16 v[124:127], a[156:159], v[212:215], v[124:127]
    s_add_u32 m0, s56, 116736
    s_xor_b32 s59, s6, 147456
    buffer_load_dwordx4 v16, s[28:31], s59 offen lds
    buffer_load_dwordx4 v19, s[28:31], s59 offen offset:1024 lds
    v_mfma_f32_16x16x32_bf16 v[64:67], a[128:131], v[216:219], 0
    s_add_u32 m0, s56, 49152
    s_xor_b32 s59, s6, 1048576
    buffer_load_dwordx4 v16, s[24:27], s59 offen lds
    v_mfma_f32_16x16x32_bf16 v[64:67], a[144:147], v[220:223], v[64:67]
    s_waitcnt vmcnt(11)
    buffer_load_dwordx4 v19, s[24:27], s59 offen offset:1024 lds
    ds_read_b64_tr_b16 a[240:241], v20 offset:32768
    v_mfma_f32_16x16x32_bf16 v[68:71], a[132:135], v[216:219], 0
    ds_read_b64_tr_b16 a[242:243], v20 offset:34816
    ds_read_b64_tr_b16 a[244:245], v21 offset:32768
    v_mfma_f32_16x16x32_bf16 v[68:71], a[148:151], v[220:223], v[68:71]
    ds_read_b64_tr_b16 a[246:247], v21 offset:34816
    ds_read_b64_tr_b16 a[248:249], v22 offset:32768
    v_mfma_f32_16x16x32_bf16 v[72:75], a[136:139], v[216:219], 0
    ds_read_b64_tr_b16 a[250:251], v22 offset:34816
    v_mfma_f32_16x16x32_bf16 v[72:75], a[152:155], v[220:223], v[72:75]
    ds_read_b64_tr_b16 a[252:253], v23 offset:32768
    ds_read_b64_tr_b16 a[254:255], v23 offset:34816
    v_mfma_f32_16x16x32_bf16 v[76:79], a[140:143], v[216:219], 0
    s_add_u32 m0, s56, 51200
    s_xor_b32 s59, s6, 1064960
    buffer_load_dwordx4 v16, s[24:27], s59 offen lds
    buffer_load_dwordx4 v19, s[24:27], s59 offen offset:1024 lds
    v_mfma_f32_16x16x32_bf16 v[76:79], a[156:159], v[220:223], v[76:79]
    s_waitcnt lgkmcnt(8)
    s_add_u32 m0, s56, 65536
    s_xor_b32 s59, s6, 1179648
    buffer_load_dwordx4 v16, s[24:27], s59 offen lds
    buffer_load_dwordx4 v19, s[24:27], s59 offen offset:1024 lds
    v_mfma_f32_16x16x32_bf16 v[80:83], a[160:163], v[224:227], v[80:83]
    s_waitcnt vmcnt(12)
    v_cmp_gt_u32 vcc, 1, v17
    s_nop 0
    s_and_b32 vcc_lo, vcc_lo, 0xff
    s_cbranch_scc1 L_k_retry2
L_k_back2:
    s_xor_b32 s92, s67, 65536
    s_add_u32 s92, s92, s64
    buffer_load_dwordx4 v[128:131], v6, s[44:47], s92 offen sc1
    v_mfma_f32_16x16x32_bf16 v[80:83], a[176:179], v[228:231], v[80:83]
    s_xor_b32 s93, s67, 81920
    s_add_u32 s93, s93, s64
    buffer_load_dwordx4 v[132:135], v6, s[44:47], s93 offen sc1
    v_mfma_f32_16x16x32_bf16 v[84:87], a[164:167], v[224:227], v[84:87]
    s_movk_i32 s60, 144
    buffer_load_dwordx4 v[136:139], v7, s[44:47], s92 offen sc1
    v_mfma_f32_16x16x32_bf16 v[84:87], a[180:183], v[228:231], v[84:87]
    s_add_u32 s61, s56, 65536
    v_lshrrev_b32 v14, 3, v1
    v_and_b32 v15, 7, v1
    v_mfma_f32_16x16x32_bf16 v[88:91], a[168:171], v[224:227], v[88:91]
    buffer_load_dwordx4 v[140:143], v7, s[44:47], s93 offen sc1
    v_mfma_f32_16x16x32_bf16 v[88:91], a[184:187], v[228:231], v[88:91]
    buffer_load_dwordx4 v[144:147], v12, s[44:47], s92 offen sc1
    v_mfma_f32_16x16x32_bf16 v[92:95], a[172:175], v[224:227], v[92:95]
    buffer_load_dwordx4 v[148:151], v12, s[44:47], s93 offen sc1
    v_mfma_f32_16x16x32_bf16 v[92:95], a[188:191], v[228:231], v[92:95]
    s_waitcnt vmcnt(12)
    v_lshlrev_b32 v15, 4, v15
    v_lshl_add_u32 v8, v14, 10, v15
    s_barrier
    v_mfma_f32_16x16x32_bf16 v[96:99], a[160:163], v[232:235], v[96:99]
    buffer_load_dwordx4 v[152:155], v4, s[44:47], s92 offen sc1
    v_mfma_f32_16x16x32_bf16 v[96:99], a[176:179], v[236:239], v[96:99]
    s_waitcnt vmcnt(9)
    buffer_load_dwordx4 v[156:159], v4, s[44:47], s93 offen sc1
    ds_read_b64_tr_b16 a[0:1], v20 offset:49152
    v_mfma_f32_16x16x32_bf16 v[100:103], a[164:167], v[232:235], v[100:103]
    ds_read_b64_tr_b16 a[2:3], v20 offset:51200
    ds_read_b64_tr_b16 a[4:5], v21 offset:49152
    v_mfma_f32_16x16x32_bf16 v[100:103], a[180:183], v[236:239], v[100:103]
    ds_read_b64_tr_b16 a[6:7], v21 offset:51200
    ds_read_b64_tr_b16 a[8:9], v22 offset:49152
    v_mfma_f32_16x16x32_bf16 v[104:107], a[168:171], v[232:235], v[104:107]
    ds_read_b64_tr_b16 a[10:11], v22 offset:51200
    v_mfma_f32_16x16x32_bf16 v[104:107], a[184:187], v[236:239], v[104:107]
    ds_read_b64_tr_b16 a[12:13], v23 offset:49152
    ds_read_b64_tr_b16 a[14:15], v23 offset:51200
    v_mfma_f32_16x16x32_bf16 v[108:111], a[172:175], v[232:235], v[108:111]
    s_xor_b32 s92, s67, 98304
    s_add_u32 s92, s92, s64
    buffer_load_dwordx4 v[160:163], v6, s[44:47], s92 offen sc1
    s_xor_b32 s93, s67, 114688
    s_add_u32 s93, s93, s64
    buffer_load_dwordx4 v[164:167], v6, s[44:47], s93 offen sc1
    v_mfma_f32_16x16x32_bf16 v[108:111], a[188:191], v[236:239], v[108:111]
    s_add_u32 m0, s56, 67584
    s_xor_b32 s59, s6, 1196032
    buffer_load_dwordx4 v16, s[24:27], s59 offen lds
    buffer_load_dwordx4 v19, s[24:27], s59 offen offset:1024 lds
    v_mfma_f32_16x16x32_bf16 v[112:115], a[160:163], v[240:243], v[112:115]
    buffer_load_dwordx4 v[168:171], v7, s[44:47], s92 offen sc1
    v_mfma_f32_16x16x32_bf16 v[112:115], a[176:179], v[244:247], v[112:115]
    v_mad_u32_u24 v56, v14, s60, v15
    v_add_u32_e64 v56, s61, v56
    v_mfma_f32_16x16x32_bf16 v[116:119], a[164:167], v[240:243], v[116:119]
    buffer_load_dwordx4 v[172:175], v7, s[44:47], s93 offen sc1
    v_mfma_f32_16x16x32_bf16 v[116:119], a[180:183], v[244:247], v[116:119]
    s_add_u32 m0, s56, 81920
    v_and_b32 v14, 15, v1
    v_lshrrev_b32 v15, 4, v1
    v_mfma_f32_16x16x32_bf16 v[120:123], a[168:171], v[240:243], v[120:123]
    s_xor_b32 s59, s6, 1310720
    buffer_load_dwordx4 v16, s[24:27], s59 offen lds
    v_mfma_f32_16x16x32_bf16 v[120:123], a[184:187], v[244:247], v[120:123]
    v_lshlrev_b32_e64 v15, 3, v15
    v_mad_u32_u24 v57, v14, s60, v15
    v_mfma_f32_16x16x32_bf16 v[124:127], a[172:175], v[240:243], v[124:127]
    buffer_load_dwordx4 v19, s[24:27], s59 offen offset:1024 lds
    v_mfma_f32_16x16x32_bf16 v[124:127], a[188:191], v[244:247], v[124:127]
    v_add_u32_e64 v57, s61, v57
    v_lshl_add_u32 v58, v14, 7, v15
    v_mfma_f32_16x16x32_bf16 v[64:67], a[160:163], v[248:251], v[64:67]
    buffer_load_dword v17, v3, s[48:51], s90 offen sc1
    ds_read_b64_tr_b16 a[96:97], v28 offset:0
    v_mfma_f32_16x16x32_bf16 v[64:67], a[176:179], v[252:255], v[64:67]
    buffer_load_dwordx4 v[176:179], v12, s[44:47], s92 offen sc1
    ds_read_b64_tr_b16 a[98:99], v28 offset:2048
    v_mfma_f32_16x16x32_bf16 v[68:71], a[164:167], v[248:251], v[68:71]
    ds_read_b64_tr_b16 a[100:101], v29 offset:0
    ds_read_b64_tr_b16 a[102:103], v29 offset:2048
    v_mfma_f32_16x16x32_bf16 v[68:71], a[180:183], v[252:255], v[68:71]
    s_add_u32 m0, s56, 83968
    buffer_load_dwordx4 v[180:183], v12, s[44:47], s93 offen sc1
    ds_read_b64_tr_b16 a[104:105], v30 offset:0
    v_mfma_f32_16x16x32_bf16 v[72:75], a[168:171], v[248:251], v[72:75]
    s_xor_b32 s59, s6, 1327104
    buffer_load_dwordx4 v16, s[24:27], s59 offen lds
    ds_read_b64_tr_b16 a[106:107], v30 offset:2048
    v_mfma_f32_16x16x32_bf16 v[72:75], a[184:187], v[252:255], v[72:75]
    ds_read_b64_tr_b16 a[108:109], v31 offset:0
    ds_read_b64_tr_b16 a[110:111], v31 offset:2048
    v_mfma_f32_16x16x32_bf16 v[76:79], a[172:175], v[248:251], v[76:79]
    buffer_load_dwordx4 v19, s[24:27], s59 offen offset:1024 lds
    v_mfma_f32_16x16x32_bf16 v[76:79], a[188:191], v[252:255], v[76:79]
    s_waitcnt vmcnt(20)
    v_add_u32 v58, s56, v58
    v_add_u32 v58, 49152, v58
    v_mfma_f32_16x16x32_bf16 v[80:83], a[192:195], v[128:131], v[80:83]
    s_waitcnt vmcnt(19)
    buffer_load_dwordx4 v[184:187], v4, s[44:47], s92 offen sc1
    v_mfma_f32_16x16x32_bf16 v[80:83], a[208:211], v[132:135], v[80:83]
    s_waitcnt vmcnt(10)
    ds_read_b64_tr_b16 a[16:17], v24 offset:0
    ds_read_b64_tr_b16 a[18:19], v24 offset:2048
    v_mfma_f32_16x16x32_bf16 v[84:87], a[196:199], v[128:131], v[84:87]
    ds_read_b64_tr_b16 a[20:21], v25 offset:0
    v_mfma_f32_16x16x32_bf16 v[84:87], a[212:215], v[132:135], v[84:87]
    ds_read_b64_tr_b16 a[22:23], v25 offset:2048
    ds_read_b64_tr_b16 a[24:25], v26 offset:0
    v_mfma_f32_16x16x32_bf16 v[88:91], a[200:203], v[128:131], v[88:91]
    ds_read_b64_tr_b16 a[26:27], v26 offset:2048
    v_mfma_f32_16x16x32_bf16 v[88:91], a[216:219], v[132:135], v[88:91]
    ds_read_b64_tr_b16 a[28:29], v27 offset:0
    ds_read_b64_tr_b16 a[30:31], v27 offset:2048
    v_mfma_f32_16x16x32_bf16 v[92:95], a[204:207], v[128:131], v[92:95]
    buffer_load_dwordx4 v[188:191], v4, s[44:47], s93 offen sc1
    v_mfma_f32_16x16x32_bf16 v[92:95], a[220:223], v[132:135], v[92:95]
    s_add_u32 m0, s56, 16384
    s_xor_b32 s59, s6, 1441792
    buffer_load_dwordx4 v16, s[24:27], s59 offen lds
    buffer_load_dwordx4 v19, s[24:27], s59 offen offset:1024 lds
    v_mfma_f32_16x16x32_bf16 v[96:99], a[192:195], v[136:139], v[96:99]
    s_waitcnt vmcnt(8)
    v_cmp_gt_u32 vcc, 2, v17
    s_nop 0
    s_and_b32 vcc_lo, vcc_lo, 0xff00
    s_cbranch_scc1 L_k_retry3
L_k_back3:
    s_xor_b32 s92, s65, 131072
    s_add_u32 s92, s92, s64
    buffer_load_dwordx4 v[192:195], v6, s[44:47], s92 offen sc1
    ds_read_b64_tr_b16 a[112:113], v28 offset:4096
    v_mfma_f32_16x16x32_bf16 v[96:99], a[208:211], v[140:143], v[96:99]
    s_xor_b32 s93, s65, 147456
    ds_read_b64_tr_b16 a[114:115], v28 offset:6144
    ds_read_b64_tr_b16 a[116:117], v29 offset:4096
    v_mfma_f32_16x16x32_bf16 v[100:103], a[196:199], v[136:139], v[100:103]
    s_add_u32 s93, s93, s64
    buffer_load_dwordx4 v[196:199], v6, s[44:47], s93 offen sc1
    ds_read_b64_tr_b16 a[118:119], v29 offset:6144
    v_mfma_f32_16x16x32_bf16 v[100:103], a[212:215], v[140:143], v[100:103]
    s_add_u32 m0, s56, 18432
    ds_read_b64_tr_b16 a[120:121], v30 offset:4096
    ds_read_b64_tr_b16 a[122:123], v30 offset:6144
    v_mfma_f32_16x16x32_bf16 v[104:107], a[200:203], v[136:139], v[104:107]
    s_xor_b32 s59, s6, 1458176
    buffer_load_dwordx4 v16, s[24:27], s59 offen lds
    ds_read_b64_tr_b16 a[124:125], v31 offset:4096
    v_mfma_f32_16x16x32_bf16 v[104:107], a[216:219], v[140:143], v[104:107]
    ds_read_b64_tr_b16 a[126:127], v31 offset:6144
    v_add_u32_e64 v9, s56, v2
    v_mfma_f32_16x16x32_bf16 v[108:111], a[204:207], v[136:139], v[108:111]
    buffer_load_dwordx4 v19, s[24:27], s59 offen offset:1024 lds
    v_mfma_f32_16x16x32_bf16 v[108:111], a[220:223], v[140:143], v[108:111]
    v_xor_b32 v10, 4096, v9
    v_xor_b32 v11, 8192, v9
    v_mfma_f32_16x16x32_bf16 v[112:115], a[192:195], v[144:147], v[112:115]
    buffer_load_dwordx4 v[200:203], v7, s[44:47], s92 offen sc1
    v_mfma_f32_16x16x32_bf16 v[112:115], a[208:211], v[148:151], v[112:115]
    s_waitcnt vmcnt(9)
    buffer_load_dwordx4 v[204:207], v7, s[44:47], s93 offen sc1
    ds_read_b64_tr_b16 a[32:33], v24 offset:16384
    v_mfma_f32_16x16x32_bf16 v[116:119], a[196:199], v[144:147], v[116:119]
    ds_read_b64_tr_b16 a[34:35], v24 offset:18432
    v_mfma_f32_16x16x32_bf16 v[116:119], a[212:215], v[148:151], v[116:119]
    ds_read_b64_tr_b16 a[36:37], v25 offset:16384
    ds_read_b64_tr_b16 a[38:39], v25 offset:18432
    v_mfma_f32_16x16x32_bf16 v[120:123], a[200:203], v[144:147], v[120:123]
    ds_read_b64_tr_b16 a[40:41], v26 offset:16384
    v_mfma_f32_16x16x32_bf16 v[120:123], a[216:219], v[148:151], v[120:123]
    ds_read_b64_tr_b16 a[42:43], v26 offset:18432
    ds_read_b64_tr_b16 a[44:45], v27 offset:16384
    v_mfma_f32_16x16x32_bf16 v[124:127], a[204:207], v[144:147], v[124:127]
    ds_read_b64_tr_b16 a[46:47], v27 offset:18432
    v_mfma_f32_16x16x32_bf16 v[124:127], a[220:223], v[148:151], v[124:127]
    s_add_u32 m0, s56, 0
    s_xor_b32 s59, s7, 1572864
    buffer_load_dwordx4 v16, s[24:27], s59 offen lds
    buffer_load_dwordx4 v19, s[24:27], s59 offen offset:1024 lds
    v_mfma_f32_16x16x32_bf16 v[64:67], a[192:195], v[152:155], v[64:67]
    buffer_load_dwordx4 v[208:211], v12, s[44:47], s92 offen sc1
    ds_read_b64_tr_b16 a[128:129], v28 offset:8192
    v_mfma_f32_16x16x32_bf16 v[64:67], a[208:211], v[156:159], v[64:67]
    ds_read_b64_tr_b16 a[130:131], v28 offset:10240
    ds_read_b64_tr_b16 a[132:133], v29 offset:8192
    v_mfma_f32_16x16x32_bf16 v[68:71], a[196:199], v[152:155], v[68:71]
    buffer_load_dwordx4 v[212:215], v12, s[44:47], s93 offen sc1
    ds_read_b64_tr_b16 a[134:135], v29 offset:10240
    v_mfma_f32_16x16x32_bf16 v[68:71], a[212:215], v[156:159], v[68:71]
    s_add_u32 m0, s56, 2048
    ds_read_b64_tr_b16 a[136:137], v30 offset:8192
    ds_read_b64_tr_b16 a[138:139], v30 offset:10240
    v_mfma_f32_16x16x32_bf16 v[72:75], a[200:203], v[152:155], v[72:75]
    s_xor_b32 s59, s7, 1589248
    buffer_load_dwordx4 v16, s[24:27], s59 offen lds
    ds_read_b64_tr_b16 a[140:141], v31 offset:8192
    v_mfma_f32_16x16x32_bf16 v[72:75], a[216:219], v[156:159], v[72:75]
    ds_read_b64_tr_b16 a[142:143], v31 offset:10240
    ds_read_b64_tr_b16 a[144:145], v28 offset:12288
    v_mfma_f32_16x16x32_bf16 v[76:79], a[204:207], v[152:155], v[76:79]
    buffer_load_dwordx4 v19, s[24:27], s59 offen offset:1024 lds
    ds_read_b64_tr_b16 a[146:147], v28 offset:14336
    v_mfma_f32_16x16x32_bf16 v[76:79], a[220:223], v[156:159], v[76:79]
    ds_read_b64_tr_b16 a[148:149], v29 offset:12288
    ds_read_b64_tr_b16 a[150:151], v29 offset:14336
    v_mfma_f32_16x16x32_bf16 v[80:83], a[224:227], v[160:163], v[80:83]
    s_waitcnt lgkmcnt(9)
    buffer_load_dword v17, v3, s[48:51], s90 offen sc1
    v_mfma_f32_16x16x32_bf16 v[80:83], a[240:243], v[164:167], v[80:83]
    s_waitcnt vmcnt(9)
    buffer_load_dwordx4 v[216:219], v4, s[44:47], s92 offen sc1
    ds_read_b64_tr_b16 a[48:49], v20 offset:16384
    v_mfma_f32_16x16x32_bf16 v[84:87], a[228:231], v[160:163], v[84:87]
    ds_read_b64_tr_b16 a[50:51], v20 offset:18432
    v_mfma_f32_16x16x32_bf16 v[84:87], a[244:247], v[164:167], v[84:87]
    ds_read_b64_tr_b16 a[52:53], v21 offset:16384
    ds_read_b64_tr_b16 a[54:55], v21 offset:18432
    v_mfma_f32_16x16x32_bf16 v[88:91], a[232:235], v[160:163], v[88:91]
    ds_read_b64_tr_b16 a[56:57], v22 offset:16384
    ds_read_b64_tr_b16 a[58:59], v22 offset:18432
    v_mfma_f32_16x16x32_bf16 v[88:91], a[248:251], v[164:167], v[88:91]
    ds_read_b64_tr_b16 a[60:61], v23 offset:16384
    v_mfma_f32_16x16x32_bf16 v[92:95], a[236:239], v[160:163], v[92:95]
    ds_read_b64_tr_b16 a[62:63], v23 offset:18432
    buffer_load_dwordx4 v[220:223], v4, s[44:47], s93 offen sc1
    v_mfma_f32_16x16x32_bf16 v[92:95], a[252:255], v[164:167], v[92:95]
    s_add_u32 m0, s56, 32768
    s_xor_b32 s59, s7, 1703936
    buffer_load_dwordx4 v16, s[24:27], s59 offen lds
    buffer_load_dwordx4 v19, s[24:27], s59 offen offset:1024 lds
    v_mfma_f32_16x16x32_bf16 v[96:99], a[224:227], v[168:171], v[96:99]
    s_xor_b32 s92, s65, 163840
    s_add_u32 s92, s92, s64
    buffer_load_dwordx4 v[224:227], v6, s[44:47], s92 offen sc1
    ds_read_b64_tr_b16 a[152:153], v30 offset:12288
    v_mfma_f32_16x16x32_bf16 v[96:99], a[240:243], v[172:175], v[96:99]
    s_xor_b32 s93, s65, 180224
    ds_read_b64_tr_b16 a[154:155], v30 offset:14336
    ds_read_b64_tr_b16 a[156:157], v31 offset:12288
    v_mfma_f32_16x16x32_bf16 v[100:103], a[228:231], v[168:171], v[100:103]
    s_add_u32 s93, s93, s64
    buffer_load_dwordx4 v[228:231], v6, s[44:47], s93 offen sc1
    ds_read_b64_tr_b16 a[158:159], v31 offset:14336
    v_mfma_f32_16x16x32_bf16 v[100:103], a[244:247], v[172:175], v[100:103]
    s_add_u32 m0, s56, 34816
    ds_read_b64_tr_b16 a[160:161], v28 offset:16384
    ds_read_b64_tr_b16 a[162:163], v28 offset:18432
    v_mfma_f32_16x16x32_bf16 v[104:107], a[232:235], v[168:171], v[104:107]
    s_xor_b32 s59, s7, 1720320
    buffer_load_dwordx4 v16, s[24:27], s59 offen lds
    ds_read_b64_tr_b16 a[164:165], v29 offset:16384
    v_mfma_f32_16x16x32_bf16 v[104:107], a[248:251], v[172:175], v[104:107]
    ds_read_b64_tr_b16 a[166:167], v29 offset:18432
    ds_read_b64_tr_b16 a[168:169], v30 offset:16384
    v_mfma_f32_16x16x32_bf16 v[108:111], a[236:239], v[168:171], v[108:111]
    buffer_load_dwordx4 v19, s[24:27], s59 offen offset:1024 lds
    ds_read_b64_tr_b16 a[170:171], v30 offset:18432
    v_mfma_f32_16x16x32_bf16 v[108:111], a[252:255], v[172:175], v[108:111]
    ds_read_b64_tr_b16 a[172:173], v31 offset:16384
    ds_read_b64_tr_b16 a[174:175], v31 offset:18432
    v_mfma_f32_16x16x32_bf16 v[112:115], a[224:227], v[176:179], v[112:115]
    s_waitcnt vmcnt(8)
    v_cmp_gt_u32 vcc, 2, v17
    s_nop 0
    s_and_b32 vcc_lo, vcc_lo, 0xff
    s_cbranch_scc1 L_k_retry4
L_k_back4:
    s_xor_b32 s86, s66, 196608
    s_add_u32 s86, s86, s64
    buffer_load_dwordx4 v[232:235], v6, s[44:47], s86 offen sc1
    v_mfma_f32_16x16x32_bf16 v[112:115], a[240:243], v[180:183], v[112:115]
    ds_read_b64_tr_b16 a[64:65], v20 offset:0
    ds_read_b64_tr_b16 a[66:67], v20 offset:2048
    v_mfma_f32_16x16x32_bf16 v[116:119], a[228:231], v[176:179], v[116:119]
    ds_read_b64_tr_b16 a[68:69], v21 offset:0
    v_mfma_f32_16x16x32_bf16 v[116:119], a[244:247], v[180:183], v[116:119]
    ds_read_b64_tr_b16 a[70:71], v21 offset:2048
    ds_read_b64_tr_b16 a[72:73], v22 offset:0
    v_mfma_f32_16x16x32_bf16 v[120:123], a[232:235], v[176:179], v[120:123]
    ds_read_b64_tr_b16 a[74:75], v22 offset:2048
    v_mfma_f32_16x16x32_bf16 v[120:123], a[248:251], v[180:183], v[120:123]
    ds_read_b64_tr_b16 a[76:77], v23 offset:0
    ds_read_b64_tr_b16 a[78:79], v23 offset:2048
    v_mfma_f32_16x16x32_bf16 v[124:127], a[236:239], v[176:179], v[124:127]
    s_xor_b32 s87, s66, 212992
    s_add_u32 s87, s87, s64
    buffer_load_dwordx4 v[236:239], v6, s[44:47], s87 offen sc1
    v_mfma_f32_16x16x32_bf16 v[124:127], a[252:255], v[180:183], v[124:127]
    s_add_u32 m0, s56, 49152
    s_nop 0
    buffer_load_dwordx4 v8, s[8:11], s91 offen lds
    s_add_u32 s59, s91, 7168
    buffer_load_dwordx4 v8, s[8:11], s59 offen offset:1024 lds
    v_mfma_f32_16x16x32_bf16 v[64:67], a[224:227], v[184:187], v[64:67]
    buffer_load_dwordx4 v[240:243], v7, s[44:47], s92 offen sc1
    ds_read_b64_tr_b16 a[176:177], v28 offset:20480
    v_mfma_f32_16x16x32_bf16 v[64:67], a[240:243], v[188:191], v[64:67]
    ds_read_b64_tr_b16 a[178:179], v28 offset:22528
    ds_read_b64_tr_b16 a[180:181], v29 offset:20480
    v_mfma_f32_16x16x32_bf16 v[68:71], a[228:231], v[184:187], v[68:71]
    ds_read_b64_tr_b16 a[182:183], v29 offset:22528
    ds_read_b64_tr_b16 a[184:185], v30 offset:20480
    v_mfma_f32_16x16x32_bf16 v[68:71], a[244:247], v[188:191], v[68:71]
    ds_read_b64_tr_b16 a[186:187], v30 offset:22528
    ds_read_b64_tr_b16 a[188:189], v31 offset:20480
    v_mfma_f32_16x16x32_bf16 v[72:75], a[232:235], v[184:187], v[72:75]
    buffer_load_dwordx4 v[244:247], v7, s[44:47], s93 offen sc1
    ds_read_b64_tr_b16 a[190:191], v31 offset:22528
    v_mfma_f32_16x16x32_bf16 v[72:75], a[248:251], v[188:191], v[72:75]
    ds_read_b64_tr_b16 a[192:193], v28 offset:24576
    ds_read_b64_tr_b16 a[194:195], v28 offset:26624
    v_mfma_f32_16x16x32_bf16 v[76:79], a[236:239], v[184:187], v[76:79]
    ds_read_b64_tr_b16 a[196:197], v29 offset:24576
    ds_read_b64_tr_b16 a[198:199], v29 offset:26624
    v_mfma_f32_16x16x32_bf16 v[76:79], a[252:255], v[188:191], v[76:79]
    ds_read_b64_tr_b16 a[200:201], v30 offset:24576
    ds_read_b64_tr_b16 a[202:203], v30 offset:26624
    v_mfma_f32_16x16x32_bf16 v[80:83], a[0:3], v[192:195], v[80:83]
    buffer_load_dwordx4 v[248:251], v7, s[44:47], s86 offen sc1
    ds_read_b64_tr_b16 a[204:205], v31 offset:24576
    v_mfma_f32_16x16x32_bf16 v[80:83], a[16:19], v[196:199], v[80:83]
    ds_read_b64_tr_b16 a[206:207], v31 offset:26624
    ds_read_b64_tr_b16 a[208:209], v28 offset:28672
    v_mfma_f32_16x16x32_bf16 v[84:87], a[4:7], v[192:195], v[84:87]
    ds_read_b64_tr_b16 a[210:211], v28 offset:30720
    ds_read_b64_tr_b16 a[212:213], v29 offset:28672
    v_mfma_f32_16x16x32_bf16 v[84:87], a[20:23], v[196:199], v[84:87]
    ds_read_b64_tr_b16 a[214:215], v29 offset:30720
    ds_read_b64_tr_b16 a[216:217], v30 offset:28672
    v_mfma_f32_16x16x32_bf16 v[88:91], a[8:11], v[192:195], v[88:91]
    buffer_load_dwordx4 v[252:255], v7, s[44:47], s87 offen sc1
    ds_read_b64_tr_b16 a[218:219], v30 offset:30720
    v_mfma_f32_16x16x32_bf16 v[88:91], a[24:27], v[196:199], v[88:91]
    ds_read_b64_tr_b16 a[220:221], v31 offset:28672
    ds_read_b64_tr_b16 a[222:223], v31 offset:30720
    v_mfma_f32_16x16x32_bf16 v[92:95], a[12:15], v[192:195], v[92:95]
    ds_read_b64_tr_b16 a[224:225], v28 offset:32768
    ds_read_b64_tr_b16 a[226:227], v28 offset:34816
    v_mfma_f32_16x16x32_bf16 v[92:95], a[28:31], v[196:199], v[92:95]
    ds_read_b64_tr_b16 a[228:229], v29 offset:32768
    ds_read_b64_tr_b16 a[230:231], v29 offset:34816
    v_mfma_f32_16x16x32_bf16 v[96:99], a[0:3], v[200:203], v[96:99]
    buffer_load_dwordx4 v[128:131], v12, s[44:47], s92 offen sc1
    v_mfma_f32_16x16x32_bf16 v[96:99], a[16:19], v[204:207], v[96:99]
    buffer_load_dwordx4 v[132:135], v12, s[44:47], s93 offen sc1
    v_mfma_f32_16x16x32_bf16 v[100:103], a[4:7], v[200:203], v[100:103]
    s_waitcnt vmcnt(10)
    ds_read_b64_tr_b16 a[80:81], v20 offset:32768
    v_mfma_f32_16x16x32_bf16 v[100:103], a[20:23], v[204:207], v[100:103]
    ds_read_b64_tr_b16 a[82:83], v20 offset:34816
    ds_read_b64_tr_b16 a[84:85], v21 offset:32768
    v_mfma_f32_16x16x32_bf16 v[104:107], a[8:11], v[200:203], v[104:107]
    ds_read_b64_tr_b16 a[86:87], v21 offset:34816
    v_mfma_f32_16x16x32_bf16 v[104:107], a[24:27], v[204:207], v[104:107]
    ds_read_b64_tr_b16 a[88:89], v22 offset:32768
    v_mfma_f32_16x16x32_bf16 v[108:111], a[12:15], v[200:203], v[108:111]
    ds_read_b64_tr_b16 a[90:91], v22 offset:34816
    v_mfma_f32_16x16x32_bf16 v[108:111], a[28:31], v[204:207], v[108:111]
    ds_read_b64_tr_b16 a[92:93], v23 offset:32768
    ds_read_b64_tr_b16 a[94:95], v23 offset:34816
    v_mfma_f32_16x16x32_bf16 v[112:115], a[0:3], v[208:211], v[112:115]
    buffer_load_dwordx4 v[136:139], v12, s[44:47], s86 offen sc1
    ds_read_b64_tr_b16 a[232:233], v30 offset:32768
    v_mfma_f32_16x16x32_bf16 v[112:115], a[16:19], v[212:215], v[112:115]
    ds_read_b64_tr_b16 a[234:235], v30 offset:34816
    ds_read_b64_tr_b16 a[236:237], v31 offset:32768
    v_mfma_f32_16x16x32_bf16 v[116:119], a[4:7], v[208:211], v[116:119]
    ds_read_b64_tr_b16 a[238:239], v31 offset:34816
    ds_read_b64_tr_b16 a[240:241], v28 offset:36864
    v_mfma_f32_16x16x32_bf16 v[116:119], a[20:23], v[212:215], v[116:119]
    ds_read_b64_tr_b16 a[242:243], v28 offset:38912
    ds_read_b64_tr_b16 a[244:245], v29 offset:36864
    v_mfma_f32_16x16x32_bf16 v[120:123], a[8:11], v[208:211], v[120:123]
    buffer_load_dwordx4 v[140:143], v12, s[44:47], s87 offen sc1
    ds_read_b64_tr_b16 a[246:247], v29 offset:38912
    v_mfma_f32_16x16x32_bf16 v[120:123], a[24:27], v[212:215], v[120:123]
    ds_read_b64_tr_b16 a[248:249], v30 offset:36864
    ds_read_b64_tr_b16 a[250:251], v30 offset:38912
    v_mfma_f32_16x16x32_bf16 v[124:127], a[12:15], v[208:211], v[124:127]
    ds_read_b64_tr_b16 a[252:253], v31 offset:36864
    ds_read_b64_tr_b16 a[254:255], v31 offset:38912
    v_mfma_f32_16x16x32_bf16 v[124:127], a[28:31], v[212:215], v[124:127]
    v_xor_b32 v13, 12288, v9
    v_mfma_f32_16x16x32_bf16 v[64:67], a[0:3], v[216:219], v[64:67]
    buffer_load_dwordx4 v[144:147], v4, s[44:47], s92 offen sc1
    v_mfma_f32_16x16x32_bf16 v[64:67], a[16:19], v[220:223], v[64:67]
    v_mfma_f32_16x16x32_bf16 v[68:71], a[4:7], v[216:219], v[68:71]
    v_mfma_f32_16x16x32_bf16 v[68:71], a[20:23], v[220:223], v[68:71]
    v_mfma_f32_16x16x32_bf16 v[72:75], a[8:11], v[216:219], v[72:75]
    buffer_load_dwordx4 v[148:151], v4, s[44:47], s93 offen sc1
    v_mfma_f32_16x16x32_bf16 v[72:75], a[24:27], v[220:223], v[72:75]
    v_mfma_f32_16x16x32_bf16 v[76:79], a[12:15], v[216:219], v[76:79]
    v_mfma_f32_16x16x32_bf16 v[76:79], a[28:31], v[220:223], v[76:79]
    v_mfma_f32_16x16x32_bf16 v[80:83], a[32:35], v[224:227], v[80:83]
    s_waitcnt lgkmcnt(0)
    buffer_load_dwordx4 v[152:155], v4, s[44:47], s86 offen sc1
    ds_read_b64_tr_b16 a[0:1], v28 offset:40960
    v_mfma_f32_16x16x32_bf16 v[80:83], a[48:51], v[228:231], v[80:83]
    ds_read_b64_tr_b16 a[2:3], v28 offset:43008
    ds_read_b64_tr_b16 a[4:5], v29 offset:40960
    v_mfma_f32_16x16x32_bf16 v[84:87], a[36:39], v[224:227], v[84:87]
    ds_read_b64_tr_b16 a[6:7], v29 offset:43008
    ds_read_b64_tr_b16 a[8:9], v30 offset:40960
    v_mfma_f32_16x16x32_bf16 v[84:87], a[52:55], v[228:231], v[84:87]
    ds_read_b64_tr_b16 a[10:11], v30 offset:43008
    ds_read_b64_tr_b16 a[12:13], v31 offset:40960
    v_mfma_f32_16x16x32_bf16 v[88:91], a[40:43], v[224:227], v[88:91]
    buffer_load_dwordx4 v[156:159], v4, s[44:47], s87 offen sc1
    ds_read_b64_tr_b16 a[14:15], v31 offset:43008
    v_mfma_f32_16x16x32_bf16 v[88:91], a[56:59], v[228:231], v[88:91]
    ds_read_b64_tr_b16 a[16:17], v28 offset:45056
    ds_read_b64_tr_b16 a[18:19], v28 offset:47104
    v_mfma_f32_16x16x32_bf16 v[92:95], a[44:47], v[224:227], v[92:95]
    ds_read_b64_tr_b16 a[20:21], v29 offset:45056
    ds_read_b64_tr_b16 a[22:23], v29 offset:47104
    v_mfma_f32_16x16x32_bf16 v[92:95], a[60:63], v[228:231], v[92:95]
    s_waitcnt vmcnt(15)
    ds_read_b64_tr_b16 a[24:25], v30 offset:45056
    ds_read_b64_tr_b16 a[26:27], v30 offset:47104
    v_mfma_f32_16x16x32_bf16 v[80:83], a[64:67], v[232:235], v[80:83]
    s_waitcnt vmcnt(12)
    s_xor_b32 s92, s65, 0
    s_add_u32 s92, s92, s68
    buffer_load_dwordx4 v[160:163], v4, s[44:47], s92 offen sc1
    ds_read_b64_tr_b16 a[28:29], v31 offset:45056
    v_mfma_f32_16x16x32_bf16 v[80:83], a[80:83], v[236:239], v[80:83]
    ds_read_b64_tr_b16 a[30:31], v31 offset:47104
    ds_read_b64 v[48:49], v58 offset:0
    v_mfma_f32_16x16x32_bf16 v[84:87], a[68:71], v[232:235], v[84:87]
    ds_read_b64 v[50:51], v58 offset:32
    ds_read_b64 v[52:53], v58 offset:64
    v_mfma_f32_16x16x32_bf16 v[84:87], a[84:87], v[236:239], v[84:87]
    s_xor_b32 s93, s65, 4096
    ds_read_b64 v[54:55], v58 offset:96
    v_mfma_f32_16x16x32_bf16 v[88:91], a[72:75], v[232:235], v[88:91]
    s_add_u32 s93, s93, s68
    buffer_load_dwordx4 v[164:167], v4, s[44:47], s93 offen sc1
    v_mfma_f32_16x16x32_bf16 v[88:91], a[88:91], v[236:239], v[88:91]
    v_mfma_f32_16x16x32_bf16 v[92:95], a[76:79], v[232:235], v[92:95]
    v_mfma_f32_16x16x32_bf16 v[92:95], a[92:95], v[236:239], v[92:95]
    s_waitcnt vmcnt(13)
    v_mfma_f32_16x16x32_bf16 v[96:99], a[32:35], v[240:243], v[96:99]
    s_xor_b32 s92, s65, 8192
    s_add_u32 s92, s92, s68
    buffer_load_dwordx4 v[168:171], v4, s[44:47], s92 offen sc1
    s_waitcnt vmcnt(13)
    v_mfma_f32_16x16x32_bf16 v[96:99], a[48:51], v[244:247], v[96:99]
    s_waitcnt lgkmcnt(1)
    ds_write_b128 v9, v[80:83] offset:0
    v_lshlrev_b32_e64 v224, 16, v48
    v_mfma_f32_16x16x32_bf16 v[100:103], a[36:39], v[240:243], v[100:103]
    v_and_b32 v225, 0xffff0000, v48
    v_lshlrev_b32_e64 v226, 16, v49
    v_mfma_f32_16x16x32_bf16 v[100:103], a[52:55], v[244:247], v[100:103]
    s_xor_b32 s93, s65, 12288
    v_and_b32 v227, 0xffff0000, v49
    v_lshlrev_b32_e64 v228, 16, v50
    v_mfma_f32_16x16x32_bf16 v[104:107], a[40:43], v[240:243], v[104:107]
    s_add_u32 s93, s93, s68
    buffer_load_dwordx4 v[172:175], v4, s[44:47], s93 offen sc1
    v_mfma_f32_16x16x32_bf16 v[104:107], a[56:59], v[244:247], v[104:107]
    ds_write_b128 v9, v[84:87] offset:1024
    v_and_b32 v229, 0xffff0000, v50
    v_mfma_f32_16x16x32_bf16 v[108:111], a[44:47], v[240:243], v[108:111]
    v_lshlrev_b32 v230, 16, v51
    v_and_b32 v231, 0xffff0000, v51
    v_mfma_f32_16x16x32_bf16 v[108:111], a[60:63], v[244:247], v[108:111]
    s_waitcnt vmcnt(13)
    v_lshlrev_b32 v232, 16, v52
    v_and_b32 v233, 0xffff0000, v52
    v_mfma_f32_16x16x32_bf16 v[96:99], a[64:67], v[248:251], v[96:99]
    s_xor_b32 s92, s65, 16384
    s_add_u32 s92, s92, s68
    buffer_load_dwordx4 v[176:179], v4, s[44:47], s92 offen sc1
    s_waitcnt vmcnt(13)
    v_mfma_f32_16x16x32_bf16 v[96:99], a[80:83], v[252:255], v[96:99]
    ds_write_b128 v9, v[88:91] offset:2048
    v_lshlrev_b32_e64 v234, 16, v53
    v_mfma_f32_16x16x32_bf16 v[100:103], a[68:71], v[248:251], v[100:103]
    s_waitcnt lgkmcnt(3)
    v_and_b32 v235, 0xffff0000, v53
    v_lshlrev_b32 v236, 16, v54
    v_mfma_f32_16x16x32_bf16 v[100:103], a[84:87], v[252:255], v[100:103]
    s_xor_b32 s93, s65, 20480
    v_and_b32 v237, 0xffff0000, v54
    v_lshlrev_b32_e64 v238, 16, v55
    v_mfma_f32_16x16x32_bf16 v[104:107], a[72:75], v[248:251], v[104:107]
    s_add_u32 s93, s93, s68
    buffer_load_dwordx4 v[180:183], v4, s[44:47], s93 offen sc1
    v_mfma_f32_16x16x32_bf16 v[104:107], a[88:91], v[252:255], v[104:107]
    ds_write_b128 v9, v[92:95] offset:3072
    v_and_b32 v239, 0xffff0000, v55
    v_mfma_f32_16x16x32_bf16 v[108:111], a[76:79], v[248:251], v[108:111]
    v_mfma_f32_16x16x32_bf16 v[108:111], a[92:95], v[252:255], v[108:111]
    s_waitcnt vmcnt(13)
    v_mfma_f32_16x16x32_bf16 v[112:115], a[32:35], v[128:131], v[112:115]
    s_xor_b32 s92, s65, 24576
    s_add_u32 s92, s92, s68
    buffer_load_dwordx4 v[184:187], v4, s[44:47], s92 offen sc1
    s_waitcnt vmcnt(13)
    v_mfma_f32_16x16x32_bf16 v[112:115], a[48:51], v[132:135], v[112:115]
    ds_write_b128 v9, v[96:99] offset:16384
    v_mfma_f32_16x16x32_bf16 v[116:119], a[36:39], v[128:131], v[116:119]
    v_mfma_f32_16x16x32_bf16 v[116:119], a[52:55], v[132:135], v[116:119]
    s_xor_b32 s93, s65, 28672
    v_mfma_f32_16x16x32_bf16 v[120:123], a[40:43], v[128:131], v[120:123]
    s_add_u32 s93, s93, s68
    buffer_load_dwordx4 v[188:191], v4, s[44:47], s93 offen sc1
    v_mfma_f32_16x16x32_bf16 v[120:123], a[56:59], v[132:135], v[120:123]
    ds_write_b128 v9, v[100:103] offset:17408
    v_mfma_f32_16x16x32_bf16 v[124:127], a[44:47], v[128:131], v[124:127]
    v_mfma_f32_16x16x32_bf16 v[124:127], a[60:63], v[132:135], v[124:127]
    s_waitcnt vmcnt(13)
    v_mfma_f32_16x16x32_bf16 v[112:115], a[64:67], v[136:139], v[112:115]
    s_xor_b32 s92, s65, 32768
    s_add_u32 s92, s92, s68
    buffer_load_dwordx4 v[192:195], v4, s[44:47], s92 offen sc1
    s_waitcnt vmcnt(13)
    v_mfma_f32_16x16x32_bf16 v[112:115], a[80:83], v[140:143], v[112:115]
    ds_write_b128 v9, v[104:107] offset:18432
    v_mfma_f32_16x16x32_bf16 v[116:119], a[68:71], v[136:139], v[116:119]
    v_mfma_f32_16x16x32_bf16 v[116:119], a[84:87], v[140:143], v[116:119]
    s_xor_b32 s93, s65, 36864
    v_mfma_f32_16x16x32_bf16 v[120:123], a[72:75], v[136:139], v[120:123]
    s_add_u32 s93, s93, s68
    buffer_load_dwordx4 v[196:199], v4, s[44:47], s93 offen sc1
    v_mfma_f32_16x16x32_bf16 v[120:123], a[88:91], v[140:143], v[120:123]
    ds_write_b128 v9, v[108:111] offset:19456
    v_mfma_f32_16x16x32_bf16 v[124:127], a[76:79], v[136:139], v[124:127]
    v_mfma_f32_16x16x32_bf16 v[124:127], a[92:95], v[140:143], v[124:127]
    s_waitcnt vmcnt(13)
    v_mfma_f32_16x16x32_bf16 v[64:67], a[32:35], v[144:147], v[64:67]
    s_xor_b32 s92, s65, 40960
    s_add_u32 s92, s92, s68
    buffer_load_dwordx4 v[200:203], v4, s[44:47], s92 offen sc1
    s_waitcnt vmcnt(13)
    v_mfma_f32_16x16x32_bf16 v[64:67], a[48:51], v[148:151], v[64:67]
    ds_write_b128 v9, v[112:115] offset:32768
    v_mfma_f32_16x16x32_bf16 v[68:71], a[36:39], v[144:147], v[68:71]
    v_mfma_f32_16x16x32_bf16 v[68:71], a[52:55], v[148:151], v[68:71]
    s_xor_b32 s93, s65, 45056
    v_mfma_f32_16x16x32_bf16 v[72:75], a[40:43], v[144:147], v[72:75]
    s_add_u32 s93, s93, s68
    buffer_load_dwordx4 v[204:207], v4, s[44:47], s93 offen sc1
    v_mfma_f32_16x16x32_bf16 v[72:75], a[56:59], v[148:151], v[72:75]
    ds_write_b128 v9, v[116:119] offset:33792
    v_mfma_f32_16x16x32_bf16 v[76:79], a[44:47], v[144:147], v[76:79]
    v_mfma_f32_16x16x32_bf16 v[76:79], a[60:63], v[148:151], v[76:79]
    s_waitcnt vmcnt(13)
    v_mfma_f32_16x16x32_bf16 v[64:67], a[64:67], v[152:155], v[64:67]
    s_xor_b32 s92, s65, 49152
    s_add_u32 s92, s92, s68
    buffer_load_dwordx4 v[208:211], v4, s[44:47], s92 offen sc1
    s_waitcnt vmcnt(13)
    v_mfma_f32_16x16x32_bf16 v[64:67], a[80:83], v[156:159], v[64:67]
    ds_write_b128 v9, v[120:123] offset:34816
    v_mfma_f32_16x16x32_bf16 v[68:71], a[68:71], v[152:155], v[68:71]
    v_mfma_f32_16x16x32_bf16 v[68:71], a[84:87], v[156:159], v[68:71]
    s_xor_b32 s93, s65, 53248
    v_mfma_f32_16x16x32_bf16 v[72:75], a[72:75], v[152:155], v[72:75]
    s_add_u32 s93, s93, s68
    buffer_load_dwordx4 v[212:215], v4, s[44:47], s93 offen sc1
    v_mfma_f32_16x16x32_bf16 v[72:75], a[88:91], v[156:159], v[72:75]
    ds_write_b128 v9, v[124:127] offset:35840
    v_mfma_f32_16x16x32_bf16 v[76:79], a[76:79], v[152:155], v[76:79]
    v_mfma_f32_16x16x32_bf16 v[76:79], a[92:95], v[156:159], v[76:79]
    s_waitcnt vmcnt(13)
    v_mfma_f32_16x16x32_bf16 v[32:35], a[96:99], v[160:163], 0
    s_xor_b32 s92, s65, 57344
    s_add_u32 s92, s92, s68
    buffer_load_dwordx4 v[216:219], v4, s[44:47], s92 offen sc1
    s_waitcnt vmcnt(13)
    v_mfma_f32_16x16x32_bf16 v[32:35], a[112:115], v[164:167], v[32:35]
    s_waitcnt vmcnt(12)
    ds_read_b64_tr_b16 a[32:33], v28 offset:49152
    ds_read_b64_tr_b16 a[34:35], v28 offset:51200
    v_mfma_f32_16x16x32_bf16 v[32:35], a[128:131], v[168:171], v[32:35]
    s_waitcnt vmcnt(11)
    ds_read_b64_tr_b16 a[36:37], v29 offset:49152
    ds_read_b64_tr_b16 a[38:39], v29 offset:51200
    v_mfma_f32_16x16x32_bf16 v[32:35], a[144:147], v[172:175], v[32:35]
    s_xor_b32 s93, s65, 61440
    ds_read_b64_tr_b16 a[40:41], v30 offset:49152
    ds_read_b64_tr_b16 a[42:43], v30 offset:51200
    v_mfma_f32_16x16x32_bf16 v[36:39], a[100:103], v[160:163], 0
    s_add_u32 s93, s93, s68
    buffer_load_dwordx4 v[220:223], v4, s[44:47], s93 offen sc1
    ds_read_b64_tr_b16 a[44:45], v31 offset:49152
    v_mfma_f32_16x16x32_bf16 v[36:39], a[116:119], v[164:167], v[36:39]
    ds_read_b64_tr_b16 a[46:47], v31 offset:51200
    ds_read_b64_tr_b16 a[48:49], v28 offset:53248
    v_mfma_f32_16x16x32_bf16 v[36:39], a[132:135], v[168:171], v[36:39]
    ds_read_b64_tr_b16 a[50:51], v28 offset:55296
    ds_read_b64_tr_b16 a[52:53], v29 offset:53248
    v_mfma_f32_16x16x32_bf16 v[36:39], a[148:151], v[172:175], v[36:39]
    s_waitcnt lgkmcnt(11)
    ds_read_b64_tr_b16 a[54:55], v29 offset:55296
    ds_read_b64_tr_b16 a[56:57], v30 offset:53248
    s_barrier
    v_mfma_f32_16x16x32_bf16 v[40:43], a[104:107], v[160:163], 0
    ds_read_b128 v[80:83], v10 offset:0
    ds_read_b128 v[96:99], v11 offset:16384
    v_mfma_f32_16x16x32_bf16 v[40:43], a[120:123], v[164:167], v[40:43]
    ds_read_b128 v[112:115], v13 offset:32768
    ds_read_b128 v[84:87], v10 offset:1024
    v_mfma_f32_16x16x32_bf16 v[40:43], a[136:139], v[168:171], v[40:43]
    ds_read_b128 v[100:103], v11 offset:17408
    ds_read_b128 v[116:119], v13 offset:33792
    v_mfma_f32_16x16x32_bf16 v[40:43], a[152:155], v[172:175], v[40:43]
    ds_read_b128 v[88:91], v10 offset:2048
    ds_read_b128 v[104:107], v11 offset:18432
    v_mfma_f32_16x16x32_bf16 v[44:47], a[108:111], v[160:163], 0
    ds_read_b128 v[120:123], v13 offset:34816
    ds_read_b128 v[92:95], v10 offset:3072
    v_mfma_f32_16x16x32_bf16 v[44:47], a[124:127], v[164:167], v[44:47]
    ds_read_b128 v[108:111], v11 offset:19456
    ds_read_b128 v[124:127], v13 offset:35840
    v_mfma_f32_16x16x32_bf16 v[44:47], a[140:143], v[168:171], v[44:47]
    ds_read_b64_tr_b16 a[58:59], v30 offset:55296
    ds_read_b64_tr_b16 a[60:61], v31 offset:53248
    v_mfma_f32_16x16x32_bf16 v[44:47], a[156:159], v[172:175], v[44:47]
    s_waitcnt vmcnt(11) lgkmcnt(12)
    ds_read_b64_tr_b16 a[62:63], v31 offset:55296
    ds_read_b64_tr_b16 a[64:65], v28 offset:57344
    v_add_f32_e64 v64, v64, v80
    v_mfma_f32_16x16x32_bf16 v[32:35], a[160:163], v[176:179], v[32:35]
    s_waitcnt vmcnt(10) lgkmcnt(12)
    ds_read_b64_tr_b16 a[66:67], v28 offset:59392
    ds_read_b64_tr_b16 a[68:69], v29 offset:57344
    v_add_f32 v96, v96, v112
    v_mfma_f32_16x16x32_bf16 v[32:35], a[176:179], v[180:183], v[32:35]
    s_waitcnt vmcnt(9)
    ds_read_b64_tr_b16 a[70:71], v29 offset:59392
    ds_read_b64_tr_b16 a[72:73], v30 offset:57344
    v_add_f32 v64, v64, v96
    v_mfma_f32_16x16x32_bf16 v[32:35], a[192:195], v[184:187], v[32:35]
    s_waitcnt vmcnt(8)
    ds_read_b64_tr_b16 a[74:75], v30 offset:59392
    ds_read_b64_tr_b16 a[76:77], v31 offset:57344
    v_mul_f32 v80, s76, v64
    v_mfma_f32_16x16x32_bf16 v[32:35], a[208:211], v[188:191], v[32:35]
    ds_read_b64_tr_b16 a[78:79], v31 offset:59392
    ds_read_b64_tr_b16 a[80:81], v28 offset:61440
    v_add_f32_e64 v65, v65, v81
    v_mfma_f32_16x16x32_bf16 v[36:39], a[164:167], v[176:179], v[36:39]
    ds_read_b64_tr_b16 a[82:83], v28 offset:63488
    ds_read_b64_tr_b16 a[84:85], v29 offset:61440
    v_add_f32_e64 v97, v97, v113
    v_mfma_f32_16x16x32_bf16 v[36:39], a[180:183], v[180:183], v[36:39]
    ds_read_b64_tr_b16 a[86:87], v29 offset:63488
    ds_read_b64_tr_b16 a[88:89], v30 offset:61440
    v_add_f32_e64 v65, v65, v97
    v_mfma_f32_16x16x32_bf16 v[36:39], a[196:199], v[184:187], v[36:39]
    ds_read_b64_tr_b16 a[90:91], v30 offset:63488
    ds_read_b64_tr_b16 a[92:93], v31 offset:61440
    v_mul_f32_e64 v81, s76, v65
    v_mfma_f32_16x16x32_bf16 v[36:39], a[212:215], v[188:191], v[36:39]
    ds_read_b64_tr_b16 a[94:95], v31 offset:63488
    v_exp_f32 v80, v80
    v_add_f32 v66, v66, v82
    v_mfma_f32_16x16x32_bf16 v[40:43], a[168:171], v[176:179], v[40:43]
    v_exp_f32 v81, v81
    v_add_f32 v80, 1.0, v80
    v_add_f32_e64 v98, v98, v114
    v_mfma_f32_16x16x32_bf16 v[40:43], a[184:187], v[180:183], v[40:43]
    v_rcp_f32 v80, v80
    v_add_f32 v81, 1.0, v81
    v_add_f32_e64 v66, v66, v98
    v_mfma_f32_16x16x32_bf16 v[40:43], a[200:203], v[184:187], v[40:43]
    v_rcp_f32 v81, v81
    v_mul_f32 v64, v64, v80
    v_mul_f32_e64 v82, s76, v66
    v_mfma_f32_16x16x32_bf16 v[40:43], a[216:219], v[188:191], v[40:43]
    v_exp_f32 v82, v82
    v_mul_f32 v65, v65, v81
    v_add_f32_e64 v67, v67, v83
    v_mfma_f32_16x16x32_bf16 v[44:47], a[172:175], v[176:179], v[44:47]
    v_add_f32 v82, 1.0, v82
    v_rcp_f32 v82, v82
    v_add_f32_e64 v99, v99, v115
    v_mfma_f32_16x16x32_bf16 v[44:47], a[188:191], v[180:183], v[44:47]
    v_mul_f32 v66, v66, v82
    v_add_f32 v67, v67, v99
    v_mul_f32 v83, s76, v67
    v_add_f32 v68, v68, v84
    v_mfma_f32_16x16x32_bf16 v[44:47], a[204:207], v[184:187], v[44:47]
    s_waitcnt lgkmcnt(0)
    v_exp_f32 v83, v83
    v_add_f32 v100, v100, v116
    v_add_f32 v68, v68, v100
    v_mfma_f32_16x16x32_bf16 v[44:47], a[220:223], v[188:191], v[44:47]
    s_waitcnt vmcnt(7)
    v_add_f32 v83, 1.0, v83
    v_rcp_f32 v83, v83
    v_mul_f32 v84, s76, v68
    v_mfma_f32_16x16x32_bf16 v[32:35], a[224:227], v[192:195], v[32:35]
    s_waitcnt vmcnt(6)
    v_exp_f32 v84, v84
    v_mul_f32 v67, v67, v83
    v_add_f32 v69, v69, v85
    v_mfma_f32_16x16x32_bf16 v[32:35], a[240:243], v[196:199], v[32:35]
    s_waitcnt vmcnt(5)
    v_add_f32 v84, 1.0, v84
    v_rcp_f32 v84, v84
    v_add_f32 v101, v101, v117
    v_mfma_f32_16x16x32_bf16 v[32:35], a[0:3], v[200:203], v[32:35]
    s_waitcnt vmcnt(4)
    v_mul_f32 v68, v68, v84
    v_add_f32 v69, v69, v101
    v_mul_f32 v85, s76, v69
    v_add_f32_e64 v70, v70, v86
    v_mfma_f32_16x16x32_bf16 v[32:35], a[16:19], v[204:207], v[32:35]
    v_exp_f32 v85, v85
    v_add_f32 v102, v102, v118
    v_add_f32_e64 v70, v70, v102
    v_mfma_f32_16x16x32_bf16 v[36:39], a[228:231], v[192:195], v[36:39]
    v_add_f32 v85, 1.0, v85
    v_rcp_f32 v85, v85
    v_mul_f32_e64 v86, s76, v70
    v_mfma_f32_16x16x32_bf16 v[36:39], a[244:247], v[196:199], v[36:39]
    v_exp_f32 v86, v86
    v_mul_f32 v69, v69, v85
    v_add_f32_e64 v71, v71, v87
    v_mfma_f32_16x16x32_bf16 v[36:39], a[4:7], v[200:203], v[36:39]
    v_add_f32 v86, 1.0, v86
    v_rcp_f32 v86, v86
    v_add_f32_e64 v103, v103, v119
    v_mfma_f32_16x16x32_bf16 v[36:39], a[20:23], v[204:207], v[36:39]
    v_mul_f32 v70, v70, v86
    v_add_f32 v71, v71, v103
    v_mul_f32 v87, s76, v71
    v_add_f32 v72, v72, v88
    v_mfma_f32_16x16x32_bf16 v[40:43], a[232:235], v[192:195], v[40:43]
    v_exp_f32 v87, v87
    v_add_f32 v104, v104, v120
    v_add_f32_e64 v72, v72, v104
    v_mfma_f32_16x16x32_bf16 v[40:43], a[248:251], v[196:199], v[40:43]
    v_add_f32 v87, 1.0, v87
    v_rcp_f32 v87, v87
    v_mul_f32_e64 v88, s76, v72
    v_mfma_f32_16x16x32_bf16 v[40:43], a[8:11], v[200:203], v[40:43]
    v_exp_f32 v88, v88
    v_mul_f32 v71, v71, v87
    v_add_f32_e64 v73, v73, v89
    v_mfma_f32_16x16x32_bf16 v[40:43], a[24:27], v[204:207], v[40:43]
    v_add_f32 v88, 1.0, v88
    v_rcp_f32 v88, v88
    v_add_f32_e64 v105, v105, v121
    v_mfma_f32_16x16x32_bf16 v[44:47], a[236:239], v[192:195], v[44:47]
    v_mul_f32 v72, v72, v88
    v_add_f32 v73, v73, v105
    v_mul_f32 v89, s76, v73
    v_add_f32 v74, v74, v90
    v_mfma_f32_16x16x32_bf16 v[44:47], a[252:255], v[196:199], v[44:47]
    v_exp_f32 v89, v89
    v_add_f32 v106, v106, v122
    v_add_f32_e64 v74, v74, v106
    v_mfma_f32_16x16x32_bf16 v[44:47], a[12:15], v[200:203], v[44:47]
    v_add_f32 v89, 1.0, v89
    v_rcp_f32 v89, v89
    v_mul_f32_e64 v90, s76, v74
    v_mfma_f32_16x16x32_bf16 v[44:47], a[28:31], v[204:207], v[44:47]
    s_waitcnt vmcnt(3)
    v_exp_f32 v90, v90
    v_mul_f32 v73, v73, v89
    v_add_f32 v75, v75, v91
    v_mfma_f32_16x16x32_bf16 v[32:35], a[32:35], v[208:211], v[32:35]
    s_waitcnt vmcnt(2)
    v_add_f32 v90, 1.0, v90
    v_rcp_f32 v90, v90
    v_add_f32 v107, v107, v123
    v_mfma_f32_16x16x32_bf16 v[32:35], a[48:51], v[212:215], v[32:35]
    s_waitcnt vmcnt(1)
    v_mul_f32 v74, v74, v90
    v_add_f32 v75, v75, v107
    v_mul_f32 v91, s76, v75
    v_add_f32_e64 v76, v76, v92
    v_mfma_f32_16x16x32_bf16 v[32:35], a[64:67], v[216:219], v[32:35]
    s_waitcnt vmcnt(0)
    v_exp_f32 v91, v91
    v_add_f32 v108, v108, v124
    v_add_f32 v76, v76, v108
    v_mfma_f32_16x16x32_bf16 v[32:35], a[80:83], v[220:223], v[32:35]
    v_add_f32 v91, 1.0, v91
    v_rcp_f32 v91, v91
    v_mul_f32_e64 v92, s76, v76
    v_mfma_f32_16x16x32_bf16 v[36:39], a[36:39], v[208:211], v[36:39]
    v_exp_f32 v92, v92
    v_mul_f32 v75, v75, v91
    v_add_f32_e64 v77, v77, v93
    v_mfma_f32_16x16x32_bf16 v[36:39], a[52:55], v[212:215], v[36:39]
    v_add_f32 v92, 1.0, v92
    v_rcp_f32 v92, v92
    v_add_f32_e64 v109, v109, v125
    v_mfma_f32_16x16x32_bf16 v[36:39], a[68:71], v[216:219], v[36:39]
    v_mul_f32 v76, v76, v92
    v_add_f32 v77, v77, v109
    v_mul_f32 v93, s76, v77
    v_add_f32 v78, v78, v94
    v_mfma_f32_16x16x32_bf16 v[36:39], a[84:87], v[220:223], v[36:39]
    v_exp_f32 v93, v93
    v_add_f32 v110, v110, v126
    v_add_f32_e64 v78, v78, v110
    v_mfma_f32_16x16x32_bf16 v[40:43], a[40:43], v[208:211], v[40:43]
    v_add_f32 v93, 1.0, v93
    v_rcp_f32 v93, v93
    v_mul_f32_e64 v94, s76, v78
    v_mfma_f32_16x16x32_bf16 v[40:43], a[56:59], v[212:215], v[40:43]
    v_exp_f32 v94, v94
    v_mul_f32 v77, v77, v93
    v_add_f32_e64 v79, v79, v95
    v_mfma_f32_16x16x32_bf16 v[40:43], a[72:75], v[216:219], v[40:43]
    v_add_f32 v94, 1.0, v94
    v_rcp_f32 v94, v94
    v_add_f32_e64 v111, v111, v127
    v_mfma_f32_16x16x32_bf16 v[40:43], a[88:91], v[220:223], v[40:43]
    v_mul_f32 v78, v78, v94
    v_add_f32 v79, v79, v111
    v_mul_f32_e64 v95, s76, v79
    v_fma_f32 v32, v32, v64, v224
    v_mfma_f32_16x16x32_bf16 v[44:47], a[44:47], v[208:211], v[44:47]
    v_exp_f32_e64 v95, v95
    v_fma_f32 v33, v33, v65, v225
    v_fma_f32 v34, v34, v66, v226
    v_mfma_f32_16x16x32_bf16 v[44:47], a[60:63], v[212:215], v[44:47]
    v_add_f32 v95, 1.0, v95
    v_rcp_f32 v95, v95
    v_fma_f32 v35, v35, v67, v227
    v_mfma_f32_16x16x32_bf16 v[44:47], a[76:79], v[216:219], v[44:47]
    v_mul_f32_e64 v79, v79, v95
    v_cvt_pk_bf16_f32 v32, v32, v33
    v_cvt_pk_bf16_f32 v33, v34, v35
    v_fma_f32 v36, v36, v68, v228
    v_mfma_f32_16x16x32_bf16 v[44:47], a[92:95], v[220:223], v[44:47]
    ds_write_b64 v57, v[32:33] offset:0
    v_fma_f32 v37, v37, v69, v229
    v_fma_f32 v38, v38, v70, v230
    v_fma_f32 v39, v39, v71, v231
    v_cvt_pk_bf16_f32 v36, v36, v37
    v_cvt_pk_bf16_f32 v37, v38, v39
    ds_write_b64 v57, v[36:37] offset:32
    v_fma_f32 v40, v40, v72, v232
    v_fma_f32 v41, v41, v73, v233
    v_fma_f32 v42, v42, v74, v234
    v_fma_f32 v43, v43, v75, v235
    v_cvt_pk_bf16_f32 v40, v40, v41
    v_cvt_pk_bf16_f32 v41, v42, v43
    v_fma_f32 v44, v44, v76, v236
    ds_write_b64 v57, v[40:41] offset:64
    v_fma_f32 v45, v45, v77, v237
    v_fma_f32 v46, v46, v78, v238
    v_fma_f32 v47, v47, v79, v239
    v_cvt_pk_bf16_f32 v44, v44, v45
    v_cvt_pk_bf16_f32 v45, v46, v47
    ds_write_b64 v57, v[44:45] offset:96
    ds_read_b128 v[96:99], v56 offset:0
    ds_read_b128 v[100:103], v56 offset:1152
    s_add_u32 s59, s91, 8192
    s_waitcnt lgkmcnt(1)
    buffer_store_dwordx4 v[96:99], v8, s[36:39], s91 offen sc1
    s_waitcnt lgkmcnt(0)
    buffer_store_dwordx4 v[100:103], v8, s[36:39], s59 offen sc1
    s_endpgm
L_k_retry0:
    s_mov_b32 s85, 0x40000
L_k_retry0_loop:
    s_sleep 1
    buffer_load_dword v17, v3, s[40:43], 0 offen sc1
    s_waitcnt vmcnt(0)
    v_cmp_gt_u32 vcc, 1, v17
    s_nop 1
    s_and_b32 vcc_lo, vcc_lo, 0xff
    s_cbranch_scc0 L_k_back0
    s_sub_u32 s85, s85, 1
    s_cbranch_scc0 L_k_retry0_loop
    s_branch L_k_back0
L_k_retry1:
    s_mov_b32 s85, 0x40000
L_k_retry1_loop:
    s_sleep 1
    buffer_load_dword v17, v3, s[48:51], s90 offen sc1
    s_waitcnt vmcnt(0)
    v_cmp_gt_u32 vcc, 1, v17
    s_nop 1
    s_and_b32 vcc_lo, vcc_lo, 0xff00
    s_cbranch_scc0 L_k_back1
    s_sub_u32 s85, s85, 1
    s_cbranch_scc0 L_k_retry1_loop
    s_branch L_k_back1
L_k_retry2:
    s_mov_b32 s85, 0x40000
L_k_retry2_loop:
    s_sleep 1
    buffer_load_dword v17, v3, s[48:51], s90 offen sc1
    s_waitcnt vmcnt(0)
    v_cmp_gt_u32 vcc, 1, v17
    s_nop 1
    s_and_b32 vcc_lo, vcc_lo, 0xff
    s_cbranch_scc0 L_k_back2
    s_sub_u32 s85, s85, 1
    s_cbranch_scc0 L_k_retry2_loop
    s_branch L_k_back2
L_k_retry3:
    s_mov_b32 s85, 0x40000
L_k_retry3_loop:
    s_sleep 1
    buffer_load_dword v17, v3, s[48:51], s90 offen sc1
    s_waitcnt vmcnt(0)
    v_cmp_gt_u32 vcc, 2, v17
    s_nop 1
    s_and_b32 vcc_lo, vcc_lo, 0xff00
    s_cbranch_scc0 L_k_back3
    s_sub_u32 s85, s85, 1
    s_cbranch_scc0 L_k_retry3_loop
    s_branch L_k_back3
L_k_retry4:
    s_mov_b32 s85, 0x40000
L_k_retry4_loop:
    s_sleep 1
    buffer_load_dword v17, v3, s[48:51], s90 offen sc1
    s_waitcnt vmcnt(0)
    v_cmp_gt_u32 vcc, 2, v17
    s_nop 1
    s_and_b32 vcc_lo, vcc_lo, 0xff
    s_cbranch_scc0 L_k_back4
    s_sub_u32 s85, s85, 1
    s_cbranch_scc0 L_k_retry4_loop
    s_branch L_k_back4
L_end:
    s_endpgm
.p2align 6
L_trace_q:
    s_waitcnt vmcnt(6)
    s_nop 0
    buffer_load_dwordx4 v[152:155], v53, s[8:11], s73 offen offset:0
    buffer_load_dwordx4 v[156:159], v53, s[8:11], s73 offen offset:128
    buffer_load_dwordx4 v[208:211], v54, s[8:11], s73 offen offset:0
    buffer_load_dwordx4 v[212:215], v54, s[8:11], s73 offen offset:128
    v_dot2_f32_bf16 v36, v128, s77, 0
    v_dot2_f32_bf16 v37, v128, v128, 0
    v_dot2_f32_bf16 v36, v129, s77, v36
    v_dot2_f32_bf16 v37, v129, v129, v37
    v_dot2_f32_bf16 v36, v130, s77, v36
    v_dot2_f32_bf16 v37, v130, v130, v37
    v_dot2_f32_bf16 v36, v131, s77, v36
    v_dot2_f32_bf16 v37, v131, v131, v37
    v_dot2_f32_bf16 v36, v132, s77, v36
    v_dot2_f32_bf16 v37, v132, v132, v37
    v_dot2_f32_bf16 v36, v133, s77, v36
    v_dot2_f32_bf16 v37, v133, v133, v37
    v_dot2_f32_bf16 v36, v134, s77, v36
    v_dot2_f32_bf16 v37, v134, v134, v37
    v_dot2_f32_bf16 v36, v135, s77, v36
    v_dot2_f32_bf16 v37, v135, v135, v37
    v_dot2_f32_bf16 v36, v136, s77, v36
    v_dot2_f32_bf16 v37, v136, v136, v37
    v_dot2_f32_bf16 v36, v137, s77, v36
    v_dot2_f32_bf16 v37, v137, v137, v37
    v_dot2_f32_bf16 v36, v138, s77, v36
    v_dot2_f32_bf16 v37, v138, v138, v37
    v_dot2_f32_bf16 v36, v139, s77, v36
    v_dot2_f32_bf16 v37, v139, v139, v37
    v_dot2_f32_bf16 v36, v140, s77, v36
    v_dot2_f32_bf16 v37, v140, v140, v37
    v_dot2_f32_bf16 v36, v141, s77, v36
    v_dot2_f32_bf16 v37, v141, v141, v37
    v_dot2_f32_bf16 v36, v142, s77, v36
    v_dot2_f32_bf16 v37, v142, v142, v37
    v_dot2_f32_bf16 v36, v143, s77, v36
    v_dot2_f32_bf16 v37, v143, v143, v37
    s_waitcnt vmcnt(6)
    s_nop 0
    buffer_load_dwordx4 v[216:219], v55, s[8:11], s73 offen offset:0
    buffer_load_dwordx4 v[220:223], v55, s[8:11], s73 offen offset:128
    s_xor_b32 s73, s72, 16384
    buffer_load_dwordx4 v[160:163], v52, s[8:11], s73 offen offset:0
    buffer_load_dwordx4 v[164:167], v52, s[8:11], s73 offen offset:128
    s_mov_b32 m0, s68
    s_nop 0
    buffer_load_dwordx4 v2, s[32:35], s62 offen lds
    v_dot2_f32_bf16 v36, v192, s77, v36
    v_dot2_f32_bf16 v37, v192, v192, v37
    v_dot2_f32_bf16 v36, v193, s77, v36
    v_dot2_f32_bf16 v37, v193, v193, v37
    v_dot2_f32_bf16 v36, v194, s77, v36
    v_dot2_f32_bf16 v37, v194, v194, v37
    v_dot2_f32_bf16 v36, v195, s77, v36
    v_dot2_f32_bf16 v37, v195, v195, v37
    v_dot2_f32_bf16 v36, v196, s77, v36
    v_dot2_f32_bf16 v37, v196, v196, v37
    v_dot2_f32_bf16 v36, v197, s77, v36
    v_dot2_f32_bf16 v37, v197, v197, v37
    v_dot2_f32_bf16 v36, v198, s77, v36
    v_dot2_f32_bf16 v37, v198, v198, v37
    v_dot2_f32_bf16 v36, v199, s77, v36
    v_dot2_f32_bf16 v37, v199, v199, v37
    v_dot2_f32_bf16 v36, v200, s77, v36
    v_dot2_f32_bf16 v37, v200, v200, v37
    v_dot2_f32_bf16 v36, v201, s77, v36
    v_dot2_f32_bf16 v37, v201, v201, v37
    v_dot2_f32_bf16 v36, v202, s77, v36
    v_dot2_f32_bf16 v37, v202, v202, v37
    v_dot2_f32_bf16 v36, v203, s77, v36
    v_dot2_f32_bf16 v37, v203, v203, v37
    v_dot2_f32_bf16 v36, v204, s77, v36
    v_dot2_f32_bf16 v37, v204, v204, v37
    v_dot2_f32_bf16 v36, v205, s77, v36
    v_dot2_f32_bf16 v37, v205, v205, v37
    v_dot2_f32_bf16 v36, v206, s77, v36
    v_dot2_f32_bf16 v37, v206, v206, v37
    v_dot2_f32_bf16 v36, v207, s77, v36
    v_dot2_f32_bf16 v37, v207, v207, v37
    s_nop 1
    v_add_f32_dpp v36, v36, v36 quad_perm:[1,0,3,2] row_mask:0xf bank_mask:0xf
    v_add_f32_dpp v37, v37, v37 quad_perm:[1,0,3,2] row_mask:0xf bank_mask:0xf
    s_nop 0
    v_add_f32_dpp v36, v36, v36 quad_perm:[2,3,0,1] row_mask:0xf bank_mask:0xf
    v_add_f32_dpp v37, v37, v37 quad_perm:[2,3,0,1] row_mask:0xf bank_mask:0xf
    s_nop 0
    v_add_f32_dpp v36, v36, v36 row_half_mirror row_mask:0xf bank_mask:0xf
    v_add_f32_dpp v37, v37, v37 row_half_mirror row_mask:0xf bank_mask:0xf
    v_mul_f32 v38, s81, v36
    v_mul_f32_e64 v39, v38, v38
    v_fma_f32 v39, v37, s81, -v39
    v_max_f32 v39, 0, v39
    v_add_f32 v39, s82, v39
    v_rsq_f32 v39, v39
    s_nop 0
    v_cvt_pk_bf16_f32 v40, v39, 0
    v_lshlrev_b32_e64 v41, 16, v40
    v_mul_f32 v42, -v38, v41
    v_dot2_f32_bf16 v64, v128, v40, v42
    v_dot2_f32_bf16 v65, v128, v41, v42
    v_dot2_f32_bf16 v66, v129, v40, v42
    v_dot2_f32_bf16 v67, v129, v41, v42
    v_dot2_f32_bf16 v68, v130, v40, v42
    v_dot2_f32_bf16 v69, v130, v41, v42
    v_dot2_f32_bf16 v70, v131, v40, v42
    v_dot2_f32_bf16 v71, v131, v41, v42
    v_cvt_pk_bf16_f32 v128, v64, v65
    v_cvt_pk_bf16_f32 v129, v66, v67
    v_cvt_pk_bf16_f32 v130, v68, v69
    v_cvt_pk_bf16_f32 v131, v70, v71
    ds_write_b128 v4, v[128:131] offset:32768
    v_dot2_f32_bf16 v72, v132, v40, v42
    v_dot2_f32_bf16 v73, v132, v41, v42
    v_dot2_f32_bf16 v74, v133, v40, v42
    v_dot2_f32_bf16 v75, v133, v41, v42
    v_dot2_f32_bf16 v76, v134, v40, v42
    v_dot2_f32_bf16 v77, v134, v41, v42
    v_dot2_f32_bf16 v78, v135, v40, v42
    v_dot2_f32_bf16 v79, v135, v41, v42
    v_cvt_pk_bf16_f32 v132, v72, v73
    v_cvt_pk_bf16_f32 v133, v74, v75
    v_cvt_pk_bf16_f32 v134, v76, v77
    v_cvt_pk_bf16_f32 v135, v78, v79
    ds_write_b128 v4, v[132:135] offset:34816
    v_dot2_f32_bf16 v64, v136, v40, v42
    v_dot2_f32_bf16 v65, v136, v41, v42
    v_dot2_f32_bf16 v66, v137, v40, v42
    v_dot2_f32_bf16 v67, v137, v41, v42
    v_dot2_f32_bf16 v68, v138, v40, v42
    v_dot2_f32_bf16 v69, v138, v41, v42
    v_dot2_f32_bf16 v70, v139, v40, v42
    v_dot2_f32_bf16 v71, v139, v41, v42
    v_cvt_pk_bf16_f32 v136, v64, v65
    v_cvt_pk_bf16_f32 v137, v66, v67
    v_cvt_pk_bf16_f32 v138, v68, v69
    v_cvt_pk_bf16_f32 v139, v70, v71
    ds_write_b128 v63, v[136:139] offset:0
    v_dot2_f32_bf16 v72, v140, v40, v42
    v_dot2_f32_bf16 v73, v140, v41, v42
    v_dot2_f32_bf16 v74, v141, v40, v42
    v_dot2_f32_bf16 v75, v141, v41, v42
    v_dot2_f32_bf16 v76, v142, v40, v42
    v_dot2_f32_bf16 v77, v142, v41, v42
    v_dot2_f32_bf16 v78, v143, v40, v42
    v_dot2_f32_bf16 v79, v143, v41, v42
    v_cvt_pk_bf16_f32 v140, v72, v73
    v_cvt_pk_bf16_f32 v141, v74, v75
    v_cvt_pk_bf16_f32 v142, v76, v77
    v_cvt_pk_bf16_f32 v143, v78, v79
    ds_write_b128 v63, v[140:143] offset:2048
    v_dot2_f32_bf16 v64, v192, v40, v42
    v_dot2_f32_bf16 v65, v192, v41, v42
    v_dot2_f32_bf16 v66, v193, v40, v42
    v_dot2_f32_bf16 v67, v193, v41, v42
    v_dot2_f32_bf16 v68, v194, v40, v42
    v_dot2_f32_bf16 v69, v194, v41, v42
    v_dot2_f32_bf16 v70, v195, v40, v42
    v_dot2_f32_bf16 v71, v195, v41, v42
    v_cvt_pk_bf16_f32 v192, v64, v65
    v_cvt_pk_bf16_f32 v193, v66, v67
    v_cvt_pk_bf16_f32 v194, v68, v69
    v_cvt_pk_bf16_f32 v195, v70, v71
    buffer_load_dwordx4 v[168:171], v53, s[8:11], s73 offen offset:0
    buffer_load_dwordx4 v[172:175], v53, s[8:11], s73 offen offset:128
    ds_write_b128 v4, v[192:195] offset:0
    v_dot2_f32_bf16 v72, v196, v40, v42
    v_dot2_f32_bf16 v73, v196, v41, v42
    v_dot2_f32_bf16 v74, v197, v40, v42
    v_dot2_f32_bf16 v75, v197, v41, v42
    v_dot2_f32_bf16 v76, v198, v40, v42
    v_dot2_f32_bf16 v77, v198, v41, v42
    v_dot2_f32_bf16 v78, v199, v40, v42
    v_dot2_f32_bf16 v79, v199, v41, v42
    v_cvt_pk_bf16_f32 v196, v72, v73
    v_cvt_pk_bf16_f32 v197, v74, v75
    v_cvt_pk_bf16_f32 v198, v76, v77
    v_cvt_pk_bf16_f32 v199, v78, v79
    ds_write_b128 v4, v[196:199] offset:2048
    v_dot2_f32_bf16 v64, v200, v40, v42
    v_dot2_f32_bf16 v65, v200, v41, v42
    v_dot2_f32_bf16 v66, v201, v40, v42
    v_dot2_f32_bf16 v67, v201, v41, v42
    v_dot2_f32_bf16 v68, v202, v40, v42
    v_dot2_f32_bf16 v69, v202, v41, v42
    v_dot2_f32_bf16 v70, v203, v40, v42
    v_dot2_f32_bf16 v71, v203, v41, v42
    v_cvt_pk_bf16_f32 v200, v64, v65
    v_cvt_pk_bf16_f32 v201, v66, v67
    v_cvt_pk_bf16_f32 v202, v68, v69
    v_cvt_pk_bf16_f32 v203, v70, v71
    buffer_load_dwordx4 v[224:227], v54, s[8:11], s73 offen offset:0
    buffer_load_dwordx4 v[228:231], v54, s[8:11], s73 offen offset:128
    v_dot2_f32_bf16 v72, v204, v40, v42
    v_dot2_f32_bf16 v73, v204, v41, v42
    v_dot2_f32_bf16 v74, v205, v40, v42
    v_dot2_f32_bf16 v75, v205, v41, v42
    v_dot2_f32_bf16 v76, v206, v40, v42
    v_dot2_f32_bf16 v77, v206, v41, v42
    v_dot2_f32_bf16 v78, v207, v40, v42
    v_dot2_f32_bf16 v79, v207, v41, v42
    v_cvt_pk_bf16_f32 v204, v72, v73
    v_cvt_pk_bf16_f32 v205, v74, v75
    v_cvt_pk_bf16_f32 v206, v76, v77
    v_cvt_pk_bf16_f32 v207, v78, v79
    s_waitcnt vmcnt(11)
    s_nop 0
    buffer_load_dwordx4 v[232:235], v55, s[8:11], s73 offen offset:0
    v_dot2_f32_bf16 v44, v144, s77, 0
    v_dot2_f32_bf16 v45, v144, v144, 0
    v_dot2_f32_bf16 v44, v145, s77, v44
    v_dot2_f32_bf16 v45, v145, v145, v45
    v_dot2_f32_bf16 v44, v146, s77, v44
    v_dot2_f32_bf16 v45, v146, v146, v45
    v_dot2_f32_bf16 v44, v147, s77, v44
    v_dot2_f32_bf16 v45, v147, v147, v45
    v_dot2_f32_bf16 v44, v148, s77, v44
    v_dot2_f32_bf16 v45, v148, v148, v45
    v_dot2_f32_bf16 v44, v149, s77, v44
    v_dot2_f32_bf16 v45, v149, v149, v45
    v_dot2_f32_bf16 v44, v150, s77, v44
    v_dot2_f32_bf16 v45, v150, v150, v45
    v_dot2_f32_bf16 v44, v151, s77, v44
    v_dot2_f32_bf16 v45, v151, v151, v45
    v_dot2_f32_bf16 v44, v152, s77, v44
    v_dot2_f32_bf16 v45, v152, v152, v45
    v_dot2_f32_bf16 v44, v153, s77, v44
    v_dot2_f32_bf16 v45, v153, v153, v45
    v_dot2_f32_bf16 v44, v154, s77, v44
    v_dot2_f32_bf16 v45, v154, v154, v45
    v_dot2_f32_bf16 v44, v155, s77, v44
    v_dot2_f32_bf16 v45, v155, v155, v45
    v_dot2_f32_bf16 v44, v156, s77, v44
    v_dot2_f32_bf16 v45, v156, v156, v45
    v_dot2_f32_bf16 v44, v157, s77, v44
    v_dot2_f32_bf16 v45, v157, v157, v45
    v_dot2_f32_bf16 v44, v158, s77, v44
    v_dot2_f32_bf16 v45, v158, v158, v45
    v_dot2_f32_bf16 v44, v159, s77, v44
    v_dot2_f32_bf16 v45, v159, v159, v45
    s_waitcnt vmcnt(8)
    s_nop 0
    buffer_load_dwordx4 v[236:239], v55, s[8:11], s73 offen offset:128
    s_xor_b32 s73, s72, 24576
    buffer_load_dwordx4 v[176:179], v52, s[8:11], s73 offen offset:0
    v_dot2_f32_bf16 v44, v208, s77, v44
    v_dot2_f32_bf16 v45, v208, v208, v45
    v_dot2_f32_bf16 v44, v209, s77, v44
    v_dot2_f32_bf16 v45, v209, v209, v45
    v_dot2_f32_bf16 v44, v210, s77, v44
    v_dot2_f32_bf16 v45, v210, v210, v45
    v_dot2_f32_bf16 v44, v211, s77, v44
    v_dot2_f32_bf16 v45, v211, v211, v45
    v_dot2_f32_bf16 v44, v212, s77, v44
    v_dot2_f32_bf16 v45, v212, v212, v45
    v_dot2_f32_bf16 v44, v213, s77, v44
    v_dot2_f32_bf16 v45, v213, v213, v45
    v_dot2_f32_bf16 v44, v214, s77, v44
    v_dot2_f32_bf16 v45, v214, v214, v45
    v_dot2_f32_bf16 v44, v215, s77, v44
    v_dot2_f32_bf16 v45, v215, v215, v45
    v_dot2_f32_bf16 v44, v216, s77, v44
    v_dot2_f32_bf16 v45, v216, v216, v45
    v_dot2_f32_bf16 v44, v217, s77, v44
    v_dot2_f32_bf16 v45, v217, v217, v45
    v_dot2_f32_bf16 v44, v218, s77, v44
    v_dot2_f32_bf16 v45, v218, v218, v45
    v_dot2_f32_bf16 v44, v219, s77, v44
    v_dot2_f32_bf16 v45, v219, v219, v45
    v_dot2_f32_bf16 v44, v220, s77, v44
    v_dot2_f32_bf16 v45, v220, v220, v45
    v_dot2_f32_bf16 v44, v221, s77, v44
    v_dot2_f32_bf16 v45, v221, v221, v45
    v_dot2_f32_bf16 v44, v222, s77, v44
    v_dot2_f32_bf16 v45, v222, v222, v45
    v_dot2_f32_bf16 v44, v223, s77, v44
    v_dot2_f32_bf16 v45, v223, v223, v45
    s_nop 1
    v_add_f32_dpp v44, v44, v44 quad_perm:[1,0,3,2] row_mask:0xf bank_mask:0xf
    v_add_f32_dpp v45, v45, v45 quad_perm:[1,0,3,2] row_mask:0xf bank_mask:0xf
    s_nop 0
    v_add_f32_dpp v44, v44, v44 quad_perm:[2,3,0,1] row_mask:0xf bank_mask:0xf
    v_add_f32_dpp v45, v45, v45 quad_perm:[2,3,0,1] row_mask:0xf bank_mask:0xf
    s_nop 0
    v_add_f32_dpp v44, v44, v44 row_half_mirror row_mask:0xf bank_mask:0xf
    v_add_f32_dpp v45, v45, v45 row_half_mirror row_mask:0xf bank_mask:0xf
    v_mul_f32 v46, s81, v44
    v_mul_f32_e64 v47, v46, v46
    v_fma_f32 v47, v45, s81, -v47
    v_max_f32 v47, 0, v47
    v_add_f32 v47, s82, v47
    v_rsq_f32 v47, v47
    s_nop 0
    v_cvt_pk_bf16_f32 v48, v47, 0
    v_lshlrev_b32_e64 v49, 16, v48
    v_mul_f32 v50, -v46, v49
    v_dot2_f32_bf16 v64, v144, v48, v50
    v_dot2_f32_bf16 v65, v144, v49, v50
    v_dot2_f32_bf16 v66, v145, v48, v50
    v_dot2_f32_bf16 v67, v145, v49, v50
    v_dot2_f32_bf16 v68, v146, v48, v50
    v_dot2_f32_bf16 v69, v146, v49, v50
    v_dot2_f32_bf16 v70, v147, v48, v50
    v_dot2_f32_bf16 v71, v147, v49, v50
    v_cvt_pk_bf16_f32 v144, v64, v65
    v_cvt_pk_bf16_f32 v145, v66, v67
    v_cvt_pk_bf16_f32 v146, v68, v69
    v_cvt_pk_bf16_f32 v147, v70, v71
    buffer_load_dwordx4 v[180:183], v52, s[8:11], s73 offen offset:128
    ds_write_b128 v4, v[144:147] offset:32896
    v_dot2_f32_bf16 v72, v148, v48, v50
    v_dot2_f32_bf16 v73, v148, v49, v50
    v_dot2_f32_bf16 v74, v149, v48, v50
    v_dot2_f32_bf16 v75, v149, v49, v50
    v_dot2_f32_bf16 v76, v150, v48, v50
    v_dot2_f32_bf16 v77, v150, v49, v50
    v_dot2_f32_bf16 v78, v151, v48, v50
    v_dot2_f32_bf16 v79, v151, v49, v50
    v_cvt_pk_bf16_f32 v148, v72, v73
    v_cvt_pk_bf16_f32 v149, v74, v75
    v_cvt_pk_bf16_f32 v150, v76, v77
    v_cvt_pk_bf16_f32 v151, v78, v79
    ds_write_b128 v4, v[148:151] offset:34944
    v_dot2_f32_bf16 v64, v152, v48, v50
    v_dot2_f32_bf16 v65, v152, v49, v50
    v_dot2_f32_bf16 v66, v153, v48, v50
    v_dot2_f32_bf16 v67, v153, v49, v50
    v_dot2_f32_bf16 v68, v154, v48, v50
    v_dot2_f32_bf16 v69, v154, v49, v50
    v_dot2_f32_bf16 v70, v155, v48, v50
    v_dot2_f32_bf16 v71, v155, v49, v50
    v_cvt_pk_bf16_f32 v152, v64, v65
    v_cvt_pk_bf16_f32 v153, v66, v67
    v_cvt_pk_bf16_f32 v154, v68, v69
    v_cvt_pk_bf16_f32 v155, v70, v71
    buffer_load_dwordx4 v[184:187], v53, s[8:11], s73 offen offset:0
    buffer_load_dwordx4 v[188:191], v53, s[8:11], s73 offen offset:128
    ds_write_b128 v63, v[152:155] offset:128
    v_dot2_f32_bf16 v72, v156, v48, v50
    v_dot2_f32_bf16 v73, v156, v49, v50
    v_dot2_f32_bf16 v74, v157, v48, v50
    v_dot2_f32_bf16 v75, v157, v49, v50
    v_dot2_f32_bf16 v76, v158, v48, v50
    v_dot2_f32_bf16 v77, v158, v49, v50
    v_dot2_f32_bf16 v78, v159, v48, v50
    v_dot2_f32_bf16 v79, v159, v49, v50
    v_cvt_pk_bf16_f32 v156, v72, v73
    v_cvt_pk_bf16_f32 v157, v74, v75
    v_cvt_pk_bf16_f32 v158, v76, v77
    v_cvt_pk_bf16_f32 v159, v78, v79
    ds_write_b128 v63, v[156:159] offset:2176
    v_dot2_f32_bf16 v64, v208, v48, v50
    v_dot2_f32_bf16 v65, v208, v49, v50
    v_dot2_f32_bf16 v66, v209, v48, v50
    v_dot2_f32_bf16 v67, v209, v49, v50
    v_dot2_f32_bf16 v68, v210, v48, v50
    v_dot2_f32_bf16 v69, v210, v49, v50
    v_dot2_f32_bf16 v70, v211, v48, v50
    v_dot2_f32_bf16 v71, v211, v49, v50
    v_cvt_pk_bf16_f32 v208, v64, v65
    v_cvt_pk_bf16_f32 v209, v66, v67
    v_cvt_pk_bf16_f32 v210, v68, v69
    v_cvt_pk_bf16_f32 v211, v70, v71
    buffer_load_dwordx4 v[240:243], v54, s[8:11], s73 offen offset:0
    ds_write_b128 v4, v[208:211] offset:128
    v_dot2_f32_bf16 v72, v212, v48, v50
    v_dot2_f32_bf16 v73, v212, v49, v50
    v_dot2_f32_bf16 v74, v213, v48, v50
    v_dot2_f32_bf16 v75, v213, v49, v50
    v_dot2_f32_bf16 v76, v214, v48, v50
    v_dot2_f32_bf16 v77, v214, v49, v50
    v_dot2_f32_bf16 v78, v215, v48, v50
    v_dot2_f32_bf16 v79, v215, v49, v50
    v_cvt_pk_bf16_f32 v212, v72, v73
    v_cvt_pk_bf16_f32 v213, v74, v75
    v_cvt_pk_bf16_f32 v214, v76, v77
    v_cvt_pk_bf16_f32 v215, v78, v79
    ds_write_b128 v4, v[212:215] offset:2176
    v_dot2_f32_bf16 v64, v216, v48, v50
    v_dot2_f32_bf16 v65, v216, v49, v50
    v_dot2_f32_bf16 v66, v217, v48, v50
    v_dot2_f32_bf16 v67, v217, v49, v50
    v_dot2_f32_bf16 v68, v218, v48, v50
    v_dot2_f32_bf16 v69, v218, v49, v50
    v_dot2_f32_bf16 v70, v219, v48, v50
    v_dot2_f32_bf16 v71, v219, v49, v50
    v_cvt_pk_bf16_f32 v216, v64, v65
    v_cvt_pk_bf16_f32 v217, v66, v67
    v_cvt_pk_bf16_f32 v218, v68, v69
    v_cvt_pk_bf16_f32 v219, v70, v71
    buffer_load_dwordx4 v[244:247], v54, s[8:11], s73 offen offset:128
    buffer_load_dwordx4 v[248:251], v55, s[8:11], s73 offen offset:0
    v_dot2_f32_bf16 v72, v220, v48, v50
    v_dot2_f32_bf16 v73, v220, v49, v50
    v_dot2_f32_bf16 v74, v221, v48, v50
    v_dot2_f32_bf16 v75, v221, v49, v50
    v_dot2_f32_bf16 v76, v222, v48, v50
    v_dot2_f32_bf16 v77, v222, v49, v50
    v_dot2_f32_bf16 v78, v223, v48, v50
    v_dot2_f32_bf16 v79, v223, v49, v50
    v_cvt_pk_bf16_f32 v220, v72, v73
    v_cvt_pk_bf16_f32 v221, v74, v75
    v_cvt_pk_bf16_f32 v222, v76, v77
    v_cvt_pk_bf16_f32 v223, v78, v79
    s_waitcnt vmcnt(11)
    s_nop 0
    buffer_load_dwordx4 v[252:255], v55, s[8:11], s73 offen offset:128
    v_dot2_f32_bf16 v36, v160, s77, 0
    v_dot2_f32_bf16 v37, v160, v160, 0
    v_dot2_f32_bf16 v36, v161, s77, v36
    v_dot2_f32_bf16 v37, v161, v161, v37
    v_dot2_f32_bf16 v36, v162, s77, v36
    v_dot2_f32_bf16 v37, v162, v162, v37
    v_dot2_f32_bf16 v36, v163, s77, v36
    v_dot2_f32_bf16 v37, v163, v163, v37
    v_dot2_f32_bf16 v36, v164, s77, v36
    v_dot2_f32_bf16 v37, v164, v164, v37
    v_dot2_f32_bf16 v36, v165, s77, v36
    v_dot2_f32_bf16 v37, v165, v165, v37
    v_dot2_f32_bf16 v36, v166, s77, v36
    v_dot2_f32_bf16 v37, v166, v166, v37
    v_dot2_f32_bf16 v36, v167, s77, v36
    v_dot2_f32_bf16 v37, v167, v167, v37
    v_dot2_f32_bf16 v36, v168, s77, v36
    v_dot2_f32_bf16 v37, v168, v168, v37
    v_dot2_f32_bf16 v36, v169, s77, v36
    v_dot2_f32_bf16 v37, v169, v169, v37
    v_dot2_f32_bf16 v36, v170, s77, v36
    v_dot2_f32_bf16 v37, v170, v170, v37
    v_dot2_f32_bf16 v36, v171, s77, v36
    v_dot2_f32_bf16 v37, v171, v171, v37
    v_dot2_f32_bf16 v36, v172, s77, v36
    v_dot2_f32_bf16 v37, v172, v172, v37
    v_dot2_f32_bf16 v36, v173, s77, v36
    v_dot2_f32_bf16 v37, v173, v173, v37
    v_dot2_f32_bf16 v36, v174, s77, v36
    v_dot2_f32_bf16 v37, v174, v174, v37
    v_dot2_f32_bf16 v36, v175, s77, v36
    v_dot2_f32_bf16 v37, v175, v175, v37
    s_waitcnt vmcnt(8)
    s_add_u32 m0, s56, 0
    s_add_u32 s59, s90, s57
    s_nop 0
    buffer_load_dwordx4 v12, s[12:15], s59 offen lds
    v_dot2_f32_bf16 v36, v224, s77, v36
    v_dot2_f32_bf16 v37, v224, v224, v37
    v_dot2_f32_bf16 v36, v225, s77, v36
    v_dot2_f32_bf16 v37, v225, v225, v37
    v_dot2_f32_bf16 v36, v226, s77, v36
    v_dot2_f32_bf16 v37, v226, v226, v37
    v_dot2_f32_bf16 v36, v227, s77, v36
    v_dot2_f32_bf16 v37, v227, v227, v37
    v_dot2_f32_bf16 v36, v228, s77, v36
    v_dot2_f32_bf16 v37, v228, v228, v37
    v_dot2_f32_bf16 v36, v229, s77, v36
    v_dot2_f32_bf16 v37, v229, v229, v37
    v_dot2_f32_bf16 v36, v230, s77, v36
    v_dot2_f32_bf16 v37, v230, v230, v37
    v_dot2_f32_bf16 v36, v231, s77, v36
    v_dot2_f32_bf16 v37, v231, v231, v37
    v_dot2_f32_bf16 v36, v232, s77, v36
    v_dot2_f32_bf16 v37, v232, v232, v37
    v_dot2_f32_bf16 v36, v233, s77, v36
    v_dot2_f32_bf16 v37, v233, v233, v37
    v_dot2_f32_bf16 v36, v234, s77, v36
    v_dot2_f32_bf16 v37, v234, v234, v37
    v_dot2_f32_bf16 v36, v235, s77, v36
    v_dot2_f32_bf16 v37, v235, v235, v37
    v_dot2_f32_bf16 v36, v236, s77, v36
    v_dot2_f32_bf16 v37, v236, v236, v37
    v_dot2_f32_bf16 v36, v237, s77, v36
    v_dot2_f32_bf16 v37, v237, v237, v37
    v_dot2_f32_bf16 v36, v238, s77, v36
    v_dot2_f32_bf16 v37, v238, v238, v37
    v_dot2_f32_bf16 v36, v239, s77, v36
    v_dot2_f32_bf16 v37, v239, v239, v37
    s_nop 1
    v_add_f32_dpp v36, v36, v36 quad_perm:[1,0,3,2] row_mask:0xf bank_mask:0xf
    v_add_f32_dpp v37, v37, v37 quad_perm:[1,0,3,2] row_mask:0xf bank_mask:0xf
    s_nop 0
    v_add_f32_dpp v36, v36, v36 quad_perm:[2,3,0,1] row_mask:0xf bank_mask:0xf
    v_add_f32_dpp v37, v37, v37 quad_perm:[2,3,0,1] row_mask:0xf bank_mask:0xf
    s_nop 0
    v_add_f32_dpp v36, v36, v36 row_half_mirror row_mask:0xf bank_mask:0xf
    v_add_f32_dpp v37, v37, v37 row_half_mirror row_mask:0xf bank_mask:0xf
    v_mul_f32 v38, s81, v36
    v_mul_f32_e64 v39, v38, v38
    v_fma_f32 v39, v37, s81, -v39
    v_max_f32 v39, 0, v39
    v_add_f32 v39, s82, v39
    v_rsq_f32 v39, v39
    s_nop 0
    v_cvt_pk_bf16_f32 v40, v39, 0
    v_lshlrev_b32_e64 v41, 16, v40
    v_mul_f32 v42, -v38, v41
    ds_read_b64_tr_b16 v[20:21], v61 offset:4096
    ds_read_b64_tr_b16 v[22:23], v61 offset:4104
    ds_read_b64_tr_b16 v[24:25], v61 offset:4112
    ds_read_b64_tr_b16 v[26:27], v61 offset:4120
    v_dot2_f32_bf16 v64, v160, v40, v42
    v_dot2_f32_bf16 v65, v160, v41, v42
    v_dot2_f32_bf16 v66, v161, v40, v42
    v_dot2_f32_bf16 v67, v161, v41, v42
    v_dot2_f32_bf16 v68, v162, v40, v42
    v_dot2_f32_bf16 v69, v162, v41, v42
    v_dot2_f32_bf16 v70, v163, v40, v42
    v_dot2_f32_bf16 v71, v163, v41, v42
    v_cvt_pk_bf16_f32 v160, v64, v65
    v_cvt_pk_bf16_f32 v161, v66, v67
    v_cvt_pk_bf16_f32 v162, v68, v69
    v_cvt_pk_bf16_f32 v163, v70, v71
    buffer_load_dwordx4 v13, s[12:15], s59 offen offset:1024 lds
    s_add_u32 m0, s56, 2048
    s_add_u32 s59, s90, s57
    s_nop 0
    s_add_u32 s59, s59, 49152
    buffer_load_dwordx4 v12, s[12:15], s59 offen lds
    ds_write_b128 v4, v[160:163] offset:36864
    v_dot2_f32_bf16 v72, v164, v40, v42
    v_dot2_f32_bf16 v73, v164, v41, v42
    v_dot2_f32_bf16 v74, v165, v40, v42
    v_dot2_f32_bf16 v75, v165, v41, v42
    v_dot2_f32_bf16 v76, v166, v40, v42
    v_dot2_f32_bf16 v77, v166, v41, v42
    v_dot2_f32_bf16 v78, v167, v40, v42
    v_dot2_f32_bf16 v79, v167, v41, v42
    v_cvt_pk_bf16_f32 v164, v72, v73
    v_cvt_pk_bf16_f32 v165, v74, v75
    v_cvt_pk_bf16_f32 v166, v76, v77
    v_cvt_pk_bf16_f32 v167, v78, v79
    ds_write_b128 v4, v[164:167] offset:38912
    v_dot2_f32_bf16 v64, v168, v40, v42
    v_dot2_f32_bf16 v65, v168, v41, v42
    v_dot2_f32_bf16 v66, v169, v40, v42
    v_dot2_f32_bf16 v67, v169, v41, v42
    v_dot2_f32_bf16 v68, v170, v40, v42
    v_dot2_f32_bf16 v69, v170, v41, v42
    v_dot2_f32_bf16 v70, v171, v40, v42
    v_dot2_f32_bf16 v71, v171, v41, v42
    v_cvt_pk_bf16_f32 v168, v64, v65
    v_cvt_pk_bf16_f32 v169, v66, v67
    v_cvt_pk_bf16_f32 v170, v68, v69
    v_cvt_pk_bf16_f32 v171, v70, v71
    buffer_load_dwordx4 v13, s[12:15], s59 offen offset:1024 lds
    ds_write_b128 v63, v[168:171] offset:4096
    v_dot2_f32_bf16 v72, v172, v40, v42
    v_dot2_f32_bf16 v73, v172, v41, v42
    v_dot2_f32_bf16 v74, v173, v40, v42
    v_dot2_f32_bf16 v75, v173, v41, v42
    v_dot2_f32_bf16 v76, v174, v40, v42
    v_dot2_f32_bf16 v77, v174, v41, v42
    v_dot2_f32_bf16 v78, v175, v40, v42
    v_dot2_f32_bf16 v79, v175, v41, v42
    v_cvt_pk_bf16_f32 v172, v72, v73
    v_cvt_pk_bf16_f32 v173, v74, v75
    v_cvt_pk_bf16_f32 v174, v76, v77
    v_cvt_pk_bf16_f32 v175, v78, v79
    ds_write_b128 v63, v[172:175] offset:6144
    v_dot2_f32_bf16 v64, v224, v40, v42
    v_dot2_f32_bf16 v65, v224, v41, v42
    v_dot2_f32_bf16 v66, v225, v40, v42
    v_dot2_f32_bf16 v67, v225, v41, v42
    v_dot2_f32_bf16 v68, v226, v40, v42
    v_dot2_f32_bf16 v69, v226, v41, v42
    v_dot2_f32_bf16 v70, v227, v40, v42
    v_dot2_f32_bf16 v71, v227, v41, v42
    v_cvt_pk_bf16_f32 v224, v64, v65
    v_cvt_pk_bf16_f32 v225, v66, v67
    v_cvt_pk_bf16_f32 v226, v68, v69
    v_cvt_pk_bf16_f32 v227, v70, v71
    s_add_u32 m0, s56, 16384
    s_add_u32 s59, s91, s57
    s_nop 0
    buffer_load_dwordx4 v12, s[12:15], s59 offen lds
    ds_write_b128 v4, v[224:227] offset:4096
    v_dot2_f32_bf16 v72, v228, v40, v42
    v_dot2_f32_bf16 v73, v228, v41, v42
    v_dot2_f32_bf16 v74, v229, v40, v42
    v_dot2_f32_bf16 v75, v229, v41, v42
    v_dot2_f32_bf16 v76, v230, v40, v42
    v_dot2_f32_bf16 v77, v230, v41, v42
    v_dot2_f32_bf16 v78, v231, v40, v42
    v_dot2_f32_bf16 v79, v231, v41, v42
    v_cvt_pk_bf16_f32 v228, v72, v73
    v_cvt_pk_bf16_f32 v229, v74, v75
    v_cvt_pk_bf16_f32 v230, v76, v77
    v_cvt_pk_bf16_f32 v231, v78, v79
    ds_write_b128 v4, v[228:231] offset:6144
    v_dot2_f32_bf16 v64, v232, v40, v42
    v_dot2_f32_bf16 v65, v232, v41, v42
    v_dot2_f32_bf16 v66, v233, v40, v42
    v_dot2_f32_bf16 v67, v233, v41, v42
    v_dot2_f32_bf16 v68, v234, v40, v42
    v_dot2_f32_bf16 v69, v234, v41, v42
    v_dot2_f32_bf16 v70, v235, v40, v42
    v_dot2_f32_bf16 v71, v235, v41, v42
    v_cvt_pk_bf16_f32 v232, v64, v65
    v_cvt_pk_bf16_f32 v233, v66, v67
    v_cvt_pk_bf16_f32 v234, v68, v69
    v_cvt_pk_bf16_f32 v235, v70, v71
    buffer_load_dwordx4 v13, s[12:15], s59 offen offset:1024 lds
    s_add_u32 m0, s56, 18432
    s_add_u32 s59, s91, s57
    s_nop 0
    s_add_u32 s59, s59, 49152
    buffer_load_dwordx4 v12, s[12:15], s59 offen lds
    v_dot2_f32_bf16 v72, v236, v40, v42
    v_dot2_f32_bf16 v73, v236, v41, v42
    v_dot2_f32_bf16 v74, v237, v40, v42
    v_dot2_f32_bf16 v75, v237, v41, v42
    v_dot2_f32_bf16 v76, v238, v40, v42
    v_dot2_f32_bf16 v77, v238, v41, v42
    v_dot2_f32_bf16 v78, v239, v40, v42
    v_dot2_f32_bf16 v79, v239, v41, v42
    v_cvt_pk_bf16_f32 v236, v72, v73
    v_cvt_pk_bf16_f32 v237, v74, v75
    v_cvt_pk_bf16_f32 v238, v76, v77
    v_cvt_pk_bf16_f32 v239, v78, v79
    s_waitcnt vmcnt(11)
    s_nop 0
    buffer_load_dwordx4 v13, s[12:15], s59 offen offset:1024 lds
    v_dot2_f32_bf16 v44, v176, s77, 0
    v_dot2_f32_bf16 v45, v176, v176, 0
    v_dot2_f32_bf16 v44, v177, s77, v44
    v_dot2_f32_bf16 v45, v177, v177, v45
    v_dot2_f32_bf16 v44, v178, s77, v44
    v_dot2_f32_bf16 v45, v178, v178, v45
    v_dot2_f32_bf16 v44, v179, s77, v44
    v_dot2_f32_bf16 v45, v179, v179, v45
    v_dot2_f32_bf16 v44, v180, s77, v44
    v_dot2_f32_bf16 v45, v180, v180, v45
    v_dot2_f32_bf16 v44, v181, s77, v44
    v_dot2_f32_bf16 v45, v181, v181, v45
    v_dot2_f32_bf16 v44, v182, s77, v44
    v_dot2_f32_bf16 v45, v182, v182, v45
    v_dot2_f32_bf16 v44, v183, s77, v44
    v_dot2_f32_bf16 v45, v183, v183, v45
    v_dot2_f32_bf16 v44, v184, s77, v44
    v_dot2_f32_bf16 v45, v184, v184, v45
    v_dot2_f32_bf16 v44, v185, s77, v44
    v_dot2_f32_bf16 v45, v185, v185, v45
    v_dot2_f32_bf16 v44, v186, s77, v44
    v_dot2_f32_bf16 v45, v186, v186, v45
    v_dot2_f32_bf16 v44, v187, s77, v44
    v_dot2_f32_bf16 v45, v187, v187, v45
    v_dot2_f32_bf16 v44, v188, s77, v44
    v_dot2_f32_bf16 v45, v188, v188, v45
    v_dot2_f32_bf16 v44, v189, s77, v44
    v_dot2_f32_bf16 v45, v189, v189, v45
    v_dot2_f32_bf16 v44, v190, s77, v44
    v_dot2_f32_bf16 v45, v190, v190, v45
    v_dot2_f32_bf16 v44, v191, s77, v44
    v_dot2_f32_bf16 v45, v191, v191, v45
    s_waitcnt vmcnt(8)
    s_add_u32 m0, s56, 32768
    s_add_u32 s59, s86, s57
    buffer_load_dwordx4 v14, s[16:19], s59 offen lds
    v_dot2_f32_bf16 v44, v240, s77, v44
    v_dot2_f32_bf16 v45, v240, v240, v45
    v_dot2_f32_bf16 v44, v241, s77, v44
    v_dot2_f32_bf16 v45, v241, v241, v45
    v_dot2_f32_bf16 v44, v242, s77, v44
    v_dot2_f32_bf16 v45, v242, v242, v45
    v_dot2_f32_bf16 v44, v243, s77, v44
    v_dot2_f32_bf16 v45, v243, v243, v45
    v_dot2_f32_bf16 v44, v244, s77, v44
    v_dot2_f32_bf16 v45, v244, v244, v45
    v_dot2_f32_bf16 v44, v245, s77, v44
    v_dot2_f32_bf16 v45, v245, v245, v45
    v_dot2_f32_bf16 v44, v246, s77, v44
    v_dot2_f32_bf16 v45, v246, v246, v45
    v_dot2_f32_bf16 v44, v247, s77, v44
    v_dot2_f32_bf16 v45, v247, v247, v45
    v_dot2_f32_bf16 v44, v248, s77, v44
    v_dot2_f32_bf16 v45, v248, v248, v45
    v_dot2_f32_bf16 v44, v249, s77, v44
    v_dot2_f32_bf16 v45, v249, v249, v45
    v_dot2_f32_bf16 v44, v250, s77, v44
    v_dot2_f32_bf16 v45, v250, v250, v45
    v_dot2_f32_bf16 v44, v251, s77, v44
    v_dot2_f32_bf16 v45, v251, v251, v45
    v_dot2_f32_bf16 v44, v252, s77, v44
    v_dot2_f32_bf16 v45, v252, v252, v45
    v_dot2_f32_bf16 v44, v253, s77, v44
    v_dot2_f32_bf16 v45, v253, v253, v45
    v_dot2_f32_bf16 v44, v254, s77, v44
    v_dot2_f32_bf16 v45, v254, v254, v45
    v_dot2_f32_bf16 v44, v255, s77, v44
    v_dot2_f32_bf16 v45, v255, v255, v45
    s_nop 1
    v_add_f32_dpp v44, v44, v44 quad_perm:[1,0,3,2] row_mask:0xf bank_mask:0xf
    v_add_f32_dpp v45, v45, v45 quad_perm:[1,0,3,2] row_mask:0xf bank_mask:0xf
    s_nop 0
    v_add_f32_dpp v44, v44, v44 quad_perm:[2,3,0,1] row_mask:0xf bank_mask:0xf
    v_add_f32_dpp v45, v45, v45 quad_perm:[2,3,0,1] row_mask:0xf bank_mask:0xf
    s_nop 0
    v_add_f32_dpp v44, v44, v44 row_half_mirror row_mask:0xf bank_mask:0xf
    v_add_f32_dpp v45, v45, v45 row_half_mirror row_mask:0xf bank_mask:0xf
    v_mul_f32 v46, s81, v44
    v_mul_f32_e64 v47, v46, v46
    v_fma_f32 v47, v45, s81, -v47
    v_max_f32 v47, 0, v47
    v_add_f32 v47, s82, v47
    v_rsq_f32 v47, v47
    s_nop 0
    v_cvt_pk_bf16_f32 v48, v47, 0
    v_lshlrev_b32_e64 v49, 16, v48
    v_mul_f32 v50, -v46, v49
    v_dot2_f32_bf16 v64, v176, v48, v50
    v_dot2_f32_bf16 v65, v176, v49, v50
    v_dot2_f32_bf16 v66, v177, v48, v50
    v_dot2_f32_bf16 v67, v177, v49, v50
    v_dot2_f32_bf16 v68, v178, v48, v50
    v_dot2_f32_bf16 v69, v178, v49, v50
    v_dot2_f32_bf16 v70, v179, v48, v50
    v_dot2_f32_bf16 v71, v179, v49, v50
    v_cvt_pk_bf16_f32 v176, v64, v65
    v_cvt_pk_bf16_f32 v177, v66, v67
    v_cvt_pk_bf16_f32 v178, v68, v69
    v_cvt_pk_bf16_f32 v179, v70, v71
    buffer_load_dwordx4 v15, s[16:19], s59 offen offset:1024 lds
    s_add_u32 m0, s56, 34816
    s_add_u32 s59, s86, s57
    s_nop 0
    s_add_u32 s59, s59, 57344
    buffer_load_dwordx4 v14, s[16:19], s59 offen lds
    ds_write_b128 v4, v[176:179] offset:36992
    v_dot2_f32_bf16 v72, v180, v48, v50
    v_dot2_f32_bf16 v73, v180, v49, v50
    v_dot2_f32_bf16 v74, v181, v48, v50
    v_dot2_f32_bf16 v75, v181, v49, v50
    v_dot2_f32_bf16 v76, v182, v48, v50
    v_dot2_f32_bf16 v77, v182, v49, v50
    v_dot2_f32_bf16 v78, v183, v48, v50
    v_dot2_f32_bf16 v79, v183, v49, v50
    v_cvt_pk_bf16_f32 v180, v72, v73
    v_cvt_pk_bf16_f32 v181, v74, v75
    v_cvt_pk_bf16_f32 v182, v76, v77
    v_cvt_pk_bf16_f32 v183, v78, v79
    ds_write_b128 v4, v[180:183] offset:39040
    v_dot2_f32_bf16 v64, v184, v48, v50
    v_dot2_f32_bf16 v65, v184, v49, v50
    v_dot2_f32_bf16 v66, v185, v48, v50
    v_dot2_f32_bf16 v67, v185, v49, v50
    v_dot2_f32_bf16 v68, v186, v48, v50
    v_dot2_f32_bf16 v69, v186, v49, v50
    v_dot2_f32_bf16 v70, v187, v48, v50
    v_dot2_f32_bf16 v71, v187, v49, v50
    v_cvt_pk_bf16_f32 v184, v64, v65
    v_cvt_pk_bf16_f32 v185, v66, v67
    v_cvt_pk_bf16_f32 v186, v68, v69
    v_cvt_pk_bf16_f32 v187, v70, v71
    buffer_load_dwordx4 v15, s[16:19], s59 offen offset:1024 lds
    ds_write_b128 v63, v[184:187] offset:4224
    v_dot2_f32_bf16 v72, v188, v48, v50
    v_dot2_f32_bf16 v73, v188, v49, v50
    v_dot2_f32_bf16 v74, v189, v48, v50
    v_dot2_f32_bf16 v75, v189, v49, v50
    v_dot2_f32_bf16 v76, v190, v48, v50
    v_dot2_f32_bf16 v77, v190, v49, v50
    v_dot2_f32_bf16 v78, v191, v48, v50
    v_dot2_f32_bf16 v79, v191, v49, v50
    v_cvt_pk_bf16_f32 v188, v72, v73
    v_cvt_pk_bf16_f32 v189, v74, v75
    v_cvt_pk_bf16_f32 v190, v76, v77
    v_cvt_pk_bf16_f32 v191, v78, v79
    ds_write_b128 v63, v[188:191] offset:6272
    v_dot2_f32_bf16 v64, v240, v48, v50
    v_dot2_f32_bf16 v65, v240, v49, v50
    v_dot2_f32_bf16 v66, v241, v48, v50
    v_dot2_f32_bf16 v67, v241, v49, v50
    v_dot2_f32_bf16 v68, v242, v48, v50
    v_dot2_f32_bf16 v69, v242, v49, v50
    v_dot2_f32_bf16 v70, v243, v48, v50
    v_dot2_f32_bf16 v71, v243, v49, v50
    v_cvt_pk_bf16_f32 v240, v64, v65
    v_cvt_pk_bf16_f32 v241, v66, v67
    v_cvt_pk_bf16_f32 v242, v68, v69
    v_cvt_pk_bf16_f32 v243, v70, v71
    ds_write_b128 v4, v[240:243] offset:4224
    v_dot2_f32_bf16 v72, v244, v48, v50
    v_dot2_f32_bf16 v73, v244, v49, v50
    v_dot2_f32_bf16 v74, v245, v48, v50
    v_dot2_f32_bf16 v75, v245, v49, v50
    v_dot2_f32_bf16 v76, v246, v48, v50
    v_dot2_f32_bf16 v77, v246, v49, v50
    v_dot2_f32_bf16 v78, v247, v48, v50
    v_dot2_f32_bf16 v79, v247, v49, v50
    v_cvt_pk_bf16_f32 v244, v72, v73
    v_cvt_pk_bf16_f32 v245, v74, v75
    v_cvt_pk_bf16_f32 v246, v76, v77
    v_cvt_pk_bf16_f32 v247, v78, v79
    ds_write_b128 v4, v[244:247] offset:6272
    v_dot2_f32_bf16 v64, v248, v48, v50
    v_dot2_f32_bf16 v65, v248, v49, v50
    v_dot2_f32_bf16 v66, v249, v48, v50
    v_dot2_f32_bf16 v67, v249, v49, v50
    v_dot2_f32_bf16 v68, v250, v48, v50
    v_dot2_f32_bf16 v69, v250, v49, v50
    v_dot2_f32_bf16 v70, v251, v48, v50
    v_dot2_f32_bf16 v71, v251, v49, v50
    v_cvt_pk_bf16_f32 v248, v64, v65
    v_cvt_pk_bf16_f32 v249, v66, v67
    v_cvt_pk_bf16_f32 v250, v68, v69
    v_cvt_pk_bf16_f32 v251, v70, v71
    v_dot2_f32_bf16 v72, v252, v48, v50
    v_dot2_f32_bf16 v73, v252, v49, v50
    v_dot2_f32_bf16 v74, v253, v48, v50
    v_dot2_f32_bf16 v75, v253, v49, v50
    v_dot2_f32_bf16 v76, v254, v48, v50
    v_dot2_f32_bf16 v77, v254, v49, v50
    v_dot2_f32_bf16 v78, v255, v48, v50
    v_dot2_f32_bf16 v79, v255, v49, v50
    v_cvt_pk_bf16_f32 v252, v72, v73
    v_cvt_pk_bf16_f32 v253, v74, v75
    v_cvt_pk_bf16_f32 v254, v76, v77
    v_cvt_pk_bf16_f32 v255, v78, v79
    s_waitcnt vmcnt(8) lgkmcnt(0)
    s_barrier
    ds_read_b128 a[0:3], v6 offset:32768
    ds_read_b64_tr_b16 v[32:33], v8 offset:0
    ds_read_b64_tr_b16 v[34:35], v8 offset:512
    ds_read_b128 a[8:11], v7 offset:33792
    ds_read_b64_tr_b16 v[36:37], v8 offset:4096
    ds_read_b64_tr_b16 v[38:39], v8 offset:4608
    ds_read_b128 a[16:19], v6 offset:34816
    ds_read_b64_tr_b16 v[40:41], v8 offset:8192
    ds_read_b64_tr_b16 v[42:43], v8 offset:8704
    ds_read_b128 a[24:27], v7 offset:35840
    ds_read_b64_tr_b16 v[44:45], v8 offset:12288
    ds_read_b64_tr_b16 v[46:47], v8 offset:12800
    ds_read_b128 a[4:7], v6 offset:36864
    ds_read_b128 a[12:15], v7 offset:37888
    ds_read_b128 a[20:23], v6 offset:38912
    ds_read_b128 a[28:31], v7 offset:39936
    ds_read_b128 a[128:131], v6 offset:40960
    ds_read_b128 a[136:139], v7 offset:41984
    ds_read_b128 a[144:147], v6 offset:43008
    ds_read_b128 a[152:155], v7 offset:44032
    ds_read_b128 a[132:135], v6 offset:45056
    ds_read_b128 a[140:143], v7 offset:46080
    ds_read_b128 a[148:151], v6 offset:47104
    ds_read_b128 a[156:159], v7 offset:48128
    s_waitcnt lgkmcnt(14)
    v_mfma_f32_16x16x32_bf16 v[128:131], v[32:35], a[0:3], 0
    s_xor_b32 s60, s65, 2
    ds_read_b64_tr_b16 v[48:49], v10 offset:0
    ds_read_b128 a[32:35], v28 offset:0
    v_mfma_f32_16x16x32_bf16 v[128:131], v[36:39], a[8:11], v[128:131]
    s_mul_i32 s88, s60, 458752
    ds_read_b64_tr_b16 v[50:51], v10 offset:512
    ds_read_b128 a[40:43], v29 offset:1024
    v_mfma_f32_16x16x32_bf16 v[128:131], v[40:43], a[16:19], v[128:131]
    s_xor_b32 s60, s65, 3
    ds_read_b64_tr_b16 v[52:53], v10 offset:4096
    ds_read_b128 a[48:51], v28 offset:2048
    s_waitcnt lgkmcnt(14)
    v_mfma_f32_16x16x32_bf16 v[128:131], v[44:47], a[24:27], v[128:131]
    s_mul_i32 s93, s60, 393216
    ds_read_b64_tr_b16 v[54:55], v10 offset:4608
    ds_read_b128 a[56:59], v29 offset:3072
    v_mfma_f32_16x16x32_bf16 v[132:135], v[32:35], a[4:7], 0
    s_mul_i32 s89, s60, 458752
    ds_read_b64_tr_b16 v[56:57], v10 offset:8192
    ds_read_b128 a[36:39], v28 offset:4096
    v_mfma_f32_16x16x32_bf16 v[132:135], v[36:39], a[12:15], v[132:135]
    s_xor_b32 s60, s65, 1
    ds_read_b64_tr_b16 v[58:59], v10 offset:8704
    ds_read_b128 a[44:47], v29 offset:5120
    v_mfma_f32_16x16x32_bf16 v[132:135], v[40:43], a[20:23], v[132:135]
    s_mul_i32 s87, s60, 458752
    ds_read_b64_tr_b16 v[60:61], v10 offset:12288
    ds_read_b128 a[52:55], v28 offset:6144
    v_mfma_f32_16x16x32_bf16 v[132:135], v[44:47], a[28:31], v[132:135]
    s_add_u32 m0, s56, 49152
    ds_read_b64_tr_b16 v[62:63], v10 offset:12800
    ds_read_b128 a[60:63], v29 offset:7168
    s_waitcnt lgkmcnt(14)
    v_mfma_f32_16x16x32_bf16 v[136:139], v[32:35], a[128:131], 0
    s_add_u32 s59, s92, s57
    buffer_load_dwordx4 v12, s[12:15], s59 offen lds
    ds_read_b128 a[160:163], v28 offset:8192
    v_mfma_f32_16x16x32_bf16 v[136:139], v[36:39], a[136:139], v[136:139]
    s_mov_b32 s22, 0x1c0000
    ds_read_b128 a[168:171], v29 offset:9216
    ds_read_b128 a[176:179], v28 offset:10240
    v_mfma_f32_16x16x32_bf16 v[136:139], v[40:43], a[144:147], v[136:139]
    s_mov_b32 s23, 0x20000
    buffer_load_dwordx4 v13, s[12:15], s59 offen offset:1024 lds
    ds_read_b128 a[184:187], v29 offset:11264
    v_mfma_f32_16x16x32_bf16 v[136:139], v[44:47], a[152:155], v[136:139]
    s_add_u32 m0, s56, 51200
    s_add_u32 s59, s92, s57
    ds_read_b128 a[164:167], v28 offset:12288
    ds_read_b128 a[172:175], v29 offset:13312
    v_mfma_f32_16x16x32_bf16 v[140:143], v[32:35], a[132:135], 0
    s_add_u32 s59, s59, 49152
    buffer_load_dwordx4 v12, s[12:15], s59 offen lds
    ds_read_b128 a[180:183], v28 offset:14336
    v_mfma_f32_16x16x32_bf16 v[140:143], v[36:39], a[140:143], v[140:143]
    s_mov_b32 s30, 0x80000
    ds_read_b128 a[188:191], v29 offset:15360
    v_lshrrev_b32_e64 v190, 4, v1
    v_mfma_f32_16x16x32_bf16 v[140:143], v[40:43], a[148:151], v[140:143]
    s_mov_b32 s31, 0x20000
    buffer_load_dwordx4 v13, s[12:15], s59 offen offset:1024 lds
    v_mfma_f32_16x16x32_bf16 v[140:143], v[44:47], a[156:159], v[140:143]
    s_waitcnt vmcnt(8) lgkmcnt(7)
    s_barrier
    v_mfma_f32_16x16x32_bf16 v[144:147], v[48:51], a[0:3], 0
    s_mov_b32 s26, 0x1c0000
    ds_read_b64_tr_b16 v[32:33], v8 offset:16384
    v_and_b32_e64 v189, 15, v1
    v_mfma_f32_16x16x32_bf16 v[144:147], v[52:55], a[8:11], v[144:147]
    s_mov_b32 s27, 0x20000
    ds_read_b64_tr_b16 v[34:35], v8 offset:16896
    v_lshlrev_b32_e64 v191, 24, v190
    v_mfma_f32_16x16x32_bf16 v[144:147], v[56:59], a[16:19], v[144:147]
    s_add_u32 m0, s56, 0
    ds_read_b64_tr_b16 v[36:37], v8 offset:20480
    v_lshl_add_u32 v191, v189, 7, v191
    v_mfma_f32_16x16x32_bf16 v[144:147], v[60:63], a[24:27], v[144:147]
    s_add_u32 s59, s93, s57
    buffer_load_dwordx4 v12, s[12:15], s59 offen lds
    ds_read_b64_tr_b16 v[38:39], v8 offset:20992
    v_mfma_f32_16x16x32_bf16 v[148:151], v[48:51], a[4:7], 0
    s_add_u32 s48, s44, 0x900000
    s_addc_u32 s49, s45, 0
    ds_read_b64_tr_b16 v[40:41], v8 offset:24576
    v_mfma_f32_16x16x32_bf16 v[148:151], v[52:55], a[12:15], v[148:151]
    s_mov_b32 s50, 0x120000
    ds_read_b64_tr_b16 v[42:43], v8 offset:25088
    v_mov_b32 v184, 0
    v_mfma_f32_16x16x32_bf16 v[148:151], v[56:59], a[20:23], v[148:151]
    s_mov_b32 s51, 0x20000
    buffer_load_dwordx4 v13, s[12:15], s59 offen offset:1024 lds
    ds_read_b64_tr_b16 v[44:45], v8 offset:28672
    v_mfma_f32_16x16x32_bf16 v[148:151], v[60:63], a[28:31], v[148:151]
    s_lshl_b32 s60, s2, 2
    ds_read_b64_tr_b16 v[46:47], v8 offset:29184
    v_mov_b32 v185, 0
    v_mfma_f32_16x16x32_bf16 v[152:155], v[48:51], a[128:131], 0
    s_add_u32 s60, s60, s3
    ds_write_b128 v4, v[200:203] offset:32768
    v_mfma_f32_16x16x32_bf16 v[152:155], v[52:55], a[136:139], v[152:155]
    s_lshl_b32 s60, s60, 11
    v_add_u32 v191, s60, v191
    v_mov_b32 v186, 0
    v_mfma_f32_16x16x32_bf16 v[152:155], v[56:59], a[144:147], v[152:155]
    s_lshl_b32 s60, s4, 26
    v_add_u32 v188, s60, v5
    v_mov_b32_e64 v187, 0
    v_mfma_f32_16x16x32_bf16 v[152:155], v[60:63], a[152:155], v[152:155]
    s_lshl_b32 s83, s5, 12
    ds_write_b128 v4, v[204:207] offset:34816
    v_mfma_f32_16x16x32_bf16 v[156:159], v[48:51], a[132:135], 0
    s_and_b32 s60, s64, 1
    v_lshrrev_b32 v5, 8, v5
    v_lshlrev_b32 v5, 24, v5
    v_mfma_f32_16x16x32_bf16 v[156:159], v[52:55], a[140:143], v[156:159]
    s_lshl_b32 s60, s60, 7
    v_lshl_add_u32 v5, v189, 7, v5
    v_lshlrev_b32 v3, 2, v189
    v_mfma_f32_16x16x32_bf16 v[156:159], v[56:59], a[148:151], v[156:159]
    s_mov_b32 s42, 0x100
    v_xor_b32_e64 v18, s60, v2
    v_add_u32 v9, 0x10000, v8
    v_mfma_f32_16x16x32_bf16 v[156:159], v[60:63], a[156:159], v[156:159]
    s_lshl_b32 s60, s3, 15
    v_add_u32 v11, 0x10000, v10
    v_lshlrev_b32 v190, 1, v190
    s_waitcnt lgkmcnt(2)
    v_mfma_f32_16x16x32_bf16 v[128:131], v[32:35], a[32:35], v[128:131]
    s_mov_b32 s43, 0x20000
    ds_read_b64_tr_b16 v[48:49], v10 offset:16384
    v_and_b32 v189, 7, v1
    v_mfma_f32_16x16x32_bf16 v[128:131], v[36:39], a[40:43], v[128:131]
    s_add_u32 m0, s56, 2048
    ds_read_b64_tr_b16 v[50:51], v10 offset:16896
    v_xor_b32_e64 v190, v190, v189
    v_mfma_f32_16x16x32_bf16 v[128:131], v[40:43], a[48:51], v[128:131]
    s_add_u32 s59, s93, s57
    ds_read_b64_tr_b16 v[52:53], v10 offset:20480
    v_lshlrev_b32 v190, 4, v190
    v_mfma_f32_16x16x32_bf16 v[128:131], v[44:47], a[56:59], v[128:131]
    s_add_u32 s59, s59, 49152
    buffer_load_dwordx4 v12, s[12:15], s59 offen lds
    ds_read_b64_tr_b16 v[54:55], v10 offset:20992
    v_mfma_f32_16x16x32_bf16 v[132:135], v[32:35], a[36:39], v[132:135]
    s_mov_b32 s46, 0x900000
    ds_read_b64_tr_b16 v[56:57], v10 offset:24576
    v_lshrrev_b32_e64 v189, 3, v1
    v_mfma_f32_16x16x32_bf16 v[132:135], v[36:39], a[44:47], v[132:135]
    s_mov_b32 s47, 0x20000
    ds_read_b64_tr_b16 v[58:59], v10 offset:25088
    v_lshl_add_u32 v190, v189, 10, v190
    v_mfma_f32_16x16x32_bf16 v[132:135], v[40:43], a[52:55], v[132:135]
    s_mov_b32 s38, 0x200000
    buffer_load_dwordx4 v13, s[12:15], s59 offen offset:1024 lds
    ds_read_b64_tr_b16 v[60:61], v10 offset:28672
    v_mfma_f32_16x16x32_bf16 v[132:135], v[44:47], a[60:63], v[132:135]
    s_mov_b32 s39, 0x20000
    ds_read_b64_tr_b16 v[62:63], v10 offset:29184
    v_add_u32_e64 v16, s60, v190
    v_mfma_f32_16x16x32_bf16 v[136:139], v[32:35], a[160:163], v[136:139]
    s_and_b32 s7, s2, 7
    ds_write_b128 v4, v[216:219] offset:32896
    v_mfma_f32_16x16x32_bf16 v[136:139], v[36:39], a[168:171], v[136:139]
    s_lshr_b32 s58, s5, 1
    v_add_u32 v19, 7168, v16
    v_mov_b32_e64 v182, 1
    v_mfma_f32_16x16x32_bf16 v[136:139], v[40:43], a[176:179], v[136:139]
    s_lshl_b32 s58, s58, 7
    v_mfma_f32_16x16x32_bf16 v[136:139], v[44:47], a[184:187], v[136:139]
    s_and_b32 s65, s3, 1
    ds_write_b128 v4, v[220:223] offset:34944
    v_mfma_f32_16x16x32_bf16 v[140:143], v[32:35], a[164:167], v[140:143]
    s_lshl_b32 s66, s65, 12
    v_mfma_f32_16x16x32_bf16 v[140:143], v[36:39], a[172:175], v[140:143]
    s_lshr_b32 s60, s3, 1
    v_mfma_f32_16x16x32_bf16 v[140:143], v[40:43], a[180:183], v[140:143]
    s_lshl_b32 s61, s4, 1
    buffer_load_dword v17, v191, s[28:31], 0 offen
    v_mfma_f32_16x16x32_bf16 v[140:143], v[44:47], a[188:191], v[140:143]
    s_waitcnt vmcnt(9) lgkmcnt(2)
    s_barrier
    v_mfma_f32_16x16x32_bf16 v[144:147], v[48:51], a[32:35], v[144:147]
    s_add_u32 s60, s60, s61
    ds_read_b64_tr_b16 v[32:33], v8 offset:32768
    v_mfma_f32_16x16x32_bf16 v[144:147], v[52:55], a[40:43], v[144:147]
    s_mul_i32 s60, s60, 294912
    ds_read_b64_tr_b16 v[34:35], v8 offset:33280
    v_mfma_f32_16x16x32_bf16 v[144:147], v[56:59], a[48:51], v[144:147]
    s_add_u32 m0, s56, 16384
    ds_read_b64_tr_b16 v[36:37], v8 offset:36864
    v_mfma_f32_16x16x32_bf16 v[144:147], v[60:63], a[56:59], v[144:147]
    s_add_u32 s59, s87, s57
    buffer_load_dwordx4 v14, s[16:19], s59 offen lds
    ds_read_b64_tr_b16 v[38:39], v8 offset:37376
    v_mfma_f32_16x16x32_bf16 v[148:151], v[48:51], a[36:39], v[148:151]
    s_add_u32 s60, s60, s66
    ds_read_b64_tr_b16 v[40:41], v8 offset:40960
    v_mfma_f32_16x16x32_bf16 v[148:151], v[52:55], a[44:47], v[148:151]
    s_lshr_b32 s61, s64, 1
    ds_read_b64_tr_b16 v[42:43], v8 offset:41472
    v_mfma_f32_16x16x32_bf16 v[148:151], v[56:59], a[52:55], v[148:151]
    s_lshl_b32 s61, s61, 10
    buffer_load_dwordx4 v15, s[16:19], s59 offen offset:1024 lds
    ds_read_b64_tr_b16 v[44:45], v8 offset:45056
    v_mfma_f32_16x16x32_bf16 v[148:151], v[60:63], a[60:63], v[148:151]
    s_add_u32 s70, s60, s61
    ds_read_b64_tr_b16 v[46:47], v8 offset:45568
    v_mfma_f32_16x16x32_bf16 v[152:155], v[48:51], a[160:163], v[152:155]
    s_xor_b32 s71, s70, 1024
    ds_write_b128 v4, v[232:235] offset:36864
    v_mfma_f32_16x16x32_bf16 v[152:155], v[52:55], a[168:171], v[152:155]
    s_xor_b32 s72, s70, 2048
    v_mfma_f32_16x16x32_bf16 v[152:155], v[56:59], a[176:179], v[152:155]
    s_xor_b32 s73, s70, 3072
    v_mfma_f32_16x16x32_bf16 v[152:155], v[60:63], a[184:187], v[152:155]
    s_lshl_b32 s69, s5, 2
    ds_write_b128 v4, v[236:239] offset:38912
    v_mfma_f32_16x16x32_bf16 v[156:159], v[48:51], a[164:167], v[156:159]
    s_add_u32 s69, s69, s3
    v_mfma_f32_16x16x32_bf16 v[156:159], v[52:55], a[172:175], v[156:159]
    s_lshl_b32 s60, s5, 2
    v_mfma_f32_16x16x32_bf16 v[156:159], v[56:59], a[180:183], v[156:159]
    s_lshl_b32 s84, s4, 11
    buffer_load_dword v17, v191, s[24:27], 0 offen
    v_mfma_f32_16x16x32_bf16 v[156:159], v[60:63], a[188:191], v[156:159]
    s_add_u32 s84, s84, s60
    s_waitcnt lgkmcnt(2)
    v_mfma_f32_16x16x32_bf16 v[64:67], v[32:35], a[0:3], 0
    s_add_u32 s84, s84, 32
    ds_read_b64_tr_b16 v[48:49], v10 offset:32768
    ds_read_b128 a[64:67], v6 offset:0
    v_mfma_f32_16x16x32_bf16 v[64:67], v[36:39], a[8:11], v[64:67]
    s_add_u32 m0, s56, 18432
    ds_read_b64_tr_b16 v[50:51], v10 offset:33280
    ds_read_b128 a[72:75], v7 offset:1024
    v_mfma_f32_16x16x32_bf16 v[64:67], v[40:43], a[16:19], v[64:67]
    s_add_u32 s59, s87, s57
    ds_read_b64_tr_b16 v[52:53], v10 offset:36864
    ds_read_b128 a[80:83], v6 offset:2048
    v_mfma_f32_16x16x32_bf16 v[64:67], v[44:47], a[24:27], v[64:67]
    s_add_u32 s59, s59, 57344
    buffer_load_dwordx4 v14, s[16:19], s59 offen lds
    ds_read_b64_tr_b16 v[54:55], v10 offset:37376
    v_mfma_f32_16x16x32_bf16 v[68:71], v[32:35], a[4:7], 0
    s_and_b32 s60, s6, 3
    ds_read_b64_tr_b16 v[56:57], v10 offset:40960
    ds_read_b128 a[88:91], v7 offset:3072
    v_mfma_f32_16x16x32_bf16 v[68:71], v[36:39], a[12:15], v[68:71]
    s_bfe_u32 s61, s6, 0x20002
    ds_read_b64_tr_b16 v[58:59], v10 offset:41472
    ds_read_b128 a[68:71], v6 offset:4096
    v_mfma_f32_16x16x32_bf16 v[68:71], v[40:43], a[20:23], v[68:71]
    s_lshl_b32 s61, s61, 1
    buffer_load_dwordx4 v15, s[16:19], s59 offen offset:1024 lds
    ds_read_b64_tr_b16 v[60:61], v10 offset:45056
    v_mfma_f32_16x16x32_bf16 v[68:71], v[44:47], a[28:31], v[68:71]
    s_and_b32 s65, s6, 1
    ds_read_b64_tr_b16 v[62:63], v10 offset:45568
    ds_read_b128 a[76:79], v7 offset:5120
    v_mfma_f32_16x16x32_bf16 v[72:75], v[32:35], a[128:131], 0
    s_xor_b32 s65, s65, 1
    ds_write_b128 v4, v[248:251] offset:36992
    v_mfma_f32_16x16x32_bf16 v[72:75], v[36:39], a[136:139], v[72:75]
    s_add_u32 s61, s61, s65
    v_mfma_f32_16x16x32_bf16 v[72:75], v[40:43], a[144:147], v[72:75]
    s_lshl_b32 s62, s61, 7
    v_mfma_f32_16x16x32_bf16 v[72:75], v[44:47], a[152:155], v[72:75]
    s_lshl_b32 s63, s60, 2
    ds_write_b128 v4, v[252:255] offset:39040
    v_mfma_f32_16x16x32_bf16 v[76:79], v[32:35], a[132:135], 0
    s_lshl_b32 s65, s7, 4
    v_mfma_f32_16x16x32_bf16 v[76:79], v[36:39], a[140:143], v[76:79]
    s_add_u32 s63, s63, s65
    v_mfma_f32_16x16x32_bf16 v[76:79], v[40:43], a[148:151], v[76:79]
    s_mul_i32 s60, s60, 3
    ds_read_b128 a[84:87], v6 offset:6144
    ds_read_b128 a[92:95], v7 offset:7168
    v_mfma_f32_16x16x32_bf16 v[76:79], v[44:47], a[156:159], v[76:79]
    s_waitcnt vmcnt(10) lgkmcnt(2)
    s_barrier
    v_mfma_f32_16x16x32_bf16 v[80:83], v[48:51], a[0:3], 0
    s_add_u32 s0, s60, s61
    ds_read_b64_tr_b16 v[32:33], v8 offset:49152
    v_lshrrev_b32_e64 v28, 2, v1
    v_mfma_f32_16x16x32_bf16 v[80:83], v[52:55], a[8:11], v[80:83]
    s_lshl_b32 s0, s0, 17
    ds_read_b64_tr_b16 v[34:35], v8 offset:49664
    v_lshlrev_b32 v28, 31, v28
    v_mfma_f32_16x16x32_bf16 v[80:83], v[56:59], a[16:19], v[80:83]
    s_add_u32 m0, s56, 32768
    ds_read_b64_tr_b16 v[36:37], v8 offset:53248
    v_lshrrev_b32_e64 v29, 16, v28
    v_mfma_f32_16x16x32_bf16 v[80:83], v[60:63], a[24:27], v[80:83]
    s_add_u32 s59, s86, s57
    buffer_load_dwordx4 v14, s[20:23], s59 offen lds
    ds_read_b64_tr_b16 v[38:39], v8 offset:53760
    v_mfma_f32_16x16x32_bf16 v[84:87], v[48:51], a[4:7], 0
    s_add_u32 s0, s0, s62
    ds_read_b64_tr_b16 v[40:41], v8 offset:57344
    v_or_b32_e64 v28, v28, v29
    v_mfma_f32_16x16x32_bf16 v[84:87], v[52:55], a[12:15], v[84:87]
    s_and_b32 s6, s0, 0x7ffff
    ds_read_b64_tr_b16 v[42:43], v8 offset:57856
    v_xor_b32_e64 v20, v20, v28
    v_mfma_f32_16x16x32_bf16 v[84:87], v[56:59], a[20:23], v[84:87]
    s_and_b32 s7, s0, 0x3ffff
    buffer_load_dwordx4 v15, s[20:23], s59 offen offset:1024 lds
    ds_read_b64_tr_b16 v[44:45], v8 offset:61440
    v_mfma_f32_16x16x32_bf16 v[84:87], v[60:63], a[28:31], v[84:87]
    s_and_b32 s0, s0, 0x7ffff
    ds_read_b64_tr_b16 v[46:47], v8 offset:61952
    v_xor_b32_e64 v21, v21, v28
    v_mfma_f32_16x16x32_bf16 v[88:91], v[48:51], a[128:131], 0
    s_mov_b32 s74, 0x3fb8aa3b
    buffer_store_dwordx4 v[184:187], v188, s[48:51], s83 offen sc1
    v_mfma_f32_16x16x32_bf16 v[88:91], v[52:55], a[136:139], v[88:91]
    s_mov_b32 s76, 0xbfb8aa3b
    v_xor_b32 v22, v22, v28
    v_xor_b32 v23, v23, v28
    v_mfma_f32_16x16x32_bf16 v[88:91], v[56:59], a[144:147], v[88:91]
    s_lshl_b32 s67, s5, 2
    v_xor_b32 v24, v24, v28
    v_xor_b32_e64 v25, v25, v28
    v_mfma_f32_16x16x32_bf16 v[88:91], v[60:63], a[152:155], v[88:91]
    s_lshl_b32 s68, s4, 12
    ds_read_b128 a[192:195], v6 offset:8192
    v_lshl_add_u32 v183, v5, 2, s68
    v_mfma_f32_16x16x32_bf16 v[92:95], v[48:51], a[132:135], 0
    s_mov_b32 s78, 0x00ff00ff
    ds_read_b128 a[200:203], v7 offset:9216
    v_xor_b32 v26, v26, v28
    v_mfma_f32_16x16x32_bf16 v[92:95], v[52:55], a[140:143], v[92:95]
    s_mov_b32 s79, 0x00ff00ff
    ds_read_b128 a[208:211], v6 offset:10240
    v_xor_b32_e64 v27, v27, v28
    v_mfma_f32_16x16x32_bf16 v[92:95], v[56:59], a[148:151], v[92:95]
    ds_read_b128 a[216:219], v7 offset:11264
    v_cndmask_b32 v192, 0, v20, s[78:79]
    v_mfma_f32_16x16x32_bf16 v[92:95], v[60:63], a[156:159], v[92:95]
    s_waitcnt lgkmcnt(4)
    ds_read_b128 a[196:199], v6 offset:12288
    v_cndmask_b32 v194, v20, 0, s[78:79]
    v_mfma_f32_16x16x32_bf16 v[128:131], v[32:35], a[64:67], v[128:131]
    ds_read_b64_tr_b16 v[48:49], v10 offset:49152
    v_cndmask_b32 v193, 0, v21, s[78:79]
    v_mfma_f32_16x16x32_bf16 v[128:131], v[36:39], a[72:75], v[128:131]
    ds_read_b64_tr_b16 v[50:51], v10 offset:49664
    v_cndmask_b32 v195, v21, 0, s[78:79]
    v_mfma_f32_16x16x32_bf16 v[128:131], v[40:43], a[80:83], v[128:131]
    ds_read_b64_tr_b16 v[52:53], v10 offset:53248
    v_cndmask_b32 v196, 0, v22, s[78:79]
    v_mfma_f32_16x16x32_bf16 v[128:131], v[44:47], a[88:91], v[128:131]
    ds_read_b64_tr_b16 v[54:55], v10 offset:53760
    v_cndmask_b32 v198, v22, 0, s[78:79]
    v_mfma_f32_16x16x32_bf16 v[132:135], v[32:35], a[68:71], v[132:135]
    ds_read_b64_tr_b16 v[56:57], v10 offset:57344
    v_cndmask_b32 v197, 0, v23, s[78:79]
    v_mfma_f32_16x16x32_bf16 v[132:135], v[36:39], a[76:79], v[132:135]
    ds_read_b64_tr_b16 v[58:59], v10 offset:57856
    v_cndmask_b32 v199, v23, 0, s[78:79]
    v_mfma_f32_16x16x32_bf16 v[132:135], v[40:43], a[84:87], v[132:135]
    ds_read_b64_tr_b16 v[60:61], v10 offset:61440
    v_cndmask_b32 v200, 0, v24, s[78:79]
    v_mfma_f32_16x16x32_bf16 v[132:135], v[44:47], a[92:95], v[132:135]
    s_waitcnt lgkmcnt(6)
    ds_read_b64_tr_b16 v[62:63], v10 offset:61952
    v_cndmask_b32 v202, v24, 0, s[78:79]
    v_mfma_f32_16x16x32_bf16 v[136:139], v[32:35], a[192:195], v[136:139]
    s_add_u32 m0, s56, 34816
    ds_read_b128 a[204:207], v7 offset:13312
    v_cndmask_b32 v201, 0, v25, s[78:79]
    v_mfma_f32_16x16x32_bf16 v[136:139], v[36:39], a[200:203], v[136:139]
    s_add_u32 s59, s86, s57
    ds_read_b128 a[212:215], v6 offset:14336
    v_cndmask_b32 v203, v25, 0, s[78:79]
    v_mfma_f32_16x16x32_bf16 v[136:139], v[40:43], a[208:211], v[136:139]
    s_add_u32 s59, s59, 57344
    buffer_load_dwordx4 v14, s[20:23], s59 offen lds
    v_mfma_f32_16x16x32_bf16 v[136:139], v[44:47], a[216:219], v[136:139]
    ds_read_b128 a[220:223], v7 offset:15360
    v_cndmask_b32 v204, 0, v26, s[78:79]
    v_mfma_f32_16x16x32_bf16 v[140:143], v[32:35], a[196:199], v[140:143]
    s_waitcnt lgkmcnt(2)
    buffer_load_dwordx4 v15, s[20:23], s59 offen offset:1024 lds
    v_mfma_f32_16x16x32_bf16 v[140:143], v[36:39], a[204:207], v[140:143]
    s_waitcnt lgkmcnt(1)
    ds_read_b128 a[96:99], v6 offset:32768
    v_cndmask_b32 v206, v26, 0, s[78:79]
    v_mfma_f32_16x16x32_bf16 v[140:143], v[40:43], a[212:215], v[140:143]
    s_waitcnt lgkmcnt(1)
    ds_read_b128 a[104:107], v7 offset:33792
    v_cndmask_b32 v205, 0, v27, s[78:79]
    v_mfma_f32_16x16x32_bf16 v[140:143], v[44:47], a[220:223], v[140:143]
    s_waitcnt vmcnt(11)
    s_barrier
    v_mfma_f32_16x16x32_bf16 v[144:147], v[48:51], a[64:67], v[144:147]
    ds_read_b64_tr_b16 v[32:33], v8 offset:0
    ds_read_b128 a[112:115], v6 offset:34816
    v_mfma_f32_16x16x32_bf16 v[144:147], v[52:55], a[72:75], v[144:147]
    ds_read_b64_tr_b16 v[34:35], v8 offset:512
    ds_read_b128 a[120:123], v7 offset:35840
    v_mfma_f32_16x16x32_bf16 v[144:147], v[56:59], a[80:83], v[144:147]
    ds_read_b64_tr_b16 v[36:37], v8 offset:4096
    ds_read_b128 a[100:103], v6 offset:36864
    v_mfma_f32_16x16x32_bf16 v[144:147], v[60:63], a[88:91], v[144:147]
    ds_read_b64_tr_b16 v[38:39], v8 offset:4608
    ds_read_b128 a[108:111], v7 offset:37888
    v_mfma_f32_16x16x32_bf16 v[148:151], v[48:51], a[68:71], v[148:151]
    ds_read_b64_tr_b16 v[40:41], v8 offset:8192
    ds_read_b128 a[116:119], v6 offset:38912
    v_mfma_f32_16x16x32_bf16 v[148:151], v[52:55], a[76:79], v[148:151]
    ds_read_b64_tr_b16 v[42:43], v8 offset:8704
    ds_read_b128 a[124:127], v7 offset:39936
    v_mfma_f32_16x16x32_bf16 v[148:151], v[56:59], a[84:87], v[148:151]
    ds_read_b64_tr_b16 v[44:45], v8 offset:12288
    ds_read_b128 a[224:227], v6 offset:40960
    v_mfma_f32_16x16x32_bf16 v[148:151], v[60:63], a[92:95], v[148:151]
    s_add_u32 m0, s56, 49152
    ds_read_b64_tr_b16 v[46:47], v8 offset:12800
    ds_read_b128 a[232:235], v7 offset:41984
    v_mfma_f32_16x16x32_bf16 v[152:155], v[48:51], a[192:195], v[152:155]
    s_add_u32 s59, s87, s57
    buffer_load_dwordx4 v14, s[20:23], s59 offen lds
    ds_read_b128 a[240:243], v6 offset:43008
    v_mfma_f32_16x16x32_bf16 v[152:155], v[52:55], a[200:203], v[152:155]
    ds_read_b128 a[248:251], v7 offset:44032
    ds_read_b128 a[228:231], v6 offset:45056
    v_mfma_f32_16x16x32_bf16 v[152:155], v[56:59], a[208:211], v[152:155]
    buffer_load_dwordx4 v15, s[20:23], s59 offen offset:1024 lds
    ds_read_b128 a[236:239], v7 offset:46080
    v_mfma_f32_16x16x32_bf16 v[152:155], v[60:63], a[216:219], v[152:155]
    s_add_u32 m0, s56, 51200
    s_add_u32 s59, s87, s57
    ds_read_b128 a[244:247], v6 offset:47104
    ds_read_b128 a[252:255], v7 offset:48128
    v_mfma_f32_16x16x32_bf16 v[156:159], v[48:51], a[196:199], v[156:159]
    s_add_u32 s59, s59, 57344
    buffer_load_dwordx4 v14, s[20:23], s59 offen lds
    v_mfma_f32_16x16x32_bf16 v[156:159], v[52:55], a[204:207], v[156:159]
    v_cndmask_b32 v207, v27, 0, s[78:79]
    v_mfma_f32_16x16x32_bf16 v[156:159], v[56:59], a[212:215], v[156:159]
    buffer_load_dwordx4 v15, s[20:23], s59 offen offset:1024 lds
    v_mfma_f32_16x16x32_bf16 v[156:159], v[60:63], a[220:223], v[156:159]
    s_waitcnt lgkmcnt(6)
    v_mfma_f32_16x16x32_bf16 v[128:131], v[32:35], a[96:99], v[128:131]
    ds_read_b64_tr_b16 v[48:49], v10 offset:0
    v_mfma_f32_16x16x32_bf16 v[128:131], v[36:39], a[104:107], v[128:131]
    ds_read_b64_tr_b16 v[50:51], v10 offset:512
    v_mfma_f32_16x16x32_bf16 v[128:131], v[40:43], a[112:115], v[128:131]
    ds_read_b64_tr_b16 v[52:53], v10 offset:4096
    v_mfma_f32_16x16x32_bf16 v[128:131], v[44:47], a[120:123], v[128:131]
    ds_read_b64_tr_b16 v[54:55], v10 offset:4608
    v_mfma_f32_16x16x32_bf16 v[132:135], v[32:35], a[100:103], v[132:135]
    ds_read_b64_tr_b16 v[56:57], v10 offset:8192
    v_mfma_f32_16x16x32_bf16 v[132:135], v[36:39], a[108:111], v[132:135]
    ds_read_b64_tr_b16 v[58:59], v10 offset:8704
    v_mfma_f32_16x16x32_bf16 v[132:135], v[40:43], a[116:119], v[132:135]
    ds_read_b64_tr_b16 v[60:61], v10 offset:12288
    v_mfma_f32_16x16x32_bf16 v[132:135], v[44:47], a[124:127], v[132:135]
    s_add_u32 m0, s56, 65536
    ds_read_b64_tr_b16 v[62:63], v10 offset:12800
    v_mfma_f32_16x16x32_bf16 v[136:139], v[32:35], a[224:227], v[136:139]
    s_add_u32 s59, s88, s57
    buffer_load_dwordx4 v14, s[16:19], s59 offen lds
    v_mfma_f32_16x16x32_bf16 v[136:139], v[36:39], a[232:235], v[136:139]
    s_waitcnt lgkmcnt(6)
    v_mfma_f32_16x16x32_bf16 v[136:139], v[40:43], a[240:243], v[136:139]
    buffer_load_dwordx4 v15, s[16:19], s59 offen offset:1024 lds
    v_mfma_f32_16x16x32_bf16 v[136:139], v[44:47], a[248:251], v[136:139]
    s_add_u32 m0, s56, 67584
    s_add_u32 s59, s88, s57
    v_mfma_f32_16x16x32_bf16 v[140:143], v[32:35], a[228:231], v[140:143]
    s_add_u32 s59, s59, 57344
    buffer_load_dwordx4 v14, s[16:19], s59 offen lds
    v_mfma_f32_16x16x32_bf16 v[140:143], v[36:39], a[236:239], v[140:143]
    v_mfma_f32_16x16x32_bf16 v[140:143], v[40:43], a[244:247], v[140:143]
    buffer_load_dwordx4 v15, s[16:19], s59 offen offset:1024 lds
    v_mfma_f32_16x16x32_bf16 v[140:143], v[44:47], a[252:255], v[140:143]
    s_waitcnt vmcnt(10) lgkmcnt(0)
    s_barrier
    buffer_store_dword v182, v183, s[40:43], s67 offen sc1
    v_mfma_f32_16x16x32_bf16 v[144:147], v[48:51], a[96:99], v[144:147]
    ds_read_b64_tr_b16 v[32:33], v8 offset:16384
    v_mfma_f32_16x16x32_bf16 v[144:147], v[52:55], a[104:107], v[144:147]
    ds_read_b64_tr_b16 v[34:35], v8 offset:16896
    v_mfma_f32_16x16x32_bf16 v[144:147], v[56:59], a[112:115], v[144:147]
    ds_read_b64_tr_b16 v[36:37], v8 offset:20480
    v_mfma_f32_16x16x32_bf16 v[144:147], v[60:63], a[120:123], v[144:147]
    ds_read_b64_tr_b16 v[38:39], v8 offset:20992
    v_mfma_f32_16x16x32_bf16 v[148:151], v[48:51], a[100:103], v[148:151]
    ds_read_b64_tr_b16 v[40:41], v8 offset:24576
    v_mfma_f32_16x16x32_bf16 v[148:151], v[52:55], a[108:111], v[148:151]
    ds_read_b64_tr_b16 v[42:43], v8 offset:25088
    v_mfma_f32_16x16x32_bf16 v[148:151], v[56:59], a[116:119], v[148:151]
    ds_read_b64_tr_b16 v[44:45], v8 offset:28672
    v_mfma_f32_16x16x32_bf16 v[148:151], v[60:63], a[124:127], v[148:151]
    s_add_u32 m0, s56, 81920
    ds_read_b64_tr_b16 v[46:47], v8 offset:29184
    v_mfma_f32_16x16x32_bf16 v[152:155], v[48:51], a[224:227], v[152:155]
    s_add_u32 s59, s88, s57
    buffer_load_dwordx4 v14, s[20:23], s59 offen lds
    v_mfma_f32_16x16x32_bf16 v[152:155], v[52:55], a[232:235], v[152:155]
    v_mfma_f32_16x16x32_bf16 v[152:155], v[56:59], a[240:243], v[152:155]
    buffer_load_dwordx4 v15, s[20:23], s59 offen offset:1024 lds
    v_mfma_f32_16x16x32_bf16 v[152:155], v[60:63], a[248:251], v[152:155]
    s_add_u32 m0, s56, 83968
    s_add_u32 s59, s88, s57
    v_mfma_f32_16x16x32_bf16 v[156:159], v[48:51], a[228:231], v[156:159]
    s_add_u32 s59, s59, 57344
    buffer_load_dwordx4 v14, s[20:23], s59 offen lds
    v_mfma_f32_16x16x32_bf16 v[156:159], v[52:55], a[236:239], v[156:159]
    v_mfma_f32_16x16x32_bf16 v[156:159], v[56:59], a[244:247], v[156:159]
    buffer_load_dwordx4 v15, s[20:23], s59 offen offset:1024 lds
    v_mfma_f32_16x16x32_bf16 v[156:159], v[60:63], a[252:255], v[156:159]
    s_waitcnt lgkmcnt(0)
    v_mfma_f32_16x16x32_bf16 v[64:67], v[32:35], a[32:35], v[64:67]
    ds_read_b64_tr_b16 v[48:49], v10 offset:16384
    v_mfma_f32_16x16x32_bf16 v[64:67], v[36:39], a[40:43], v[64:67]
    ds_read_b64_tr_b16 v[50:51], v10 offset:16896
    v_mfma_f32_16x16x32_bf16 v[64:67], v[40:43], a[48:51], v[64:67]
    ds_read_b64_tr_b16 v[52:53], v10 offset:20480
    v_mfma_f32_16x16x32_bf16 v[64:67], v[44:47], a[56:59], v[64:67]
    ds_read_b64_tr_b16 v[54:55], v10 offset:20992
    v_cvt_pk_bf16_f32 v128, v128, v129
    v_mfma_f32_16x16x32_bf16 v[68:71], v[32:35], a[36:39], v[68:71]
    ds_read_b64_tr_b16 v[56:57], v10 offset:24576
    v_cvt_pk_bf16_f32 v129, v130, v131
    v_mfma_f32_16x16x32_bf16 v[68:71], v[36:39], a[44:47], v[68:71]
    ds_read_b64_tr_b16 v[58:59], v10 offset:25088
    v_cvt_pk_bf16_f32 v130, v144, v145
    v_mfma_f32_16x16x32_bf16 v[68:71], v[40:43], a[52:55], v[68:71]
    ds_read_b64_tr_b16 v[60:61], v10 offset:28672
    v_cvt_pk_bf16_f32 v131, v146, v147
    s_nop 1
    v_mfma_f32_16x16x32_bf16 v[224:227], v[192:195], v[128:131], 0
    v_cvt_pk_bf16_f32 v132, v132, v133
    v_cvt_pk_bf16_f32 v133, v134, v135
    v_mfma_f32_16x16x32_bf16 v[228:231], v[196:199], v[128:131], 0
    v_cvt_pk_bf16_f32 v134, v148, v149
    v_cvt_pk_bf16_f32 v135, v150, v151
    v_mfma_f32_16x16x32_bf16 v[232:235], v[200:203], v[128:131], 0
    v_cvt_pk_bf16_f32 v136, v136, v137
    v_cvt_pk_bf16_f32 v137, v138, v139
    v_mfma_f32_16x16x32_bf16 v[236:239], v[204:207], v[128:131], 0
    v_max3_f32 v208, v224, v225, v226
    v_cvt_pk_bf16_f32 v138, v152, v153
    v_mfma_f32_16x16x32_bf16 v[240:243], v[192:195], v[132:135], 0
    v_max3_f32 v209, v227, v228, v229
    v_cvt_pk_bf16_f32 v139, v154, v155
    v_mfma_f32_16x16x32_bf16 v[244:247], v[196:199], v[132:135], 0
    v_max3_f32 v210, v230, v231, v232
    v_max3_f32 v211, v233, v234, v235
    v_mfma_f32_16x16x32_bf16 v[248:251], v[200:203], v[132:135], 0
    v_max3_f32 v212, v236, v237, v238
    v_max3_f32 v208, v208, v209, v210
    v_mfma_f32_16x16x32_bf16 v[252:255], v[204:207], v[132:135], 0
    v_max3_f32 v211, v211, v212, v239
    v_max_f32_e64 v208, v208, v211
    v_mfma_f32_16x16x32_bf16 v[68:71], v[44:47], a[60:63], v[68:71]
    s_add_u32 m0, s56, 0
    ds_read_b64_tr_b16 v[62:63], v10 offset:29184
    v_mul_f32 v208, s76, v208
    v_mfma_f32_16x16x32_bf16 v[72:75], v[32:35], a[160:163], v[72:75]
    s_add_u32 s59, s89, s57
    buffer_load_dwordx4 v14, s[16:19], s59 offen lds
    v_mfma_f32_16x16x32_bf16 v[72:75], v[36:39], a[168:171], v[72:75]
    v_fma_f32 v224, v224, s74, v208
    v_fma_f32 v225, v225, s74, v208
    v_mfma_f32_16x16x32_bf16 v[72:75], v[40:43], a[176:179], v[72:75]
    buffer_load_dwordx4 v15, s[16:19], s59 offen offset:1024 lds
    v_mfma_f32_16x16x32_bf16 v[72:75], v[44:47], a[184:187], v[72:75]
    s_add_u32 m0, s56, 98304
    v_exp_f32 v224, v224
    v_mfma_f32_16x16x32_bf16 v[76:79], v[32:35], a[164:167], v[76:79]
    s_xor_b32 s59, s0, 0
    buffer_load_dwordx4 v16, s[24:27], s59 offen lds
    v_mfma_f32_16x16x32_bf16 v[76:79], v[36:39], a[172:175], v[76:79]
    v_exp_f32 v225, v225
    v_mfma_f32_16x16x32_bf16 v[76:79], v[40:43], a[180:183], v[76:79]
    buffer_load_dwordx4 v19, s[24:27], s59 offen offset:1024 lds
    v_mfma_f32_16x16x32_bf16 v[76:79], v[44:47], a[188:191], v[76:79]
    s_waitcnt vmcnt(17) lgkmcnt(0)
    s_barrier
    v_mfma_f32_16x16x32_bf16 v[80:83], v[48:51], a[32:35], v[80:83]
    ds_read_b64_tr_b16 v[32:33], v8 offset:32768
    v_add_f32_e64 v209, v224, v225
    v_mfma_f32_16x16x32_bf16 v[80:83], v[52:55], a[40:43], v[80:83]
    ds_read_b64_tr_b16 v[34:35], v8 offset:33280
    v_fma_f32 v226, v226, s74, v208
    v_mfma_f32_16x16x32_bf16 v[80:83], v[56:59], a[48:51], v[80:83]
    ds_read_b64_tr_b16 v[36:37], v8 offset:36864
    v_fma_f32 v227, v227, s74, v208
    v_mfma_f32_16x16x32_bf16 v[80:83], v[60:63], a[56:59], v[80:83]
    ds_read_b64_tr_b16 v[38:39], v8 offset:37376
    v_fma_f32 v228, v228, s74, v208
    v_mfma_f32_16x16x32_bf16 v[84:87], v[48:51], a[36:39], v[84:87]
    ds_read_b64_tr_b16 v[40:41], v8 offset:40960
    v_fma_f32 v229, v229, s74, v208
    v_mfma_f32_16x16x32_bf16 v[84:87], v[52:55], a[44:47], v[84:87]
    ds_read_b64_tr_b16 v[42:43], v8 offset:41472
    v_fma_f32 v230, v230, s74, v208
    v_mfma_f32_16x16x32_bf16 v[84:87], v[56:59], a[52:55], v[84:87]
    s_add_u32 m0, s56, 2048
    ds_read_b64_tr_b16 v[44:45], v8 offset:45056
    v_fma_f32 v231, v231, s74, v208
    v_mfma_f32_16x16x32_bf16 v[84:87], v[60:63], a[60:63], v[84:87]
    s_add_u32 s59, s89, s57
    ds_read_b64_tr_b16 v[46:47], v8 offset:45568
    v_fma_f32 v232, v232, s74, v208
    v_mfma_f32_16x16x32_bf16 v[88:91], v[48:51], a[160:163], v[88:91]
    s_add_u32 s59, s59, 57344
    buffer_load_dwordx4 v14, s[16:19], s59 offen lds
    v_mfma_f32_16x16x32_bf16 v[88:91], v[52:55], a[168:171], v[88:91]
    v_exp_f32 v226, v226
    v_mfma_f32_16x16x32_bf16 v[88:91], v[56:59], a[176:179], v[88:91]
    buffer_load_dwordx4 v15, s[16:19], s59 offen offset:1024 lds
    v_mfma_f32_16x16x32_bf16 v[88:91], v[60:63], a[184:187], v[88:91]
    s_add_u32 m0, s56, 16384
    v_exp_f32_e64 v227, v227
    v_mfma_f32_16x16x32_bf16 v[92:95], v[48:51], a[164:167], v[92:95]
    s_add_u32 s59, s89, s57
    buffer_load_dwordx4 v14, s[20:23], s59 offen lds
    v_mfma_f32_16x16x32_bf16 v[92:95], v[52:55], a[172:175], v[92:95]
    v_exp_f32 v228, v228
    v_mfma_f32_16x16x32_bf16 v[92:95], v[56:59], a[180:183], v[92:95]
    buffer_load_dwordx4 v15, s[20:23], s59 offen offset:1024 lds
    v_mfma_f32_16x16x32_bf16 v[92:95], v[60:63], a[188:191], v[92:95]
    s_waitcnt lgkmcnt(0)
    v_exp_f32 v229, v229
    v_mfma_f32_16x16x32_bf16 v[96:99], v[32:35], a[0:3], 0
    ds_read_b64_tr_b16 v[48:49], v10 offset:32768
    v_add_f32_e64 v209, v209, v226
    v_mfma_f32_16x16x32_bf16 v[96:99], v[36:39], a[8:11], v[96:99]
    ds_read_b64_tr_b16 v[50:51], v10 offset:33280
    v_add_f32_e64 v209, v209, v227
    v_mfma_f32_16x16x32_bf16 v[96:99], v[40:43], a[16:19], v[96:99]
    ds_read_b64_tr_b16 v[52:53], v10 offset:36864
    v_add_f32_e64 v209, v209, v228
    v_mfma_f32_16x16x32_bf16 v[96:99], v[44:47], a[24:27], v[96:99]
    ds_read_b64_tr_b16 v[54:55], v10 offset:37376
    v_add_f32_e64 v209, v209, v229
    v_mfma_f32_16x16x32_bf16 v[100:103], v[32:35], a[4:7], 0
    ds_read_b64_tr_b16 v[56:57], v10 offset:40960
    v_fma_f32 v233, v233, s74, v208
    v_mfma_f32_16x16x32_bf16 v[100:103], v[36:39], a[12:15], v[100:103]
    ds_read_b64_tr_b16 v[58:59], v10 offset:41472
    v_fma_f32 v234, v234, s74, v208
    v_mfma_f32_16x16x32_bf16 v[100:103], v[40:43], a[20:23], v[100:103]
    s_add_u32 m0, s56, 18432
    ds_read_b64_tr_b16 v[60:61], v10 offset:45056
    v_fma_f32 v235, v235, s74, v208
    v_mfma_f32_16x16x32_bf16 v[100:103], v[44:47], a[28:31], v[100:103]
    s_add_u32 s59, s89, s57
    ds_read_b64_tr_b16 v[62:63], v10 offset:45568
    v_fma_f32 v236, v236, s74, v208
    v_mfma_f32_16x16x32_bf16 v[104:107], v[32:35], a[128:131], 0
    s_add_u32 s59, s59, 57344
    buffer_load_dwordx4 v14, s[20:23], s59 offen lds
    v_mfma_f32_16x16x32_bf16 v[104:107], v[36:39], a[136:139], v[104:107]
    v_exp_f32 v230, v230
    v_mfma_f32_16x16x32_bf16 v[104:107], v[40:43], a[144:147], v[104:107]
    buffer_load_dwordx4 v15, s[20:23], s59 offen offset:1024 lds
    v_mfma_f32_16x16x32_bf16 v[104:107], v[44:47], a[152:155], v[104:107]
    s_add_u32 m0, s56, 100352
    v_exp_f32_e64 v231, v231
    v_mfma_f32_16x16x32_bf16 v[108:111], v[32:35], a[132:135], 0
    s_xor_b32 s59, s0, 16384
    buffer_load_dwordx4 v16, s[24:27], s59 offen lds
    v_mfma_f32_16x16x32_bf16 v[108:111], v[36:39], a[140:143], v[108:111]
    v_exp_f32_e64 v232, v232
    v_mfma_f32_16x16x32_bf16 v[108:111], v[40:43], a[148:151], v[108:111]
    buffer_load_dwordx4 v19, s[24:27], s59 offen offset:1024 lds
    v_mfma_f32_16x16x32_bf16 v[108:111], v[44:47], a[156:159], v[108:111]
    s_waitcnt vmcnt(21) lgkmcnt(0)
    s_barrier
    v_mfma_f32_16x16x32_bf16 v[112:115], v[48:51], a[0:3], 0
    ds_read_b64_tr_b16 v[32:33], v8 offset:49152
    v_add_f32_e64 v209, v209, v230
    v_mfma_f32_16x16x32_bf16 v[112:115], v[52:55], a[8:11], v[112:115]
    ds_read_b64_tr_b16 v[34:35], v8 offset:49664
    v_add_f32_e64 v209, v209, v231
    v_mfma_f32_16x16x32_bf16 v[112:115], v[56:59], a[16:19], v[112:115]
    ds_read_b64_tr_b16 v[36:37], v8 offset:53248
    v_add_f32_e64 v209, v209, v232
    v_mfma_f32_16x16x32_bf16 v[112:115], v[60:63], a[24:27], v[112:115]
    ds_read_b64_tr_b16 v[38:39], v8 offset:53760
    v_fma_f32 v237, v237, s74, v208
    v_mfma_f32_16x16x32_bf16 v[116:119], v[48:51], a[4:7], 0
    ds_read_b64_tr_b16 v[40:41], v8 offset:57344
    v_fma_f32 v238, v238, s74, v208
    v_mfma_f32_16x16x32_bf16 v[116:119], v[52:55], a[12:15], v[116:119]
    ds_read_b64_tr_b16 v[42:43], v8 offset:57856
    v_fma_f32 v239, v239, s74, v208
    v_mfma_f32_16x16x32_bf16 v[116:119], v[56:59], a[20:23], v[116:119]
    ds_read_b64_tr_b16 v[44:45], v8 offset:61440
    v_max3_f32 v213, v240, v241, v242
    v_mfma_f32_16x16x32_bf16 v[116:119], v[60:63], a[28:31], v[116:119]
    ds_read_b64_tr_b16 v[46:47], v8 offset:61952
    v_max3_f32 v214, v243, v244, v245
    v_mfma_f32_16x16x32_bf16 v[120:123], v[48:51], a[128:131], 0
    s_add_u32 m0, s56, 32768
    v_exp_f32_e64 v233, v233
    v_mfma_f32_16x16x32_bf16 v[120:123], v[52:55], a[136:139], v[120:123]
    s_add_u32 s59, s86, s57
    v_exp_f32 v234, v234
    v_mfma_f32_16x16x32_bf16 v[120:123], v[56:59], a[144:147], v[120:123]
    s_add_u32 s59, s59, 2048
    buffer_load_dwordx4 v14, s[16:19], s59 offen lds
    v_mfma_f32_16x16x32_bf16 v[120:123], v[60:63], a[152:155], v[120:123]
    v_exp_f32_e64 v235, v235
    v_mfma_f32_16x16x32_bf16 v[124:127], v[48:51], a[132:135], 0
    buffer_load_dwordx4 v15, s[16:19], s59 offen offset:1024 lds
    v_mfma_f32_16x16x32_bf16 v[124:127], v[52:55], a[140:143], v[124:127]
    v_exp_f32_e64 v236, v236
    v_mfma_f32_16x16x32_bf16 v[124:127], v[56:59], a[148:151], v[124:127]
    v_exp_f32_e64 v237, v237
    v_mfma_f32_16x16x32_bf16 v[124:127], v[60:63], a[156:159], v[124:127]
    s_waitcnt lgkmcnt(0)
    v_exp_f32 v238, v238
    v_mfma_f32_16x16x32_bf16 v[96:99], v[32:35], a[32:35], v[96:99]
    ds_read_b64_tr_b16 v[48:49], v10 offset:49152
    v_add_f32_e64 v209, v209, v233
    v_mfma_f32_16x16x32_bf16 v[96:99], v[36:39], a[40:43], v[96:99]
    ds_read_b64_tr_b16 v[50:51], v10 offset:49664
    v_add_f32_e64 v209, v209, v234
    v_mfma_f32_16x16x32_bf16 v[96:99], v[40:43], a[48:51], v[96:99]
    ds_read_b64_tr_b16 v[52:53], v10 offset:53248
    v_add_f32_e64 v209, v209, v235
    v_mfma_f32_16x16x32_bf16 v[96:99], v[44:47], a[56:59], v[96:99]
    ds_read_b64_tr_b16 v[54:55], v10 offset:53760
    v_add_f32_e64 v209, v209, v236
    v_mfma_f32_16x16x32_bf16 v[100:103], v[32:35], a[36:39], v[100:103]
    ds_read_b64_tr_b16 v[56:57], v10 offset:57344
    v_add_f32_e64 v209, v209, v237
    v_mfma_f32_16x16x32_bf16 v[100:103], v[36:39], a[44:47], v[100:103]
    ds_read_b64_tr_b16 v[58:59], v10 offset:57856
    v_add_f32_e64 v209, v209, v238
    v_mfma_f32_16x16x32_bf16 v[100:103], v[40:43], a[52:55], v[100:103]
    s_add_u32 m0, s56, 34816
    ds_read_b64_tr_b16 v[60:61], v10 offset:61440
    v_max3_f32 v215, v246, v247, v248
    v_mfma_f32_16x16x32_bf16 v[100:103], v[44:47], a[60:63], v[100:103]
    s_add_u32 s59, s86, s57
    ds_read_b64_tr_b16 v[62:63], v10 offset:61952
    v_max3_f32 v216, v249, v250, v251
    v_mfma_f32_16x16x32_bf16 v[104:107], v[32:35], a[160:163], v[104:107]
    s_add_u32 s59, s59, 59392
    buffer_load_dwordx4 v14, s[16:19], s59 offen lds
    v_mfma_f32_16x16x32_bf16 v[104:107], v[36:39], a[168:171], v[104:107]
    v_exp_f32 v239, v239
    v_mfma_f32_16x16x32_bf16 v[104:107], v[40:43], a[176:179], v[104:107]
    buffer_load_dwordx4 v15, s[16:19], s59 offen offset:1024 lds
    v_mfma_f32_16x16x32_bf16 v[104:107], v[44:47], a[184:187], v[104:107]
    s_add_u32 m0, s56, 114688
    v_add_f32_e64 v209, v209, v239
    v_max3_f32 v217, v252, v253, v254
    v_mfma_f32_16x16x32_bf16 v[108:111], v[32:35], a[164:167], v[108:111]
    s_xor_b32 s59, s0, 131072
    buffer_load_dwordx4 v16, s[24:27], s59 offen lds
    v_mfma_f32_16x16x32_bf16 v[108:111], v[36:39], a[172:175], v[108:111]
    v_rcp_f32_e64 v209, v209
    v_mfma_f32_16x16x32_bf16 v[108:111], v[40:43], a[180:183], v[108:111]
    buffer_load_dwordx4 v19, s[24:27], s59 offen offset:1024 lds
    v_mfma_f32_16x16x32_bf16 v[108:111], v[44:47], a[188:191], v[108:111]
    s_waitcnt vmcnt(23) lgkmcnt(0)
    s_barrier
    v_mfma_f32_16x16x32_bf16 v[112:115], v[48:51], a[32:35], v[112:115]
    ds_read_b64_tr_b16 v[32:33], v9 offset:0
    v_mul_f32_e64 v224, v224, v209
    v_mfma_f32_16x16x32_bf16 v[112:115], v[52:55], a[40:43], v[112:115]
    ds_read_b64_tr_b16 v[34:35], v9 offset:512
    v_mul_f32_e64 v225, v225, v209
    v_mfma_f32_16x16x32_bf16 v[112:115], v[56:59], a[48:51], v[112:115]
    ds_read_b64_tr_b16 v[36:37], v9 offset:4096
    v_cvt_pk_bf16_f32 v128, v224, v225
    v_mfma_f32_16x16x32_bf16 v[112:115], v[60:63], a[56:59], v[112:115]
    ds_read_b64_tr_b16 v[38:39], v9 offset:4608
    v_mul_f32_e64 v226, v226, v209
    v_mfma_f32_16x16x32_bf16 v[116:119], v[48:51], a[36:39], v[116:119]
    ds_read_b64_tr_b16 v[40:41], v9 offset:8192
    v_mul_f32_e64 v227, v227, v209
    v_mfma_f32_16x16x32_bf16 v[116:119], v[52:55], a[44:47], v[116:119]
    ds_read_b64_tr_b16 v[42:43], v9 offset:8704
    v_cvt_pk_bf16_f32 v129, v226, v227
    v_mfma_f32_16x16x32_bf16 v[224:227], v[192:195], v[136:139], 0
    v_mul_f32 v228, v228, v209
    v_mul_f32 v229, v229, v209
    v_mfma_f32_16x16x32_bf16 v[116:119], v[56:59], a[52:55], v[116:119]
    ds_read_b64_tr_b16 v[44:45], v9 offset:12288
    v_cvt_pk_bf16_f32 v130, v228, v229
    v_mfma_f32_16x16x32_bf16 v[116:119], v[60:63], a[60:63], v[116:119]
    ds_read_b64_tr_b16 v[46:47], v9 offset:12800
    v_mul_f32_e64 v230, v230, v209
    v_mfma_f32_16x16x32_bf16 v[120:123], v[48:51], a[160:163], v[120:123]
    s_add_u32 m0, s56, 49152
    v_mul_f32_e64 v231, v231, v209
    v_cvt_pk_bf16_f32 v131, v230, v231
    v_mfma_f32_16x16x32_bf16 v[228:231], v[196:199], v[136:139], 0
    v_mul_f32 v232, v232, v209
    v_mul_f32 v233, v233, v209
    v_mfma_f32_16x16x32_bf16 v[120:123], v[52:55], a[168:171], v[120:123]
    s_add_u32 s59, s86, s57
    v_cvt_pk_bf16_f32 v144, v232, v233
    v_mul_f32 v234, v234, v209
    v_mfma_f32_16x16x32_bf16 v[120:123], v[56:59], a[176:179], v[120:123]
    s_add_u32 s59, s59, 2048
    buffer_load_dwordx4 v14, s[20:23], s59 offen lds
    v_mfma_f32_16x16x32_bf16 v[120:123], v[60:63], a[184:187], v[120:123]
    v_mul_f32_e64 v235, v235, v209
    v_cvt_pk_bf16_f32 v145, v234, v235
    v_mfma_f32_16x16x32_bf16 v[232:235], v[200:203], v[136:139], 0
    v_mul_f32 v236, v236, v209
    v_mul_f32 v237, v237, v209
    v_mfma_f32_16x16x32_bf16 v[124:127], v[48:51], a[164:167], v[124:127]
    buffer_load_dwordx4 v15, s[20:23], s59 offen offset:1024 lds
    v_mfma_f32_16x16x32_bf16 v[124:127], v[52:55], a[172:175], v[124:127]
    v_cvt_pk_bf16_f32 v146, v236, v237
    v_mul_f32_e64 v238, v238, v209
    v_mfma_f32_16x16x32_bf16 v[124:127], v[56:59], a[180:183], v[124:127]
    v_mul_f32_e64 v239, v239, v209
    v_cvt_pk_bf16_f32 v147, v238, v239
    v_mfma_f32_16x16x32_bf16 v[236:239], v[204:207], v[136:139], 0
    v_max3_f32 v213, v213, v214, v215
    v_max3_f32 v216, v216, v217, v255
    v_mfma_f32_16x16x32_bf16 v[124:127], v[60:63], a[188:191], v[124:127]
    s_waitcnt lgkmcnt(0)
    v_max_f32 v213, v213, v216
    v_mul_f32_e64 v213, s76, v213
    v_mfma_f32_16x16x32_bf16 v[64:67], v[32:35], a[64:67], v[64:67]
    ds_read_b64_tr_b16 v[48:49], v11 offset:0
    v_fma_f32 v240, v240, s74, v213
    v_mfma_f32_16x16x32_bf16 v[64:67], v[36:39], a[72:75], v[64:67]
    ds_read_b64_tr_b16 v[50:51], v11 offset:512
    v_fma_f32 v241, v241, s74, v213
    v_mfma_f32_16x16x32_bf16 v[64:67], v[40:43], a[80:83], v[64:67]
    ds_read_b64_tr_b16 v[52:53], v11 offset:4096
    v_fma_f32 v242, v242, s74, v213
    v_mfma_f32_16x16x32_bf16 v[64:67], v[44:47], a[88:91], v[64:67]
    ds_read_b64_tr_b16 v[54:55], v11 offset:4608
    v_fma_f32 v243, v243, s74, v213
    v_mfma_f32_16x16x32_bf16 v[68:71], v[32:35], a[68:71], v[68:71]
    ds_read_b64_tr_b16 v[56:57], v11 offset:8192
    v_fma_f32 v244, v244, s74, v213
    v_mfma_f32_16x16x32_bf16 v[68:71], v[36:39], a[76:79], v[68:71]
    ds_read_b64_tr_b16 v[58:59], v11 offset:8704
    v_fma_f32 v245, v245, s74, v213
    v_mfma_f32_16x16x32_bf16 v[68:71], v[40:43], a[84:87], v[68:71]
    s_add_u32 m0, s56, 51200
    ds_read_b64_tr_b16 v[60:61], v11 offset:12288
    v_fma_f32 v246, v246, s74, v213
    v_mfma_f32_16x16x32_bf16 v[68:71], v[44:47], a[92:95], v[68:71]
    s_add_u32 s59, s86, s57
    ds_read_b64_tr_b16 v[62:63], v11 offset:12800
    v_fma_f32 v247, v247, s74, v213
    v_mfma_f32_16x16x32_bf16 v[72:75], v[32:35], a[192:195], v[72:75]
    s_add_u32 s59, s59, 59392
    buffer_load_dwordx4 v14, s[20:23], s59 offen lds
    v_mfma_f32_16x16x32_bf16 v[72:75], v[36:39], a[200:203], v[72:75]
    v_exp_f32 v240, v240
    v_mfma_f32_16x16x32_bf16 v[72:75], v[40:43], a[208:211], v[72:75]
    buffer_load_dwordx4 v15, s[20:23], s59 offen offset:1024 lds
    v_mfma_f32_16x16x32_bf16 v[72:75], v[44:47], a[216:219], v[72:75]
    s_add_u32 m0, s56, 116736
    v_exp_f32_e64 v241, v241
    v_mfma_f32_16x16x32_bf16 v[76:79], v[32:35], a[196:199], v[76:79]
    s_xor_b32 s59, s0, 147456
    buffer_load_dwordx4 v16, s[24:27], s59 offen lds
    v_mfma_f32_16x16x32_bf16 v[76:79], v[36:39], a[204:207], v[76:79]
    v_exp_f32_e64 v242, v242
    v_mfma_f32_16x16x32_bf16 v[76:79], v[40:43], a[212:215], v[76:79]
    buffer_load_dwordx4 v19, s[24:27], s59 offen offset:1024 lds
    v_mfma_f32_16x16x32_bf16 v[76:79], v[44:47], a[220:223], v[76:79]
    s_waitcnt vmcnt(24) lgkmcnt(0)
    s_barrier
    v_mfma_f32_16x16x32_bf16 v[80:83], v[48:51], a[64:67], v[80:83]
    ds_read_b64_tr_b16 v[32:33], v9 offset:16384
    v_add_f32_e64 v214, v240, v241
    v_mfma_f32_16x16x32_bf16 v[80:83], v[52:55], a[72:75], v[80:83]
    ds_read_b64_tr_b16 v[34:35], v9 offset:16896
    v_add_f32_e64 v214, v214, v242
    v_mfma_f32_16x16x32_bf16 v[80:83], v[56:59], a[80:83], v[80:83]
    ds_read_b64_tr_b16 v[36:37], v9 offset:20480
    v_fma_f32 v248, v248, s74, v213
    v_mfma_f32_16x16x32_bf16 v[80:83], v[60:63], a[88:91], v[80:83]
    ds_read_b64_tr_b16 v[38:39], v9 offset:20992
    v_fma_f32 v249, v249, s74, v213
    v_mfma_f32_16x16x32_bf16 v[84:87], v[48:51], a[68:71], v[84:87]
    ds_read_b64_tr_b16 v[40:41], v9 offset:24576
    v_fma_f32 v250, v250, s74, v213
    v_mfma_f32_16x16x32_bf16 v[84:87], v[52:55], a[76:79], v[84:87]
    ds_read_b64_tr_b16 v[42:43], v9 offset:25088
    v_fma_f32 v251, v251, s74, v213
    v_mfma_f32_16x16x32_bf16 v[84:87], v[56:59], a[84:87], v[84:87]
    ds_read_b64_tr_b16 v[44:45], v9 offset:28672
    v_fma_f32 v252, v252, s74, v213
    v_mfma_f32_16x16x32_bf16 v[84:87], v[60:63], a[92:95], v[84:87]
    ds_read_b64_tr_b16 v[46:47], v9 offset:29184
    v_fma_f32 v253, v253, s74, v213
    v_mfma_f32_16x16x32_bf16 v[88:91], v[48:51], a[192:195], v[88:91]
    s_add_u32 m0, s56, 65536
    v_exp_f32_e64 v243, v243
    v_mfma_f32_16x16x32_bf16 v[88:91], v[52:55], a[200:203], v[88:91]
    s_add_u32 s59, s87, s57
    v_exp_f32 v244, v244
    v_mfma_f32_16x16x32_bf16 v[88:91], v[56:59], a[208:211], v[88:91]
    s_add_u32 s59, s59, 2048
    buffer_load_dwordx4 v14, s[16:19], s59 offen lds
    v_mfma_f32_16x16x32_bf16 v[88:91], v[60:63], a[216:219], v[88:91]
    v_exp_f32_e64 v245, v245
    v_mfma_f32_16x16x32_bf16 v[92:95], v[48:51], a[196:199], v[92:95]
    buffer_load_dwordx4 v15, s[16:19], s59 offen offset:1024 lds
    v_mfma_f32_16x16x32_bf16 v[92:95], v[52:55], a[204:207], v[92:95]
    v_exp_f32_e64 v246, v246
    v_mfma_f32_16x16x32_bf16 v[92:95], v[56:59], a[212:215], v[92:95]
    v_exp_f32_e64 v247, v247
    v_mfma_f32_16x16x32_bf16 v[92:95], v[60:63], a[220:223], v[92:95]
    s_waitcnt lgkmcnt(0)
    v_exp_f32 v248, v248
    v_mfma_f32_16x16x32_bf16 v[96:99], v[32:35], a[64:67], v[96:99]
    ds_read_b64_tr_b16 v[48:49], v11 offset:16384
    v_add_f32_e64 v214, v214, v243
    v_mfma_f32_16x16x32_bf16 v[96:99], v[36:39], a[72:75], v[96:99]
    ds_read_b64_tr_b16 v[50:51], v11 offset:16896
    v_add_f32_e64 v214, v214, v244
    v_mfma_f32_16x16x32_bf16 v[96:99], v[40:43], a[80:83], v[96:99]
    ds_read_b64_tr_b16 v[52:53], v11 offset:20480
    v_add_f32_e64 v214, v214, v245
    v_mfma_f32_16x16x32_bf16 v[96:99], v[44:47], a[88:91], v[96:99]
    ds_read_b64_tr_b16 v[54:55], v11 offset:20992
    v_add_f32_e64 v214, v214, v246
    v_mfma_f32_16x16x32_bf16 v[100:103], v[32:35], a[68:71], v[100:103]
    ds_read_b64_tr_b16 v[56:57], v11 offset:24576
    v_add_f32_e64 v214, v214, v247
    v_mfma_f32_16x16x32_bf16 v[100:103], v[36:39], a[76:79], v[100:103]
    ds_read_b64_tr_b16 v[58:59], v11 offset:25088
    v_add_f32_e64 v214, v214, v248
    v_mfma_f32_16x16x32_bf16 v[100:103], v[40:43], a[84:87], v[100:103]
    s_add_u32 m0, s56, 67584
    ds_read_b64_tr_b16 v[60:61], v11 offset:28672
    v_fma_f32 v254, v254, s74, v213
    v_mfma_f32_16x16x32_bf16 v[100:103], v[44:47], a[92:95], v[100:103]
    s_add_u32 s59, s87, s57
    ds_read_b64_tr_b16 v[62:63], v11 offset:29184
    v_fma_f32 v255, v255, s74, v213
    v_mfma_f32_16x16x32_bf16 v[104:107], v[32:35], a[192:195], v[104:107]
    s_add_u32 s59, s59, 59392
    buffer_load_dwordx4 v14, s[16:19], s59 offen lds
    v_mfma_f32_16x16x32_bf16 v[104:107], v[36:39], a[200:203], v[104:107]
    v_exp_f32 v249, v249
    v_mfma_f32_16x16x32_bf16 v[104:107], v[40:43], a[208:211], v[104:107]
    buffer_load_dwordx4 v15, s[16:19], s59 offen offset:1024 lds
    v_mfma_f32_16x16x32_bf16 v[104:107], v[44:47], a[216:219], v[104:107]
    s_add_u32 m0, s56, 131072
    v_exp_f32_e64 v250, v250
    v_mfma_f32_16x16x32_bf16 v[108:111], v[32:35], a[196:199], v[108:111]
    s_xor_b32 s59, s6, 262144
    buffer_load_dwordx4 v16, s[28:31], s59 offen lds
    v_mfma_f32_16x16x32_bf16 v[108:111], v[36:39], a[204:207], v[108:111]
    v_exp_f32_e64 v251, v251
    v_mfma_f32_16x16x32_bf16 v[108:111], v[40:43], a[212:215], v[108:111]
    buffer_load_dwordx4 v19, s[28:31], s59 offen offset:1024 lds
    v_mfma_f32_16x16x32_bf16 v[108:111], v[44:47], a[220:223], v[108:111]
    s_waitcnt vmcnt(24) lgkmcnt(0)
    s_barrier
    v_mfma_f32_16x16x32_bf16 v[112:115], v[48:51], a[64:67], v[112:115]
    ds_read_b64_tr_b16 v[32:33], v8 offset:0
    v_add_f32_e64 v214, v214, v249
    v_mfma_f32_16x16x32_bf16 v[112:115], v[52:55], a[72:75], v[112:115]
    ds_read_b64_tr_b16 v[34:35], v8 offset:512
    v_add_f32_e64 v214, v214, v250
    v_mfma_f32_16x16x32_bf16 v[112:115], v[56:59], a[80:83], v[112:115]
    ds_read_b64_tr_b16 v[36:37], v8 offset:4096
    v_add_f32_e64 v214, v214, v251
    v_mfma_f32_16x16x32_bf16 v[112:115], v[60:63], a[88:91], v[112:115]
    ds_read_b64_tr_b16 v[38:39], v8 offset:4608
    v_cvt_pk_bf16_f32 v140, v140, v141
    v_mfma_f32_16x16x32_bf16 v[116:119], v[48:51], a[68:71], v[116:119]
    ds_read_b64_tr_b16 v[40:41], v8 offset:8192
    v_cvt_pk_bf16_f32 v141, v142, v143
    v_mfma_f32_16x16x32_bf16 v[116:119], v[52:55], a[76:79], v[116:119]
    ds_read_b64_tr_b16 v[42:43], v8 offset:8704
    v_cvt_pk_bf16_f32 v142, v156, v157
    v_mfma_f32_16x16x32_bf16 v[116:119], v[56:59], a[84:87], v[116:119]
    ds_read_b64_tr_b16 v[44:45], v8 offset:12288
    v_cvt_pk_bf16_f32 v143, v158, v159
    v_mfma_f32_16x16x32_bf16 v[116:119], v[60:63], a[92:95], v[116:119]
    ds_read_b64_tr_b16 v[46:47], v8 offset:12800
    v_max3_f32 v208, v224, v225, v226
    v_mfma_f32_16x16x32_bf16 v[120:123], v[48:51], a[192:195], v[120:123]
    s_add_u32 m0, s56, 81920
    v_exp_f32_e64 v252, v252
    v_mfma_f32_16x16x32_bf16 v[120:123], v[52:55], a[200:203], v[120:123]
    s_add_u32 s59, s87, s57
    v_exp_f32 v253, v253
    v_mfma_f32_16x16x32_bf16 v[120:123], v[56:59], a[208:211], v[120:123]
    s_add_u32 s59, s59, 2048
    buffer_load_dwordx4 v14, s[20:23], s59 offen lds
    v_mfma_f32_16x16x32_bf16 v[120:123], v[60:63], a[216:219], v[120:123]
    v_exp_f32_e64 v254, v254
    v_mfma_f32_16x16x32_bf16 v[124:127], v[48:51], a[196:199], v[124:127]
    buffer_load_dwordx4 v15, s[20:23], s59 offen offset:1024 lds
    v_mfma_f32_16x16x32_bf16 v[124:127], v[52:55], a[204:207], v[124:127]
    v_exp_f32_e64 v255, v255
    v_mfma_f32_16x16x32_bf16 v[124:127], v[56:59], a[212:215], v[124:127]
    v_add_f32 v214, v214, v252
    v_add_f32 v214, v214, v253
    v_mfma_f32_16x16x32_bf16 v[124:127], v[60:63], a[220:223], v[124:127]
    s_waitcnt lgkmcnt(0)
    v_add_f32 v214, v214, v254
    v_add_f32_e64 v214, v214, v255
    buffer_load_dword v17, v3, s[40:43], 0 offen sc1
    v_mfma_f32_16x16x32_bf16 v[64:67], v[32:35], a[96:99], v[64:67]
    ds_read_b64_tr_b16 v[48:49], v10 offset:0
    v_max3_f32 v209, v227, v228, v229
    v_mfma_f32_16x16x32_bf16 v[64:67], v[36:39], a[104:107], v[64:67]
    ds_read_b64_tr_b16 v[50:51], v10 offset:512
    v_max3_f32 v210, v230, v231, v232
    v_mfma_f32_16x16x32_bf16 v[64:67], v[40:43], a[112:115], v[64:67]
    ds_read_b64_tr_b16 v[52:53], v10 offset:4096
    v_max3_f32 v211, v233, v234, v235
    v_mfma_f32_16x16x32_bf16 v[64:67], v[44:47], a[120:123], v[64:67]
    ds_read_b64_tr_b16 v[54:55], v10 offset:4608
    v_max3_f32 v212, v236, v237, v238
    v_mfma_f32_16x16x32_bf16 v[68:71], v[32:35], a[100:103], v[68:71]
    ds_read_b64_tr_b16 v[56:57], v10 offset:8192
    v_max3_f32 v208, v208, v209, v210
    v_mfma_f32_16x16x32_bf16 v[68:71], v[36:39], a[108:111], v[68:71]
    ds_read_b64_tr_b16 v[58:59], v10 offset:8704
    v_max3_f32 v211, v211, v212, v239
    v_mfma_f32_16x16x32_bf16 v[68:71], v[40:43], a[116:119], v[68:71]
    s_add_u32 m0, s56, 83968
    ds_read_b64_tr_b16 v[60:61], v10 offset:12288
    v_max_f32_e64 v208, v208, v211
    v_mfma_f32_16x16x32_bf16 v[68:71], v[44:47], a[124:127], v[68:71]
    s_add_u32 s59, s87, s57
    ds_read_b64_tr_b16 v[62:63], v10 offset:12800
    v_mul_f32 v208, s76, v208
    v_mfma_f32_16x16x32_bf16 v[72:75], v[32:35], a[224:227], v[72:75]
    s_add_u32 s59, s59, 59392
    buffer_load_dwordx4 v14, s[20:23], s59 offen lds
    v_mfma_f32_16x16x32_bf16 v[72:75], v[36:39], a[232:235], v[72:75]
    v_rcp_f32_e64 v214, v214
    v_mfma_f32_16x16x32_bf16 v[72:75], v[40:43], a[240:243], v[72:75]
    buffer_load_dwordx4 v15, s[20:23], s59 offen offset:1024 lds
    v_mfma_f32_16x16x32_bf16 v[72:75], v[44:47], a[248:251], v[72:75]
    s_add_u32 m0, s56, 133120
    v_mul_f32 v240, v240, v214
    v_mul_f32 v241, v241, v214
    v_mfma_f32_16x16x32_bf16 v[76:79], v[32:35], a[228:231], v[76:79]
    s_xor_b32 s59, s6, 278528
    buffer_load_dwordx4 v16, s[28:31], s59 offen lds
    v_mfma_f32_16x16x32_bf16 v[76:79], v[36:39], a[236:239], v[76:79]
    v_cvt_pk_bf16_f32 v132, v240, v241
    v_mul_f32_e64 v242, v242, v214
    v_mfma_f32_16x16x32_bf16 v[76:79], v[40:43], a[244:247], v[76:79]
    buffer_load_dwordx4 v19, s[28:31], s59 offen offset:1024 lds
    v_mfma_f32_16x16x32_bf16 v[76:79], v[44:47], a[252:255], v[76:79]
    s_waitcnt vmcnt(27) lgkmcnt(0)
    s_barrier
    v_mfma_f32_16x16x32_bf16 v[80:83], v[48:51], a[96:99], v[80:83]
    ds_read_b64_tr_b16 v[32:33], v8 offset:16384
    v_mul_f32_e64 v243, v243, v214
    v_mfma_f32_16x16x32_bf16 v[80:83], v[52:55], a[104:107], v[80:83]
    ds_read_b64_tr_b16 v[34:35], v8 offset:16896
    v_cvt_pk_bf16_f32 v133, v242, v243
    v_mfma_f32_16x16x32_bf16 v[240:243], v[192:195], v[140:143], 0
    v_mul_f32 v244, v244, v214
    v_mul_f32 v245, v245, v214
    v_mfma_f32_16x16x32_bf16 v[80:83], v[56:59], a[112:115], v[80:83]
    ds_read_b64_tr_b16 v[36:37], v8 offset:20480
    v_cvt_pk_bf16_f32 v134, v244, v245
    v_mfma_f32_16x16x32_bf16 v[80:83], v[60:63], a[120:123], v[80:83]
    ds_read_b64_tr_b16 v[38:39], v8 offset:20992
    v_mul_f32_e64 v246, v246, v214
    v_mfma_f32_16x16x32_bf16 v[84:87], v[48:51], a[100:103], v[84:87]
    ds_read_b64_tr_b16 v[40:41], v8 offset:24576
    v_mul_f32_e64 v247, v247, v214
    v_mfma_f32_16x16x32_bf16 v[84:87], v[52:55], a[108:111], v[84:87]
    ds_read_b64_tr_b16 v[42:43], v8 offset:25088
    v_cvt_pk_bf16_f32 v135, v246, v247
    v_mfma_f32_16x16x32_bf16 v[244:247], v[196:199], v[140:143], 0
    v_mul_f32 v248, v248, v214
    v_mul_f32 v249, v249, v214
    v_mfma_f32_16x16x32_bf16 v[84:87], v[56:59], a[116:119], v[84:87]
    ds_read_b64_tr_b16 v[44:45], v8 offset:28672
    v_cvt_pk_bf16_f32 v148, v248, v249
    v_mfma_f32_16x16x32_bf16 v[84:87], v[60:63], a[124:127], v[84:87]
    ds_read_b64_tr_b16 v[46:47], v8 offset:29184
    v_mul_f32_e64 v250, v250, v214
    v_mfma_f32_16x16x32_bf16 v[88:91], v[48:51], a[224:227], v[88:91]
    s_add_u32 m0, s56, 0
    v_mul_f32 v251, v251, v214
    v_cvt_pk_bf16_f32 v149, v250, v251
    v_mfma_f32_16x16x32_bf16 v[248:251], v[200:203], v[140:143], 0
    v_mul_f32 v252, v252, v214
    v_mul_f32 v253, v253, v214
    v_mfma_f32_16x16x32_bf16 v[88:91], v[52:55], a[232:235], v[88:91]
    s_add_u32 s59, s88, s57
    v_cvt_pk_bf16_f32 v150, v252, v253
    v_mul_f32 v254, v254, v214
    v_mfma_f32_16x16x32_bf16 v[88:91], v[56:59], a[240:243], v[88:91]
    s_add_u32 s59, s59, 2048
    buffer_load_dwordx4 v14, s[16:19], s59 offen lds
    v_mfma_f32_16x16x32_bf16 v[88:91], v[60:63], a[248:251], v[88:91]
    v_mul_f32_e64 v255, v255, v214
    v_cvt_pk_bf16_f32 v151, v254, v255
    v_mfma_f32_16x16x32_bf16 v[252:255], v[204:207], v[140:143], 0
    v_fma_f32 v224, v224, s74, v208
    v_fma_f32 v225, v225, s74, v208
    v_mfma_f32_16x16x32_bf16 v[92:95], v[48:51], a[228:231], v[92:95]
    buffer_load_dwordx4 v15, s[16:19], s59 offen offset:1024 lds
    v_mfma_f32_16x16x32_bf16 v[92:95], v[52:55], a[236:239], v[92:95]
    v_exp_f32_e64 v224, v224
    v_mfma_f32_16x16x32_bf16 v[92:95], v[56:59], a[244:247], v[92:95]
    v_exp_f32_e64 v225, v225
    v_mfma_f32_16x16x32_bf16 v[92:95], v[60:63], a[252:255], v[92:95]
    s_waitcnt lgkmcnt(0)
    v_add_f32 v209, v224, v225
    v_fma_f32 v226, v226, s74, v208
    v_mfma_f32_16x16x32_bf16 v[96:99], v[32:35], a[96:99], v[96:99]
    s_lshr_b32 s91, s62, 8
    ds_read_b64_tr_b16 v[48:49], v10 offset:16384
    v_lshrrev_b32 v28, 2, v1
    v_mfma_f32_16x16x32_bf16 v[96:99], v[36:39], a[104:107], v[96:99]
    s_and_b32 s91, s91, 3
    ds_read_b64_tr_b16 v[50:51], v10 offset:16896
    v_lshlrev_b32 v28, 7, v28
    v_mfma_f32_16x16x32_bf16 v[96:99], v[40:43], a[112:115], v[96:99]
    s_xor_b32 s91, s91, s3
    ds_read_b64_tr_b16 v[52:53], v10 offset:20480
    v_and_b32 v29, 3, v1
    v_mfma_f32_16x16x32_bf16 v[96:99], v[44:47], a[120:123], v[96:99]
    s_lshl_b32 s68, s91, 10
    ds_read_b64_tr_b16 v[54:55], v10 offset:20992
    v_lshl_add_u32 v28, v29, 3, v28
    v_mfma_f32_16x16x32_bf16 v[100:103], v[32:35], a[100:103], v[100:103]
    s_lshr_b32 s67, s0, 17
    ds_read_b64_tr_b16 v[56:57], v10 offset:24576
    v_bfe_u32 v29, v1, 3, 2
    v_mfma_f32_16x16x32_bf16 v[100:103], v[36:39], a[108:111], v[100:103]
    s_lshl_b32 s67, s67, 14
    ds_read_b64_tr_b16 v[58:59], v10 offset:25088
    v_lshl_add_u32 v28, v29, 5, v28
    v_mfma_f32_16x16x32_bf16 v[100:103], v[40:43], a[116:119], v[100:103]
    s_add_u32 m0, s56, 2048
    ds_read_b64_tr_b16 v[60:61], v10 offset:28672
    v_add_u32 v20, s56, v28
    v_mfma_f32_16x16x32_bf16 v[100:103], v[44:47], a[124:127], v[100:103]
    s_add_u32 s59, s88, s57
    ds_read_b64_tr_b16 v[62:63], v10 offset:29184
    v_add_u32 v28, 98304, v28
    v_mfma_f32_16x16x32_bf16 v[104:107], v[32:35], a[224:227], v[104:107]
    s_add_u32 s59, s59, 59392
    buffer_load_dwordx4 v14, s[16:19], s59 offen lds
    v_mfma_f32_16x16x32_bf16 v[104:107], v[36:39], a[232:235], v[104:107]
    s_lshr_b32 s65, s6, 17
    v_exp_f32_e64 v226, v226
    v_mfma_f32_16x16x32_bf16 v[104:107], v[40:43], a[240:243], v[104:107]
    s_lshl_b32 s65, s65, 14
    buffer_load_dwordx4 v15, s[16:19], s59 offen offset:1024 lds
    v_mfma_f32_16x16x32_bf16 v[104:107], v[44:47], a[248:251], v[104:107]
    s_add_u32 m0, s56, 147456
    v_xor_b32 v21, 32, v20
    v_xor_b32_e64 v29, 32, v28
    v_mfma_f32_16x16x32_bf16 v[108:111], v[32:35], a[228:231], v[108:111]
    s_xor_b32 s59, s6, 393216
    buffer_load_dwordx4 v16, s[28:31], s59 offen lds
    v_mfma_f32_16x16x32_bf16 v[108:111], v[36:39], a[236:239], v[108:111]
    s_lshr_b32 s66, s7, 17
    v_xor_b32 v22, 64, v20
    v_xor_b32_e64 v30, 64, v28
    v_mfma_f32_16x16x32_bf16 v[108:111], v[40:43], a[244:247], v[108:111]
    s_lshl_b32 s66, s66, 14
    buffer_load_dwordx4 v19, s[28:31], s59 offen offset:1024 lds
    v_mfma_f32_16x16x32_bf16 v[108:111], v[44:47], a[252:255], v[108:111]
    s_waitcnt vmcnt(27) lgkmcnt(0)
    s_barrier
    v_mfma_f32_16x16x32_bf16 v[112:115], v[48:51], a[96:99], v[112:115]
    s_lshl_b32 s90, s63, 8
    ds_read_b64_tr_b16 v[32:33], v8 offset:32768
    v_xor_b32 v23, 96, v20
    v_mfma_f32_16x16x32_bf16 v[112:115], v[52:55], a[104:107], v[112:115]
    s_add_u32 s90, s90, s62
    ds_read_b64_tr_b16 v[34:35], v8 offset:33280
    v_xor_b32 v31, 96, v28
    v_mfma_f32_16x16x32_bf16 v[112:115], v[56:59], a[112:115], v[112:115]
    s_add_u32 s91, s63, s91
    ds_read_b64_tr_b16 v[36:37], v8 offset:36864
    v_add_u32 v24, 0x10000, v20
    v_mfma_f32_16x16x32_bf16 v[112:115], v[60:63], a[120:123], v[112:115]
    s_lshl_b32 s91, s91, 14
    ds_read_b64_tr_b16 v[38:39], v8 offset:37376
    v_add_u32 v25, 0x10000, v21
    v_mfma_f32_16x16x32_bf16 v[116:119], v[48:51], a[100:103], v[116:119]
    s_add_u32 s91, s91, s62
    ds_read_b64_tr_b16 v[40:41], v8 offset:40960
    v_add_u32 v26, 0x10000, v22
    v_mfma_f32_16x16x32_bf16 v[116:119], v[52:55], a[108:111], v[116:119]
    ds_read_b64_tr_b16 v[42:43], v8 offset:41472
    v_add_u32 v27, 0x10000, v23
    v_mfma_f32_16x16x32_bf16 v[116:119], v[56:59], a[116:119], v[116:119]
    ds_read_b64_tr_b16 v[44:45], v8 offset:45056
    v_add_u32_e64 v4, s68, v2
    v_mfma_f32_16x16x32_bf16 v[116:119], v[60:63], a[124:127], v[116:119]
    s_lshr_b32 s68, s63, 2
    ds_read_b64_tr_b16 v[46:47], v8 offset:45568
    v_xor_b32 v6, 1024, v4
    v_mfma_f32_16x16x32_bf16 v[120:123], v[48:51], a[224:227], v[120:123]
    s_add_u32 m0, s56, 16384
    v_xor_b32 v7, 2048, v4
    v_xor_b32 v12, 3072, v4
    v_mfma_f32_16x16x32_bf16 v[120:123], v[52:55], a[232:235], v[120:123]
    s_add_u32 s59, s88, s57
    v_mov_b32 v223, 1
    v_add_f32 v209, v209, v226
    v_mfma_f32_16x16x32_bf16 v[120:123], v[56:59], a[240:243], v[120:123]
    s_add_u32 s59, s59, 2048
    buffer_load_dwordx4 v14, s[20:23], s59 offen lds
    v_mfma_f32_16x16x32_bf16 v[120:123], v[60:63], a[248:251], v[120:123]
    s_mul_i32 s68, s68, 294912
    v_fma_f32 v227, v227, s74, v208
    v_fma_f32 v228, v228, s74, v208
    v_mfma_f32_16x16x32_bf16 v[124:127], v[48:51], a[228:231], v[124:127]
    s_add_u32 s64, s68, s56
    buffer_load_dwordx4 v15, s[20:23], s59 offen offset:1024 lds
    v_mfma_f32_16x16x32_bf16 v[124:127], v[52:55], a[236:239], v[124:127]
    s_add_u32 s68, s68, 229376
    v_exp_f32 v227, v227
    v_mfma_f32_16x16x32_bf16 v[124:127], v[56:59], a[244:247], v[124:127]
    v_exp_f32_e64 v228, v228
    v_mfma_f32_16x16x32_bf16 v[124:127], v[60:63], a[252:255], v[124:127]
    s_waitcnt lgkmcnt(0)
    v_add_f32 v209, v209, v227
    v_add_f32 v209, v209, v228
    v_mfma_f32_16x16x32_bf16 v[160:163], v[32:35], a[0:3], 0
    ds_read_b64_tr_b16 v[48:49], v10 offset:32768
    v_fma_f32 v229, v229, s74, v208
    v_fma_f32 v230, v230, s74, v208
    v_mfma_f32_16x16x32_bf16 v[160:163], v[36:39], a[8:11], v[160:163]
    ds_read_b64_tr_b16 v[50:51], v10 offset:33280
    v_exp_f32 v229, v229
    v_mfma_f32_16x16x32_bf16 v[160:163], v[40:43], a[16:19], v[160:163]
    ds_read_b64_tr_b16 v[52:53], v10 offset:36864
    v_exp_f32_e64 v230, v230
    v_mfma_f32_16x16x32_bf16 v[160:163], v[44:47], a[24:27], v[160:163]
    s_lshl_b32 s75, s57, 6
    ds_read_b64_tr_b16 v[54:55], v10 offset:37376
    v_mul_f32 v96, v64, v96
    v_mul_f32_e64 v97, v65, v97
    v_mfma_f32_16x16x32_bf16 v[164:167], v[32:35], a[4:7], 0
    s_add_u32 s75, s75, 0
    ds_read_b64_tr_b16 v[56:57], v10 offset:40960
    v_mul_f32 v98, v66, v98
    v_mul_f32_e64 v99, v67, v99
    v_mfma_f32_16x16x32_bf16 v[164:167], v[36:39], a[12:15], v[164:167]
    ds_read_b64_tr_b16 v[58:59], v10 offset:41472
    v_mul_f32 v112, v80, v112
    v_mul_f32 v113, v81, v113
    v_mfma_f32_16x16x32_bf16 v[164:167], v[40:43], a[20:23], v[164:167]
    s_add_u32 m0, s56, 18432
    ds_read_b64_tr_b16 v[60:61], v10 offset:45056
    v_mul_f32 v114, v82, v114
    v_mul_f32 v115, v83, v115
    v_mfma_f32_16x16x32_bf16 v[164:167], v[44:47], a[28:31], v[164:167]
    s_add_u32 s59, s88, s57
    ds_read_b64_tr_b16 v[62:63], v10 offset:45568
    v_mul_f32 v100, v68, v100
    v_mul_f32_e64 v101, v69, v101
    v_mfma_f32_16x16x32_bf16 v[168:171], v[32:35], a[128:131], 0
    s_add_u32 s59, s59, 59392
    buffer_load_dwordx4 v14, s[20:23], s59 offen lds
    v_mul_f32_e64 v102, v70, v102
    v_mfma_f32_16x16x32_bf16 v[168:171], v[36:39], a[136:139], v[168:171]
    v_mul_f32 v103, v71, v103
    v_mul_f32 v116, v84, v116
    v_mul_f32_e64 v117, v85, v117
    v_mfma_f32_16x16x32_bf16 v[168:171], v[40:43], a[144:147], v[168:171]
    buffer_load_dwordx4 v15, s[20:23], s59 offen offset:1024 lds
    v_mul_f32_e64 v118, v86, v118
    v_mfma_f32_16x16x32_bf16 v[168:171], v[44:47], a[152:155], v[168:171]
    s_add_u32 m0, s56, 149504
    v_mul_f32 v119, v87, v119
    v_mul_f32 v104, v72, v104
    v_mul_f32_e64 v105, v73, v105
    v_mfma_f32_16x16x32_bf16 v[172:175], v[32:35], a[132:135], 0
    s_xor_b32 s59, s6, 409600
    buffer_load_dwordx4 v16, s[28:31], s59 offen lds
    v_mul_f32_e64 v106, v74, v106
    v_mfma_f32_16x16x32_bf16 v[172:175], v[36:39], a[140:143], v[172:175]
    v_mul_f32 v107, v75, v107
    v_mul_f32 v120, v88, v120
    v_mul_f32_e64 v121, v89, v121
    v_mfma_f32_16x16x32_bf16 v[172:175], v[40:43], a[148:151], v[172:175]
    buffer_load_dwordx4 v19, s[28:31], s59 offen offset:1024 lds
    v_mul_f32_e64 v122, v90, v122
    v_mfma_f32_16x16x32_bf16 v[172:175], v[44:47], a[156:159], v[172:175]
    s_waitcnt vmcnt(27) lgkmcnt(0)
    s_barrier
    s_waitcnt vmcnt(16)
    v_cmp_gt_u32 vcc, 1, v17
    s_nop 0
    s_and_b32 vcc_lo, vcc_lo, 0xff
    s_cbranch_scc1 L_q_retry0
L_q_back0:
    v_mfma_f32_16x16x32_bf16 v[176:179], v[48:51], a[0:3], 0
    ds_read_b64_tr_b16 v[32:33], v8 offset:49152
    v_mul_f32 v123, v91, v123
    v_mul_f32 v108, v76, v108
    v_mfma_f32_16x16x32_bf16 v[176:179], v[52:55], a[8:11], v[176:179]
    s_add_u32 m0, s56, 32768
    ds_read_b64_tr_b16 v[34:35], v8 offset:49664
    v_mul_f32 v109, v77, v109
    v_mul_f32 v110, v78, v110
    v_mfma_f32_16x16x32_bf16 v[176:179], v[56:59], a[16:19], v[176:179]
    s_add_u32 s59, s89, s57
    ds_read_b64_tr_b16 v[36:37], v8 offset:53248
    v_mul_f32 v111, v79, v111
    v_mul_f32_e64 v124, v92, v124
    v_mfma_f32_16x16x32_bf16 v[176:179], v[60:63], a[24:27], v[176:179]
    s_add_u32 s59, s59, 2048
    buffer_load_dwordx4 v14, s[16:19], s59 offen lds
    ds_read_b64_tr_b16 v[38:39], v8 offset:53760
    v_mfma_f32_16x16x32_bf16 v[180:183], v[48:51], a[4:7], 0
    ds_read_b64_tr_b16 v[40:41], v8 offset:57344
    v_mul_f32 v125, v93, v125
    v_mul_f32 v126, v94, v126
    v_mfma_f32_16x16x32_bf16 v[180:183], v[52:55], a[12:15], v[180:183]
    ds_read_b64_tr_b16 v[42:43], v8 offset:57856
    v_mul_f32_e64 v127, v95, v127
    v_cvt_pk_bf16_f32 v96, v96, v97
    v_mfma_f32_16x16x32_bf16 v[180:183], v[56:59], a[20:23], v[180:183]
    buffer_load_dwordx4 v15, s[16:19], s59 offen offset:1024 lds
    ds_read_b64_tr_b16 v[44:45], v8 offset:61440
    v_mfma_f32_16x16x32_bf16 v[180:183], v[60:63], a[28:31], v[180:183]
    ds_read_b64_tr_b16 v[46:47], v8 offset:61952
    v_cvt_pk_bf16_f32 v97, v98, v99
    v_cvt_pk_bf16_f32 v98, v112, v113
    v_mfma_f32_16x16x32_bf16 v[184:187], v[48:51], a[128:131], 0
    v_cvt_pk_bf16_f32 v99, v114, v115
    v_cvt_pk_bf16_f32 v100, v100, v101
    v_cvt_pk_bf16_f32 v101, v102, v103
    v_mfma_f32_16x16x32_bf16 v[184:187], v[52:55], a[136:139], v[184:187]
    s_add_u32 s60, s75, s70
    buffer_store_dwordx4 v[96:99], v18, s[44:47], s60 offen sc1
    v_cvt_pk_bf16_f32 v102, v116, v117
    v_mfma_f32_16x16x32_bf16 v[184:187], v[56:59], a[144:147], v[184:187]
    v_cvt_pk_bf16_f32 v103, v118, v119
    v_cvt_pk_bf16_f32 v104, v104, v105
    v_cvt_pk_bf16_f32 v105, v106, v107
    v_mfma_f32_16x16x32_bf16 v[184:187], v[60:63], a[152:155], v[184:187]
    v_cvt_pk_bf16_f32 v106, v120, v121
    v_cvt_pk_bf16_f32 v107, v122, v123
    v_cvt_pk_bf16_f32 v108, v108, v109
    v_mfma_f32_16x16x32_bf16 v[188:191], v[48:51], a[132:135], 0
    s_add_u32 s60, s75, s71
    buffer_store_dwordx4 v[100:103], v18, s[44:47], s60 offen sc1
    v_cvt_pk_bf16_f32 v109, v110, v111
    v_mfma_f32_16x16x32_bf16 v[188:191], v[52:55], a[140:143], v[188:191]
    v_cvt_pk_bf16_f32 v110, v124, v125
    v_cvt_pk_bf16_f32 v111, v126, v127
    v_add_f32_e64 v209, v209, v229
    v_mfma_f32_16x16x32_bf16 v[188:191], v[56:59], a[148:151], v[188:191]
    v_add_f32_e64 v209, v209, v230
    v_fma_f32 v231, v231, s74, v208
    v_fma_f32 v232, v232, s74, v208
    v_mfma_f32_16x16x32_bf16 v[188:191], v[60:63], a[156:159], v[188:191]
    s_waitcnt lgkmcnt(0)
    v_exp_f32 v231, v231
    v_fma_f32 v233, v233, s74, v208
    v_mfma_f32_16x16x32_bf16 v[64:67], v[32:35], a[0:3], 0
    ds_read_b64_tr_b16 v[48:49], v10 offset:49152
    v_exp_f32_e64 v232, v232
    v_mfma_f32_16x16x32_bf16 v[64:67], v[36:39], a[8:11], v[64:67]
    s_add_u32 m0, s56, 34816
    ds_read_b64_tr_b16 v[50:51], v10 offset:49664
    v_exp_f32_e64 v233, v233
    v_mfma_f32_16x16x32_bf16 v[64:67], v[40:43], a[16:19], v[64:67]
    s_add_u32 s59, s89, s57
    ds_read_b64_tr_b16 v[52:53], v10 offset:53248
    v_add_f32 v209, v209, v231
    v_add_f32_e64 v209, v209, v232
    v_mfma_f32_16x16x32_bf16 v[64:67], v[44:47], a[24:27], v[64:67]
    s_add_u32 s59, s59, 59392
    buffer_load_dwordx4 v14, s[16:19], s59 offen lds
    ds_read_b64_tr_b16 v[54:55], v10 offset:53760
    v_mfma_f32_16x16x32_bf16 v[68:71], v[32:35], a[4:7], 0
    ds_read_b64_tr_b16 v[56:57], v10 offset:57344
    v_add_f32_e64 v209, v209, v233
    v_fma_f32 v234, v234, s74, v208
    v_mfma_f32_16x16x32_bf16 v[68:71], v[36:39], a[12:15], v[68:71]
    ds_read_b64_tr_b16 v[58:59], v10 offset:57856
    v_exp_f32_e64 v234, v234
    v_mfma_f32_16x16x32_bf16 v[68:71], v[40:43], a[20:23], v[68:71]
    buffer_load_dwordx4 v15, s[16:19], s59 offen offset:1024 lds
    ds_read_b64_tr_b16 v[60:61], v10 offset:61440
    v_mfma_f32_16x16x32_bf16 v[68:71], v[44:47], a[28:31], v[68:71]
    ds_read_b64_tr_b16 v[62:63], v10 offset:61952
    v_add_f32_e64 v209, v209, v234
    v_fma_f32 v235, v235, s74, v208
    v_mfma_f32_16x16x32_bf16 v[72:75], v[32:35], a[128:131], 0
    s_add_u32 s60, s75, s72
    buffer_store_dwordx4 v[104:107], v18, s[44:47], s60 offen sc1
    v_fma_f32 v236, v236, s74, v208
    v_mfma_f32_16x16x32_bf16 v[72:75], v[36:39], a[136:139], v[72:75]
    v_exp_f32 v235, v235
    v_fma_f32 v237, v237, s74, v208
    v_mfma_f32_16x16x32_bf16 v[72:75], v[40:43], a[144:147], v[72:75]
    v_exp_f32 v236, v236
    v_add_f32 v209, v209, v235
    v_mfma_f32_16x16x32_bf16 v[72:75], v[44:47], a[152:155], v[72:75]
    s_add_u32 s60, s75, s73
    buffer_store_dwordx4 v[108:111], v18, s[44:47], s60 offen sc1
    v_add_f32 v209, v209, v236
    v_mfma_f32_16x16x32_bf16 v[76:79], v[32:35], a[132:135], 0
    v_exp_f32_e64 v237, v237
    v_fma_f32 v238, v238, s74, v208
    v_mfma_f32_16x16x32_bf16 v[76:79], v[36:39], a[140:143], v[76:79]
    v_exp_f32 v238, v238
    v_add_f32 v209, v209, v237
    v_mfma_f32_16x16x32_bf16 v[76:79], v[40:43], a[148:151], v[76:79]
    v_add_f32_e64 v209, v209, v238
    v_fma_f32 v239, v239, s74, v208
    v_max3_f32 v213, v240, v241, v242
    v_mfma_f32_16x16x32_bf16 v[76:79], v[44:47], a[156:159], v[76:79]
    s_waitcnt lgkmcnt(0)
    s_barrier
    v_mfma_f32_16x16x32_bf16 v[80:83], v[48:51], a[0:3], 0
    ds_read_b64_tr_b16 v[32:33], v9 offset:0
    v_exp_f32_e64 v239, v239
    v_mfma_f32_16x16x32_bf16 v[80:83], v[52:55], a[8:11], v[80:83]
    ds_read_b64_tr_b16 v[34:35], v9 offset:512
    v_add_f32_e64 v209, v209, v239
    v_max3_f32 v214, v243, v244, v245
    v_mfma_f32_16x16x32_bf16 v[80:83], v[56:59], a[16:19], v[80:83]
    ds_read_b64_tr_b16 v[36:37], v9 offset:4096
    v_rcp_f32_e64 v209, v209
    v_mfma_f32_16x16x32_bf16 v[80:83], v[60:63], a[24:27], v[80:83]
    ds_read_b64_tr_b16 v[38:39], v9 offset:4608
    v_mul_f32 v224, v224, v209
    v_mul_f32 v225, v225, v209
    v_mfma_f32_16x16x32_bf16 v[84:87], v[48:51], a[4:7], 0
    ds_read_b64_tr_b16 v[40:41], v9 offset:8192
    v_cvt_pk_bf16_f32 v136, v224, v225
    v_mul_f32_e64 v226, v226, v209
    v_mfma_f32_16x16x32_bf16 v[84:87], v[52:55], a[12:15], v[84:87]
    ds_read_b64_tr_b16 v[42:43], v9 offset:8704
    v_mul_f32_e64 v227, v227, v209
    v_cvt_pk_bf16_f32 v137, v226, v227
    v_mfma_f32_16x16x32_bf16 v[84:87], v[56:59], a[20:23], v[84:87]
    ds_read_b64_tr_b16 v[44:45], v9 offset:12288
    v_mul_f32 v228, v228, v209
    v_mul_f32 v229, v229, v209
    v_mfma_f32_16x16x32_bf16 v[84:87], v[60:63], a[28:31], v[84:87]
    ds_read_b64_tr_b16 v[46:47], v9 offset:12800
    v_cvt_pk_bf16_f32 v138, v228, v229
    v_mul_f32_e64 v230, v230, v209
    v_mfma_f32_16x16x32_bf16 v[88:91], v[48:51], a[128:131], 0
    s_add_u32 m0, s56, 49152
    v_mul_f32_e64 v231, v231, v209
    v_cvt_pk_bf16_f32 v139, v230, v231
    v_mul_f32_e64 v232, v232, v209
    v_mfma_f32_16x16x32_bf16 v[88:91], v[52:55], a[136:139], v[88:91]
    s_add_u32 s59, s89, s57
    v_mul_f32 v233, v233, v209
    v_cvt_pk_bf16_f32 v152, v232, v233
    v_mul_f32_e64 v234, v234, v209
    v_mfma_f32_16x16x32_bf16 v[88:91], v[56:59], a[144:147], v[88:91]
    s_add_u32 s59, s59, 2048
    buffer_load_dwordx4 v14, s[20:23], s59 offen lds
    v_mul_f32_e64 v235, v235, v209
    v_mfma_f32_16x16x32_bf16 v[88:91], v[60:63], a[152:155], v[88:91]
    v_cvt_pk_bf16_f32 v153, v234, v235
    v_mul_f32 v236, v236, v209
    v_mul_f32 v237, v237, v209
    v_mfma_f32_16x16x32_bf16 v[92:95], v[48:51], a[132:135], 0
    buffer_load_dwordx4 v15, s[20:23], s59 offen offset:1024 lds
    v_cvt_pk_bf16_f32 v154, v236, v237
    v_mfma_f32_16x16x32_bf16 v[92:95], v[52:55], a[140:143], v[92:95]
    v_mul_f32 v238, v238, v209
    v_mul_f32 v239, v239, v209
    v_cvt_pk_bf16_f32 v155, v238, v239
    v_mfma_f32_16x16x32_bf16 v[92:95], v[56:59], a[148:151], v[92:95]
    v_max3_f32 v215, v246, v247, v248
    v_max3_f32 v216, v249, v250, v251
    v_max3_f32 v217, v252, v253, v254
    v_mfma_f32_16x16x32_bf16 v[92:95], v[60:63], a[156:159], v[92:95]
    s_waitcnt lgkmcnt(0)
    v_max3_f32 v213, v213, v214, v215
    v_max3_f32 v216, v216, v217, v255
    v_max_f32 v213, v213, v216
    v_mfma_f32_16x16x32_bf16 v[160:163], v[32:35], a[32:35], v[160:163]
    ds_read_b64_tr_b16 v[48:49], v11 offset:0
    ds_read_b64_tr_b16 a[0:1], v24 offset:32768
    v_mfma_f32_16x16x32_bf16 v[160:163], v[36:39], a[40:43], v[160:163]
    ds_read_b64_tr_b16 v[50:51], v11 offset:512
    ds_read_b64_tr_b16 a[2:3], v24 offset:34816
    v_mfma_f32_16x16x32_bf16 v[160:163], v[40:43], a[48:51], v[160:163]
    ds_read_b64_tr_b16 v[52:53], v11 offset:4096
    ds_read_b64_tr_b16 a[4:5], v25 offset:32768
    v_mfma_f32_16x16x32_bf16 v[160:163], v[44:47], a[56:59], v[160:163]
    ds_read_b64_tr_b16 v[54:55], v11 offset:4608
    ds_read_b64_tr_b16 a[6:7], v25 offset:34816
    v_mfma_f32_16x16x32_bf16 v[164:167], v[32:35], a[36:39], v[164:167]
    ds_read_b64_tr_b16 v[56:57], v11 offset:8192
    ds_read_b64_tr_b16 a[8:9], v26 offset:32768
    v_mfma_f32_16x16x32_bf16 v[164:167], v[36:39], a[44:47], v[164:167]
    ds_read_b64_tr_b16 v[58:59], v11 offset:8704
    ds_read_b64_tr_b16 a[10:11], v26 offset:34816
    v_mfma_f32_16x16x32_bf16 v[164:167], v[40:43], a[52:55], v[164:167]
    ds_read_b64_tr_b16 v[60:61], v11 offset:12288
    ds_read_b64_tr_b16 a[12:13], v27 offset:32768
    v_mfma_f32_16x16x32_bf16 v[164:167], v[44:47], a[60:63], v[164:167]
    ds_read_b64_tr_b16 v[62:63], v11 offset:12800
    ds_read_b64_tr_b16 a[14:15], v27 offset:34816
    v_mfma_f32_16x16x32_bf16 v[168:171], v[32:35], a[160:163], v[168:171]
    s_add_u32 m0, s56, 51200
    ds_read_b64_tr_b16 a[16:17], v24 offset:49152
    ds_read_b64_tr_b16 a[18:19], v24 offset:51200
    v_mfma_f32_16x16x32_bf16 v[168:171], v[36:39], a[168:171], v[168:171]
    s_add_u32 s59, s89, s57
    ds_read_b64_tr_b16 a[20:21], v25 offset:49152
    ds_read_b64_tr_b16 a[22:23], v25 offset:51200
    v_mfma_f32_16x16x32_bf16 v[168:171], v[40:43], a[176:179], v[168:171]
    s_add_u32 s59, s59, 59392
    buffer_load_dwordx4 v14, s[20:23], s59 offen lds
    ds_read_b64_tr_b16 a[24:25], v26 offset:49152
    v_mfma_f32_16x16x32_bf16 v[168:171], v[44:47], a[184:187], v[168:171]
    ds_read_b64_tr_b16 a[26:27], v26 offset:51200
    ds_read_b64_tr_b16 a[28:29], v27 offset:49152
    v_mfma_f32_16x16x32_bf16 v[172:175], v[32:35], a[164:167], v[172:175]
    buffer_load_dwordx4 v15, s[20:23], s59 offen offset:1024 lds
    ds_read_b64_tr_b16 a[30:31], v27 offset:51200
    v_mfma_f32_16x16x32_bf16 v[172:175], v[36:39], a[172:175], v[172:175]
    v_mul_f32 v213, s76, v213
    v_fma_f32 v240, v240, s74, v213
    v_fma_f32 v241, v241, s74, v213
    v_mfma_f32_16x16x32_bf16 v[172:175], v[40:43], a[180:183], v[172:175]
    v_exp_f32_e64 v240, v240
    v_fma_f32 v242, v242, s74, v213
    v_mfma_f32_16x16x32_bf16 v[172:175], v[44:47], a[188:191], v[172:175]
    s_waitcnt vmcnt(4) lgkmcnt(8)
    s_barrier
    buffer_store_dword v223, v5, s[48:51], s84 offen sc1
    v_mfma_f32_16x16x32_bf16 v[176:179], v[48:51], a[32:35], v[176:179]
    ds_read_b64_tr_b16 v[32:33], v9 offset:16384
    v_exp_f32_e64 v241, v241
    v_mfma_f32_16x16x32_bf16 v[176:179], v[52:55], a[40:43], v[176:179]
    ds_read_b64_tr_b16 v[34:35], v9 offset:16896
    v_exp_f32_e64 v242, v242
    v_mfma_f32_16x16x32_bf16 v[176:179], v[56:59], a[48:51], v[176:179]
    ds_read_b64_tr_b16 v[36:37], v9 offset:20480
    v_add_f32 v214, v240, v241
    v_add_f32 v214, v214, v242
    v_mfma_f32_16x16x32_bf16 v[176:179], v[60:63], a[56:59], v[176:179]
    ds_read_b64_tr_b16 v[38:39], v9 offset:20992
    v_fma_f32 v243, v243, s74, v213
    v_fma_f32 v244, v244, s74, v213
    v_mfma_f32_16x16x32_bf16 v[180:183], v[48:51], a[36:39], v[180:183]
    ds_read_b64_tr_b16 v[40:41], v9 offset:24576
    v_exp_f32_e64 v243, v243
    v_mfma_f32_16x16x32_bf16 v[180:183], v[52:55], a[44:47], v[180:183]
    ds_read_b64_tr_b16 v[42:43], v9 offset:25088
    v_exp_f32_e64 v244, v244
    v_mfma_f32_16x16x32_bf16 v[180:183], v[56:59], a[52:55], v[180:183]
    ds_read_b64_tr_b16 v[44:45], v9 offset:28672
    v_add_f32 v214, v214, v243
    v_add_f32 v214, v214, v244
    v_mfma_f32_16x16x32_bf16 v[180:183], v[60:63], a[60:63], v[180:183]
    s_add_u32 m0, s56, 98304
    ds_read_b64_tr_b16 v[46:47], v9 offset:29184
    v_fma_f32 v245, v245, s74, v213
    v_fma_f32 v246, v246, s74, v213
    v_mfma_f32_16x16x32_bf16 v[184:187], v[48:51], a[160:163], v[184:187]
    s_xor_b32 s59, s0, 262144
    buffer_load_dwordx4 v16, s[24:27], s59 offen lds
    v_fma_f32 v247, v247, s74, v213
    v_mfma_f32_16x16x32_bf16 v[184:187], v[52:55], a[168:171], v[184:187]
    v_exp_f32_e64 v245, v245
    v_fma_f32 v248, v248, s74, v213
    v_mfma_f32_16x16x32_bf16 v[184:187], v[56:59], a[176:179], v[184:187]
    buffer_load_dwordx4 v19, s[24:27], s59 offen offset:1024 lds
    v_add_f32_e64 v214, v214, v245
    v_mfma_f32_16x16x32_bf16 v[184:187], v[60:63], a[184:187], v[184:187]
    s_add_u32 m0, s56, 100352
    v_exp_f32_e64 v246, v246
    v_fma_f32 v249, v249, s74, v213
    v_mfma_f32_16x16x32_bf16 v[188:191], v[48:51], a[164:167], v[188:191]
    s_xor_b32 s59, s0, 278528
    buffer_load_dwordx4 v16, s[24:27], s59 offen lds
    v_add_f32_e64 v214, v214, v246
    v_mfma_f32_16x16x32_bf16 v[188:191], v[52:55], a[172:175], v[188:191]
    v_exp_f32_e64 v247, v247
    v_fma_f32 v250, v250, s74, v213
    v_mfma_f32_16x16x32_bf16 v[188:191], v[56:59], a[180:183], v[188:191]
    buffer_load_dwordx4 v19, s[24:27], s59 offen offset:1024 lds
    v_add_f32_e64 v214, v214, v247
    v_mfma_f32_16x16x32_bf16 v[188:191], v[60:63], a[188:191], v[188:191]
    s_waitcnt lgkmcnt(0)
    v_exp_f32 v248, v248
    v_fma_f32 v251, v251, s74, v213
    v_mfma_f32_16x16x32_bf16 v[64:67], v[32:35], a[32:35], v[64:67]
    ds_read_b64_tr_b16 v[48:49], v11 offset:16384
    v_exp_f32_e64 v249, v249
    v_mfma_f32_16x16x32_bf16 v[64:67], v[36:39], a[40:43], v[64:67]
    ds_read_b64_tr_b16 v[50:51], v11 offset:16896
    v_exp_f32_e64 v250, v250
    v_mfma_f32_16x16x32_bf16 v[64:67], v[40:43], a[48:51], v[64:67]
    ds_read_b64_tr_b16 v[52:53], v11 offset:20480
    v_exp_f32_e64 v251, v251
    v_mfma_f32_16x16x32_bf16 v[64:67], v[44:47], a[56:59], v[64:67]
    ds_read_b64_tr_b16 v[54:55], v11 offset:20992
    v_add_f32 v214, v214, v248
    v_add_f32 v214, v214, v249
    v_mfma_f32_16x16x32_bf16 v[68:71], v[32:35], a[36:39], v[68:71]
    ds_read_b64_tr_b16 v[56:57], v11 offset:24576
    v_add_f32 v214, v214, v250
    v_add_f32 v214, v214, v251
    v_mfma_f32_16x16x32_bf16 v[68:71], v[36:39], a[44:47], v[68:71]
    ds_read_b64_tr_b16 v[58:59], v11 offset:25088
    v_fma_f32 v252, v252, s74, v213
    v_fma_f32 v253, v253, s74, v213
    v_mfma_f32_16x16x32_bf16 v[68:71], v[40:43], a[52:55], v[68:71]
    ds_read_b64_tr_b16 v[60:61], v11 offset:28672
    v_exp_f32_e64 v252, v252
    v_mfma_f32_16x16x32_bf16 v[68:71], v[44:47], a[60:63], v[68:71]
    s_add_u32 m0, s56, 114688
    ds_read_b64_tr_b16 v[62:63], v11 offset:29184
    v_exp_f32_e64 v253, v253
    v_mfma_f32_16x16x32_bf16 v[72:75], v[32:35], a[160:163], v[72:75]
    s_xor_b32 s59, s0, 393216
    buffer_load_dwordx4 v16, s[24:27], s59 offen lds
    v_add_f32_e64 v214, v214, v252
    v_mfma_f32_16x16x32_bf16 v[72:75], v[36:39], a[168:171], v[72:75]
    v_add_f32_e64 v214, v214, v253
    v_fma_f32 v254, v254, s74, v213
    v_fma_f32 v255, v255, s74, v213
    v_mfma_f32_16x16x32_bf16 v[72:75], v[40:43], a[176:179], v[72:75]
    buffer_load_dwordx4 v19, s[24:27], s59 offen offset:1024 lds
    v_mfma_f32_16x16x32_bf16 v[72:75], v[44:47], a[184:187], v[72:75]
    s_add_u32 m0, s56, 116736
    v_exp_f32_e64 v254, v254
    v_mfma_f32_16x16x32_bf16 v[76:79], v[32:35], a[164:167], v[76:79]
    s_xor_b32 s59, s0, 409600
    buffer_load_dwordx4 v16, s[24:27], s59 offen lds
    v_add_f32_e64 v214, v214, v254
    v_mfma_f32_16x16x32_bf16 v[76:79], v[36:39], a[172:175], v[76:79]
    v_exp_f32_e64 v255, v255
    v_mfma_f32_16x16x32_bf16 v[76:79], v[40:43], a[180:183], v[76:79]
    buffer_load_dwordx4 v19, s[24:27], s59 offen offset:1024 lds
    v_add_f32_e64 v214, v214, v255
    v_mfma_f32_16x16x32_bf16 v[76:79], v[44:47], a[188:191], v[76:79]
    s_waitcnt lgkmcnt(0)
    s_barrier
    v_mfma_f32_16x16x32_bf16 v[80:83], v[48:51], a[32:35], v[80:83]
    ds_read_b64_tr_b16 v[32:33], v8 offset:0
    v_rcp_f32_e64 v214, v214
    v_mfma_f32_16x16x32_bf16 v[80:83], v[52:55], a[40:43], v[80:83]
    ds_read_b64_tr_b16 v[34:35], v8 offset:512
    v_mul_f32 v240, v240, v214
    v_mul_f32 v241, v241, v214
    v_mfma_f32_16x16x32_bf16 v[80:83], v[56:59], a[48:51], v[80:83]
    ds_read_b64_tr_b16 v[36:37], v8 offset:4096
    v_cvt_pk_bf16_f32 v140, v240, v241
    v_mul_f32_e64 v242, v242, v214
    v_mfma_f32_16x16x32_bf16 v[80:83], v[60:63], a[56:59], v[80:83]
    ds_read_b64_tr_b16 v[38:39], v8 offset:4608
    v_mul_f32_e64 v243, v243, v214
    v_cvt_pk_bf16_f32 v141, v242, v243
    v_mfma_f32_16x16x32_bf16 v[84:87], v[48:51], a[36:39], v[84:87]
    ds_read_b64_tr_b16 v[40:41], v8 offset:8192
    v_mul_f32 v244, v244, v214
    v_mul_f32 v245, v245, v214
    v_mfma_f32_16x16x32_bf16 v[84:87], v[52:55], a[44:47], v[84:87]
    ds_read_b64_tr_b16 v[42:43], v8 offset:8704
    v_cvt_pk_bf16_f32 v142, v244, v245
    v_mul_f32_e64 v246, v246, v214
    v_mfma_f32_16x16x32_bf16 v[84:87], v[56:59], a[52:55], v[84:87]
    ds_read_b64_tr_b16 v[44:45], v8 offset:12288
    v_mul_f32_e64 v247, v247, v214
    v_cvt_pk_bf16_f32 v143, v246, v247
    v_mfma_f32_16x16x32_bf16 v[84:87], v[60:63], a[60:63], v[84:87]
    s_add_u32 m0, s56, 65536
    ds_read_b64_tr_b16 v[46:47], v8 offset:12800
    v_mul_f32 v248, v248, v214
    v_mul_f32 v249, v249, v214
    v_mfma_f32_16x16x32_bf16 v[88:91], v[48:51], a[160:163], v[88:91]
    s_xor_b32 s59, s0, 524288
    buffer_load_dwordx4 v16, s[24:27], s59 offen lds
    v_cvt_pk_bf16_f32 v156, v248, v249
    v_mfma_f32_16x16x32_bf16 v[88:91], v[52:55], a[168:171], v[88:91]
    v_mul_f32 v250, v250, v214
    v_mul_f32 v251, v251, v214
    v_cvt_pk_bf16_f32 v157, v250, v251
    v_mfma_f32_16x16x32_bf16 v[88:91], v[56:59], a[176:179], v[88:91]
    buffer_load_dwordx4 v19, s[24:27], s59 offen offset:1024 lds
    v_mul_f32_e64 v252, v252, v214
    v_mfma_f32_16x16x32_bf16 v[88:91], v[60:63], a[184:187], v[88:91]
    s_add_u32 m0, s56, 67584
    v_mul_f32_e64 v253, v253, v214
    v_cvt_pk_bf16_f32 v158, v252, v253
    v_mul_f32_e64 v254, v254, v214
    v_mfma_f32_16x16x32_bf16 v[92:95], v[48:51], a[164:167], v[92:95]
    s_xor_b32 s59, s0, 540672
    buffer_load_dwordx4 v16, s[24:27], s59 offen lds
    v_mul_f32_e64 v255, v255, v214
    v_mfma_f32_16x16x32_bf16 v[92:95], v[52:55], a[172:175], v[92:95]
    v_cvt_pk_bf16_f32 v159, v254, v255
    v_mfma_f32_16x16x32_bf16 v[92:95], v[56:59], a[180:183], v[92:95]
    buffer_load_dwordx4 v19, s[24:27], s59 offen offset:1024 lds
    v_mfma_f32_16x16x32_bf16 v[92:95], v[60:63], a[188:191], v[92:95]
    s_waitcnt lgkmcnt(0)
    v_mfma_f32_16x16x32_bf16 v[160:163], v[32:35], a[64:67], v[160:163]
    ds_read_b64_tr_b16 v[48:49], v10 offset:0
    v_mfma_f32_16x16x32_bf16 v[160:163], v[36:39], a[72:75], v[160:163]
    ds_read_b64_tr_b16 v[50:51], v10 offset:512
    v_mfma_f32_16x16x32_bf16 v[160:163], v[40:43], a[80:83], v[160:163]
    ds_read_b64_tr_b16 v[52:53], v10 offset:4096
    v_mfma_f32_16x16x32_bf16 v[160:163], v[44:47], a[88:91], v[160:163]
    ds_read_b64_tr_b16 v[54:55], v10 offset:4608
    v_mfma_f32_16x16x32_bf16 v[164:167], v[32:35], a[68:71], v[164:167]
    ds_read_b64_tr_b16 v[56:57], v10 offset:8192
    v_mfma_f32_16x16x32_bf16 v[164:167], v[36:39], a[76:79], v[164:167]
    ds_read_b64_tr_b16 v[58:59], v10 offset:8704
    v_mfma_f32_16x16x32_bf16 v[164:167], v[40:43], a[84:87], v[164:167]
    ds_read_b64_tr_b16 v[60:61], v10 offset:12288
    v_mfma_f32_16x16x32_bf16 v[164:167], v[44:47], a[92:95], v[164:167]
    s_add_u32 m0, s56, 81920
    ds_read_b64_tr_b16 v[62:63], v10 offset:12800
    v_mfma_f32_16x16x32_bf16 v[168:171], v[32:35], a[192:195], v[168:171]
    s_xor_b32 s59, s0, 655360
    buffer_load_dwordx4 v16, s[24:27], s59 offen lds
    v_mfma_f32_16x16x32_bf16 v[168:171], v[36:39], a[200:203], v[168:171]
    v_mfma_f32_16x16x32_bf16 v[168:171], v[40:43], a[208:211], v[168:171]
    buffer_load_dwordx4 v19, s[24:27], s59 offen offset:1024 lds
    v_mfma_f32_16x16x32_bf16 v[168:171], v[44:47], a[216:219], v[168:171]
    s_add_u32 m0, s56, 83968
    v_mfma_f32_16x16x32_bf16 v[172:175], v[32:35], a[196:199], v[172:175]
    s_xor_b32 s59, s0, 671744
    buffer_load_dwordx4 v16, s[24:27], s59 offen lds
    v_mfma_f32_16x16x32_bf16 v[172:175], v[36:39], a[204:207], v[172:175]
    v_mfma_f32_16x16x32_bf16 v[172:175], v[40:43], a[212:215], v[172:175]
    buffer_load_dwordx4 v19, s[24:27], s59 offen offset:1024 lds
    v_mfma_f32_16x16x32_bf16 v[172:175], v[44:47], a[220:223], v[172:175]
    s_waitcnt lgkmcnt(0)
    s_barrier
    v_mfma_f32_16x16x32_bf16 v[176:179], v[48:51], a[64:67], v[176:179]
    s_waitcnt vmcnt(8)
    ds_read_b64_tr_b16 v[32:33], v8 offset:16384
    ds_read_b64_tr_b16 a[128:129], v24 offset:32768
    v_mfma_f32_16x16x32_bf16 v[176:179], v[52:55], a[72:75], v[176:179]
    ds_read_b64_tr_b16 v[34:35], v8 offset:16896
    ds_read_b64_tr_b16 a[130:131], v24 offset:34816
    v_mfma_f32_16x16x32_bf16 v[176:179], v[56:59], a[80:83], v[176:179]
    ds_read_b64_tr_b16 v[36:37], v8 offset:20480
    ds_read_b64_tr_b16 a[132:133], v25 offset:32768
    v_mfma_f32_16x16x32_bf16 v[176:179], v[60:63], a[88:91], v[176:179]
    ds_read_b64_tr_b16 v[38:39], v8 offset:20992
    ds_read_b64_tr_b16 a[134:135], v25 offset:34816
    v_mfma_f32_16x16x32_bf16 v[180:183], v[48:51], a[68:71], v[180:183]
    ds_read_b64_tr_b16 v[40:41], v8 offset:24576
    ds_read_b64_tr_b16 a[136:137], v26 offset:32768
    v_mfma_f32_16x16x32_bf16 v[180:183], v[52:55], a[76:79], v[180:183]
    ds_read_b64_tr_b16 v[42:43], v8 offset:25088
    ds_read_b64_tr_b16 a[138:139], v26 offset:34816
    v_mfma_f32_16x16x32_bf16 v[180:183], v[56:59], a[84:87], v[180:183]
    ds_read_b64_tr_b16 v[44:45], v8 offset:28672
    ds_read_b64_tr_b16 a[140:141], v27 offset:32768
    v_mfma_f32_16x16x32_bf16 v[180:183], v[60:63], a[92:95], v[180:183]
    s_add_u32 m0, s56, 0
    ds_read_b64_tr_b16 v[46:47], v8 offset:29184
    ds_read_b64_tr_b16 a[142:143], v27 offset:34816
    v_mfma_f32_16x16x32_bf16 v[184:187], v[48:51], a[192:195], v[184:187]
    s_xor_b32 s59, s0, 786432
    buffer_load_dwordx4 v16, s[24:27], s59 offen lds
    ds_read_b64_tr_b16 a[144:145], v24 offset:49152
    v_mfma_f32_16x16x32_bf16 v[184:187], v[52:55], a[200:203], v[184:187]
    ds_read_b64_tr_b16 a[146:147], v24 offset:51200
    ds_read_b64_tr_b16 a[148:149], v25 offset:49152
    v_mfma_f32_16x16x32_bf16 v[184:187], v[56:59], a[208:211], v[184:187]
    buffer_load_dwordx4 v19, s[24:27], s59 offen offset:1024 lds
    ds_read_b64_tr_b16 a[150:151], v25 offset:51200
    v_mfma_f32_16x16x32_bf16 v[184:187], v[60:63], a[216:219], v[184:187]
    s_add_u32 m0, s56, 2048
    ds_read_b64_tr_b16 a[152:153], v26 offset:49152
    ds_read_b64_tr_b16 a[154:155], v26 offset:51200
    v_mfma_f32_16x16x32_bf16 v[188:191], v[48:51], a[196:199], v[188:191]
    s_xor_b32 s59, s0, 802816
    buffer_load_dwordx4 v16, s[24:27], s59 offen lds
    ds_read_b64_tr_b16 a[156:157], v27 offset:49152
    v_mfma_f32_16x16x32_bf16 v[188:191], v[52:55], a[204:207], v[188:191]
    ds_read_b64_tr_b16 a[158:159], v27 offset:51200
    v_mfma_f32_16x16x32_bf16 v[188:191], v[56:59], a[212:215], v[188:191]
    buffer_load_dwordx4 v19, s[24:27], s59 offen offset:1024 lds
    v_mfma_f32_16x16x32_bf16 v[188:191], v[60:63], a[220:223], v[188:191]
    s_waitcnt lgkmcnt(8)
    v_mfma_f32_16x16x32_bf16 v[64:67], v[32:35], a[64:67], v[64:67]
    s_waitcnt vmcnt(8)
    ds_read_b64_tr_b16 v[48:49], v10 offset:16384
    ds_read_b64_tr_b16 a[32:33], v24 offset:0
    v_mfma_f32_16x16x32_bf16 v[64:67], v[36:39], a[72:75], v[64:67]
    ds_read_b64_tr_b16 v[50:51], v10 offset:16896
    ds_read_b64_tr_b16 a[34:35], v24 offset:2048
    v_mfma_f32_16x16x32_bf16 v[64:67], v[40:43], a[80:83], v[64:67]
    ds_read_b64_tr_b16 v[52:53], v10 offset:20480
    ds_read_b64_tr_b16 a[36:37], v25 offset:0
    v_mfma_f32_16x16x32_bf16 v[64:67], v[44:47], a[88:91], v[64:67]
    ds_read_b64_tr_b16 v[54:55], v10 offset:20992
    ds_read_b64_tr_b16 a[38:39], v25 offset:2048
    v_mfma_f32_16x16x32_bf16 v[68:71], v[32:35], a[68:71], v[68:71]
    ds_read_b64_tr_b16 v[56:57], v10 offset:24576
    ds_read_b64_tr_b16 a[40:41], v26 offset:0
    v_mfma_f32_16x16x32_bf16 v[68:71], v[36:39], a[76:79], v[68:71]
    ds_read_b64_tr_b16 v[58:59], v10 offset:25088
    ds_read_b64_tr_b16 a[42:43], v26 offset:2048
    v_mfma_f32_16x16x32_bf16 v[68:71], v[40:43], a[84:87], v[68:71]
    ds_read_b64_tr_b16 v[60:61], v10 offset:28672
    ds_read_b64_tr_b16 a[44:45], v27 offset:0
    v_mfma_f32_16x16x32_bf16 v[68:71], v[44:47], a[92:95], v[68:71]
    s_add_u32 m0, s56, 98304
    ds_read_b64_tr_b16 v[62:63], v10 offset:29184
    ds_read_b64_tr_b16 a[46:47], v27 offset:2048
    v_mfma_f32_16x16x32_bf16 v[72:75], v[32:35], a[192:195], v[72:75]
    s_xor_b32 s59, s6, 0
    buffer_load_dwordx4 v16, s[28:31], s59 offen lds
    v_mfma_f32_16x16x32_bf16 v[72:75], v[36:39], a[200:203], v[72:75]
    v_mfma_f32_16x16x32_bf16 v[72:75], v[40:43], a[208:211], v[72:75]
    buffer_load_dwordx4 v19, s[28:31], s59 offen offset:1024 lds
    v_mfma_f32_16x16x32_bf16 v[72:75], v[44:47], a[216:219], v[72:75]
    s_add_u32 m0, s56, 100352
    v_mfma_f32_16x16x32_bf16 v[76:79], v[32:35], a[196:199], v[76:79]
    s_xor_b32 s59, s6, 16384
    buffer_load_dwordx4 v16, s[28:31], s59 offen lds
    v_mfma_f32_16x16x32_bf16 v[76:79], v[36:39], a[204:207], v[76:79]
    v_mfma_f32_16x16x32_bf16 v[76:79], v[40:43], a[212:215], v[76:79]
    buffer_load_dwordx4 v19, s[28:31], s59 offen offset:1024 lds
    v_mfma_f32_16x16x32_bf16 v[76:79], v[44:47], a[220:223], v[76:79]
    s_waitcnt lgkmcnt(0)
    s_barrier
    s_lshl_b32 s61, s5, 4
    s_add_u32 s61, s61, s4
    s_lshl_b32 s61, s61, 7
    s_add_u32 s61, s61, 64
    buffer_load_dword v17, v3, s[48:51], s61 offen sc1
    v_mfma_f32_16x16x32_bf16 v[80:83], v[48:51], a[64:67], v[80:83]
    s_waitcnt vmcnt(9)
    ds_read_b64_tr_b16 v[32:33], v8 offset:32768
    ds_read_b64_tr_b16 a[48:49], v24 offset:16384
    v_mfma_f32_16x16x32_bf16 v[80:83], v[52:55], a[72:75], v[80:83]
    ds_read_b64_tr_b16 v[34:35], v8 offset:33280
    ds_read_b64_tr_b16 a[50:51], v24 offset:18432
    v_mfma_f32_16x16x32_bf16 v[80:83], v[56:59], a[80:83], v[80:83]
    ds_read_b64_tr_b16 v[36:37], v8 offset:36864
    ds_read_b64_tr_b16 a[52:53], v25 offset:16384
    v_mfma_f32_16x16x32_bf16 v[80:83], v[60:63], a[88:91], v[80:83]
    ds_read_b64_tr_b16 v[38:39], v8 offset:37376
    ds_read_b64_tr_b16 a[54:55], v25 offset:18432
    v_mfma_f32_16x16x32_bf16 v[84:87], v[48:51], a[68:71], v[84:87]
    ds_read_b64_tr_b16 v[40:41], v8 offset:40960
    ds_read_b64_tr_b16 a[56:57], v26 offset:16384
    v_mfma_f32_16x16x32_bf16 v[84:87], v[52:55], a[76:79], v[84:87]
    ds_read_b64_tr_b16 v[42:43], v8 offset:41472
    ds_read_b64_tr_b16 a[58:59], v26 offset:18432
    v_mfma_f32_16x16x32_bf16 v[84:87], v[56:59], a[84:87], v[84:87]
    ds_read_b64_tr_b16 v[44:45], v8 offset:45056
    ds_read_b64_tr_b16 a[60:61], v27 offset:16384
    v_mfma_f32_16x16x32_bf16 v[84:87], v[60:63], a[92:95], v[84:87]
    s_add_u32 m0, s56, 65536
    ds_read_b64_tr_b16 v[46:47], v8 offset:45568
    ds_read_b64_tr_b16 a[62:63], v27 offset:18432
    v_mfma_f32_16x16x32_bf16 v[88:91], v[48:51], a[192:195], v[88:91]
    s_xor_b32 s59, s0, 917504
    buffer_load_dwordx4 v16, s[24:27], s59 offen lds
    v_mfma_f32_16x16x32_bf16 v[88:91], v[52:55], a[200:203], v[88:91]
    v_mfma_f32_16x16x32_bf16 v[88:91], v[56:59], a[208:211], v[88:91]
    buffer_load_dwordx4 v19, s[24:27], s59 offen offset:1024 lds
    v_mfma_f32_16x16x32_bf16 v[88:91], v[60:63], a[216:219], v[88:91]
    s_add_u32 m0, s56, 67584
    v_mfma_f32_16x16x32_bf16 v[92:95], v[48:51], a[196:199], v[92:95]
    s_xor_b32 s59, s0, 933888
    buffer_load_dwordx4 v16, s[24:27], s59 offen lds
    v_mfma_f32_16x16x32_bf16 v[92:95], v[52:55], a[204:207], v[92:95]
    v_mfma_f32_16x16x32_bf16 v[92:95], v[56:59], a[212:215], v[92:95]
    buffer_load_dwordx4 v19, s[24:27], s59 offen offset:1024 lds
    v_mfma_f32_16x16x32_bf16 v[92:95], v[60:63], a[220:223], v[92:95]
    s_waitcnt lgkmcnt(0)
    v_mfma_f32_16x16x32_bf16 v[160:163], v[32:35], a[96:99], v[160:163]
    s_waitcnt vmcnt(9)
    ds_read_b64_tr_b16 v[48:49], v10 offset:32768
    ds_read_b64_tr_b16 a[160:161], v20 offset:0
    v_mfma_f32_16x16x32_bf16 v[160:163], v[36:39], a[104:107], v[160:163]
    ds_read_b64_tr_b16 v[50:51], v10 offset:33280
    ds_read_b64_tr_b16 a[162:163], v20 offset:2048
    v_mfma_f32_16x16x32_bf16 v[160:163], v[40:43], a[112:115], v[160:163]
    ds_read_b64_tr_b16 v[52:53], v10 offset:36864
    ds_read_b64_tr_b16 a[164:165], v21 offset:0
    v_mfma_f32_16x16x32_bf16 v[160:163], v[44:47], a[120:123], v[160:163]
    ds_read_b64_tr_b16 v[54:55], v10 offset:37376
    ds_read_b64_tr_b16 a[166:167], v21 offset:2048
    v_mfma_f32_16x16x32_bf16 v[164:167], v[32:35], a[100:103], v[164:167]
    ds_read_b64_tr_b16 v[56:57], v10 offset:40960
    ds_read_b64_tr_b16 a[168:169], v22 offset:0
    v_mfma_f32_16x16x32_bf16 v[164:167], v[36:39], a[108:111], v[164:167]
    ds_read_b64_tr_b16 v[58:59], v10 offset:41472
    ds_read_b64_tr_b16 a[170:171], v22 offset:2048
    v_mfma_f32_16x16x32_bf16 v[164:167], v[40:43], a[116:119], v[164:167]
    ds_read_b64_tr_b16 v[60:61], v10 offset:45056
    ds_read_b64_tr_b16 a[172:173], v23 offset:0
    v_mfma_f32_16x16x32_bf16 v[164:167], v[44:47], a[124:127], v[164:167]
    s_add_u32 m0, s56, 16384
    ds_read_b64_tr_b16 v[62:63], v10 offset:45568
    ds_read_b64_tr_b16 a[174:175], v23 offset:2048
    v_mfma_f32_16x16x32_bf16 v[168:171], v[32:35], a[224:227], v[168:171]
    s_xor_b32 s59, s6, 1048576
    buffer_load_dwordx4 v16, s[24:27], s59 offen lds
    v_mfma_f32_16x16x32_bf16 v[168:171], v[36:39], a[232:235], v[168:171]
    v_mfma_f32_16x16x32_bf16 v[168:171], v[40:43], a[240:243], v[168:171]
    buffer_load_dwordx4 v19, s[24:27], s59 offen offset:1024 lds
    v_mfma_f32_16x16x32_bf16 v[168:171], v[44:47], a[248:251], v[168:171]
    s_add_u32 m0, s56, 18432
    v_mfma_f32_16x16x32_bf16 v[172:175], v[32:35], a[228:231], v[172:175]
    s_xor_b32 s59, s6, 1064960
    buffer_load_dwordx4 v16, s[24:27], s59 offen lds
    v_mfma_f32_16x16x32_bf16 v[172:175], v[36:39], a[236:239], v[172:175]
    v_mfma_f32_16x16x32_bf16 v[172:175], v[40:43], a[244:247], v[172:175]
    buffer_load_dwordx4 v19, s[24:27], s59 offen offset:1024 lds
    v_mfma_f32_16x16x32_bf16 v[172:175], v[44:47], a[252:255], v[172:175]
    s_waitcnt lgkmcnt(0)
    s_barrier
    s_waitcnt vmcnt(8)
    v_cmp_gt_u32 vcc, 1, v17
    s_nop 0
    s_and_b32 vcc_lo, vcc_lo, 0xffff
    s_cbranch_scc1 L_q_retry1
L_q_back1:
    v_mfma_f32_16x16x32_bf16 v[176:179], v[48:51], a[96:99], v[176:179]
    s_lshl_b32 s78, s69, 11
    ds_read_b64_tr_b16 v[32:33], v8 offset:49152
    v_lshlrev_b32 v104, 2, v1
    v_and_b32 v105, 15, v1
    v_mfma_f32_16x16x32_bf16 v[176:179], v[52:55], a[104:107], v[176:179]
    s_add_u32 s78, s78, 32768
    ds_read_b64_tr_b16 v[34:35], v8 offset:49664
    v_lshrrev_b32 v106, 4, v1
    v_lshlrev_b32 v107, 3, v106
    v_mfma_f32_16x16x32_bf16 v[176:179], v[56:59], a[112:115], v[176:179]
    s_lshl_b32 s79, s69, 14
    ds_read_b64_tr_b16 v[36:37], v8 offset:53248
    v_lshl_add_u32 v105, v105, 5, v107
    v_and_b32 v107, 31, v1
    v_mfma_f32_16x16x32_bf16 v[176:179], v[60:63], a[120:123], v[176:179]
    s_add_u32 s79, s79, 131072
    ds_read_b64_tr_b16 v[38:39], v8 offset:53760
    v_mfma_f32_16x16x32_bf16 v[180:183], v[48:51], a[100:103], v[180:183]
    s_and_b32 s80, s4, 3
    ds_read_b64_tr_b16 v[40:41], v8 offset:57344
    v_mfma_f32_16x16x32_bf16 v[180:183], v[52:55], a[108:111], v[180:183]
    s_lshl_b32 s80, s80, 12
    ds_read_b64_tr_b16 v[42:43], v8 offset:57856
    v_mfma_f32_16x16x32_bf16 v[180:183], v[56:59], a[116:119], v[180:183]
    s_add_u32 s79, s79, s80
    ds_read_b64_tr_b16 v[44:45], v8 offset:61440
    v_mfma_f32_16x16x32_bf16 v[180:183], v[60:63], a[124:127], v[180:183]
    s_xor_b32 s80, s79, 0
    ds_read_b64_tr_b16 v[46:47], v8 offset:61952
    v_mfma_f32_16x16x32_bf16 v[184:187], v[48:51], a[224:227], v[184:187]
    s_lshl_b32 s81, s3, 10
    buffer_load_dwordx4 v[192:195], v2, s[48:51], s80 offen offset:0 sc1
    v_mfma_f32_16x16x32_bf16 v[184:187], v[52:55], a[232:235], v[184:187]
    s_add_u32 s81, s81, 32768
    buffer_load_dwordx4 v[196:199], v2, s[48:51], s80 offen offset:1024 sc1
    v_add_u32 v105, s81, v105
    v_mfma_f32_16x16x32_bf16 v[184:187], v[56:59], a[240:243], v[184:187]
    s_lshl_b32 s81, s3, 6
    buffer_load_dwordx4 v[200:203], v2, s[48:51], s80 offen offset:2048 sc1
    v_mfma_f32_16x16x32_bf16 v[184:187], v[60:63], a[248:251], v[184:187]
    s_add_u32 s81, s81, 32768
    buffer_load_dwordx4 v[204:207], v2, s[48:51], s80 offen offset:3072 sc1
    v_lshl_add_u32 v107, v107, 1, s81
    v_mfma_f32_16x16x32_bf16 v[188:191], v[48:51], a[228:231], v[188:191]
    s_xor_b32 s80, s79, 4096
    v_mfma_f32_16x16x32_bf16 v[188:191], v[52:55], a[236:239], v[188:191]
    s_and_b32 s83, s3, 1
    buffer_load_dwordx4 v[208:211], v2, s[48:51], s80 offen offset:0 sc1
    v_mfma_f32_16x16x32_bf16 v[188:191], v[56:59], a[244:247], v[188:191]
    s_lshl_b32 s81, s83, 11
    buffer_load_dwordx4 v[212:215], v2, s[48:51], s80 offen offset:1024 sc1
    v_mfma_f32_16x16x32_bf16 v[188:191], v[60:63], a[252:255], v[188:191]
    s_add_u32 s81, s81, 32768
    buffer_load_dwordx4 v[216:219], v2, s[48:51], s80 offen offset:2048 sc1
    v_lshl_add_u32 v108, v1, 5, s81
    s_waitcnt lgkmcnt(0)
    v_mfma_f32_16x16x32_bf16 v[64:67], v[32:35], a[96:99], v[64:67]
    s_waitcnt vmcnt(11)
    s_lshl_b32 s81, s83, 7
    ds_read_b64_tr_b16 v[48:49], v10 offset:49152
    ds_read_b64_tr_b16 a[176:177], v24 offset:0
    v_mfma_f32_16x16x32_bf16 v[64:67], v[36:39], a[104:107], v[64:67]
    s_add_u32 s81, s81, 32768
    ds_read_b64_tr_b16 v[50:51], v10 offset:49664
    ds_read_b64_tr_b16 a[178:179], v24 offset:2048
    v_mfma_f32_16x16x32_bf16 v[64:67], v[40:43], a[112:115], v[64:67]
    ds_read_b64_tr_b16 v[52:53], v10 offset:53248
    ds_read_b64_tr_b16 a[180:181], v25 offset:0
    v_mfma_f32_16x16x32_bf16 v[64:67], v[44:47], a[120:123], v[64:67]
    ds_read_b64_tr_b16 v[54:55], v10 offset:53760
    ds_read_b64_tr_b16 a[182:183], v25 offset:2048
    v_mfma_f32_16x16x32_bf16 v[68:71], v[32:35], a[100:103], v[68:71]
    ds_read_b64_tr_b16 v[56:57], v10 offset:57344
    ds_read_b64_tr_b16 a[184:185], v26 offset:0
    v_mfma_f32_16x16x32_bf16 v[68:71], v[36:39], a[108:111], v[68:71]
    ds_read_b64_tr_b16 v[58:59], v10 offset:57856
    ds_read_b64_tr_b16 a[186:187], v26 offset:2048
    v_mfma_f32_16x16x32_bf16 v[68:71], v[40:43], a[116:119], v[68:71]
    ds_read_b64_tr_b16 v[60:61], v10 offset:61440
    ds_read_b64_tr_b16 a[188:189], v27 offset:0
    v_mfma_f32_16x16x32_bf16 v[68:71], v[44:47], a[124:127], v[68:71]
    ds_read_b64_tr_b16 v[62:63], v10 offset:61952
    ds_read_b64_tr_b16 a[190:191], v27 offset:2048
    v_mfma_f32_16x16x32_bf16 v[72:75], v[32:35], a[224:227], v[72:75]
    buffer_load_dwordx4 v[220:223], v2, s[48:51], s80 offen offset:3072 sc1
    v_lshl_add_u32 v109, v106, 5, s81
    v_mfma_f32_16x16x32_bf16 v[72:75], v[36:39], a[232:235], v[72:75]
    s_xor_b32 s80, s79, 8192
    v_mfma_f32_16x16x32_bf16 v[72:75], v[40:43], a[240:243], v[72:75]
    buffer_load_dwordx4 v[224:227], v2, s[48:51], s80 offen offset:0 sc1
    v_mfma_f32_16x16x32_bf16 v[72:75], v[44:47], a[248:251], v[72:75]
    buffer_load_dwordx4 v[228:231], v2, s[48:51], s80 offen offset:1024 sc1
    v_mfma_f32_16x16x32_bf16 v[76:79], v[32:35], a[228:231], v[76:79]
    buffer_load_dwordx4 v[232:235], v2, s[48:51], s80 offen offset:2048 sc1
    v_mfma_f32_16x16x32_bf16 v[76:79], v[36:39], a[236:239], v[76:79]
    buffer_load_dwordx4 v[236:239], v2, s[48:51], s80 offen offset:3072 sc1
    v_mfma_f32_16x16x32_bf16 v[76:79], v[40:43], a[244:247], v[76:79]
    s_xor_b32 s80, s79, 12288
    v_mfma_f32_16x16x32_bf16 v[76:79], v[44:47], a[252:255], v[76:79]
    s_waitcnt lgkmcnt(0)
    buffer_load_dwordx4 v[240:243], v2, s[48:51], s80 offen offset:0 sc1
    v_mfma_f32_16x16x32_bf16 v[80:83], v[48:51], a[96:99], v[80:83]
    s_waitcnt vmcnt(13)
    buffer_load_dwordx4 v[244:247], v2, s[48:51], s80 offen offset:1024 sc1
    ds_read_b64_tr_b16 a[64:65], v20 offset:16384
    v_mfma_f32_16x16x32_bf16 v[80:83], v[52:55], a[104:107], v[80:83]
    buffer_load_dwordx4 v[248:251], v2, s[48:51], s80 offen offset:2048 sc1
    ds_read_b64_tr_b16 a[66:67], v20 offset:18432
    v_mfma_f32_16x16x32_bf16 v[80:83], v[56:59], a[112:115], v[80:83]
    buffer_load_dwordx4 v[252:255], v2, s[48:51], s80 offen offset:3072 sc1
    ds_read_b64_tr_b16 a[68:69], v21 offset:16384
    v_mfma_f32_16x16x32_bf16 v[80:83], v[60:63], a[120:123], v[80:83]
    buffer_load_dword v96, v104, s[48:51], s78 offen offset:0 sc1
    ds_read_b64_tr_b16 a[70:71], v21 offset:18432
    v_mfma_f32_16x16x32_bf16 v[84:87], v[48:51], a[100:103], v[84:87]
    buffer_load_dword v97, v104, s[48:51], s78 offen offset:256 sc1
    ds_read_b64_tr_b16 a[72:73], v22 offset:16384
    v_mfma_f32_16x16x32_bf16 v[84:87], v[52:55], a[108:111], v[84:87]
    buffer_load_dword v98, v104, s[48:51], s78 offen offset:512 sc1
    ds_read_b64_tr_b16 a[74:75], v22 offset:18432
    v_mfma_f32_16x16x32_bf16 v[84:87], v[56:59], a[116:119], v[84:87]
    buffer_load_dword v99, v104, s[48:51], s78 offen offset:768 sc1
    ds_read_b64_tr_b16 a[76:77], v23 offset:16384
    v_mfma_f32_16x16x32_bf16 v[84:87], v[60:63], a[124:127], v[84:87]
    buffer_load_dword v100, v104, s[48:51], s78 offen offset:1024 sc1
    ds_read_b64_tr_b16 a[78:79], v23 offset:18432
    v_mfma_f32_16x16x32_bf16 v[88:91], v[48:51], a[224:227], v[88:91]
    buffer_load_dword v101, v104, s[48:51], s78 offen offset:1280 sc1
    v_mfma_f32_16x16x32_bf16 v[88:91], v[52:55], a[232:235], v[88:91]
    buffer_load_dword v102, v104, s[48:51], s78 offen offset:1536 sc1
    v_mfma_f32_16x16x32_bf16 v[88:91], v[56:59], a[240:243], v[88:91]
    buffer_load_dword v103, v104, s[48:51], s78 offen offset:1792 sc1
    v_mfma_f32_16x16x32_bf16 v[88:91], v[60:63], a[248:251], v[88:91]
    buffer_load_dword v17, v3, s[48:51], s90 offen sc1
    v_mfma_f32_16x16x32_bf16 v[92:95], v[48:51], a[228:231], v[92:95]
    v_mfma_f32_16x16x32_bf16 v[92:95], v[52:55], a[236:239], v[92:95]
    v_mfma_f32_16x16x32_bf16 v[92:95], v[56:59], a[244:247], v[92:95]
    v_mfma_f32_16x16x32_bf16 v[92:95], v[60:63], a[252:255], v[92:95]
    s_lshl_b32 s75, s57, 6
    s_nop 0
    s_add_u32 s75, s75, 131072
    v_pk_mul_f32 v[64:65], v[160:161], v[64:65]
    v_pk_mul_f32 v[66:67], v[162:163], v[66:67]
    v_pk_mul_f32 v[80:81], v[176:177], v[80:81]
    v_pk_mul_f32 v[82:83], v[178:179], v[82:83]
    v_cvt_pk_bf16_f32 v64, v64, v65
    v_cvt_pk_bf16_f32 v65, v66, v67
    v_cvt_pk_bf16_f32 v66, v80, v81
    v_cvt_pk_bf16_f32 v67, v82, v83
    v_pk_mul_f32 v[68:69], v[164:165], v[68:69]
    v_pk_mul_f32 v[70:71], v[166:167], v[70:71]
    v_pk_mul_f32 v[84:85], v[180:181], v[84:85]
    v_pk_mul_f32 v[86:87], v[182:183], v[86:87]
    v_cvt_pk_bf16_f32 v68, v68, v69
    v_cvt_pk_bf16_f32 v69, v70, v71
    v_cvt_pk_bf16_f32 v70, v84, v85
    v_cvt_pk_bf16_f32 v71, v86, v87
    v_pk_mul_f32 v[72:73], v[168:169], v[72:73]
    v_pk_mul_f32 v[74:75], v[170:171], v[74:75]
    v_pk_mul_f32 v[88:89], v[184:185], v[88:89]
    v_pk_mul_f32 v[90:91], v[186:187], v[90:91]
    v_cvt_pk_bf16_f32 v72, v72, v73
    v_cvt_pk_bf16_f32 v73, v74, v75
    v_cvt_pk_bf16_f32 v74, v88, v89
    v_cvt_pk_bf16_f32 v75, v90, v91
    v_pk_mul_f32 v[76:77], v[172:173], v[76:77]
    v_pk_mul_f32 v[78:79], v[174:175], v[78:79]
    v_pk_mul_f32 v[92:93], v[188:189], v[92:93]
    v_pk_mul_f32 v[94:95], v[190:191], v[94:95]
    v_cvt_pk_bf16_f32 v76, v76, v77
    v_cvt_pk_bf16_f32 v77, v78, v79
    v_cvt_pk_bf16_f32 v78, v92, v93
    v_cvt_pk_bf16_f32 v79, v94, v95
    v_mov_b32_e64 v59, 2
    s_mov_b32 s78, 0x3f80
    s_mov_b32 s79, 0x3f800000
    s_waitcnt vmcnt(24)
    v_dot2_f32_bf16 v32, v192, s78, 0
    v_dot2_f32_bf16 v33, v192, s79, 0
    v_dot2_f32_bf16 v34, v193, s78, 0
    v_dot2_f32_bf16 v35, v193, s79, 0
    v_dot2_f32_bf16 v36, v194, s78, 0
    v_dot2_f32_bf16 v37, v194, s79, 0
    v_dot2_f32_bf16 v38, v195, s78, 0
    v_dot2_f32_bf16 v39, v195, s79, 0
    s_add_u32 s60, s75, s70
    buffer_store_dwordx4 v[64:67], v18, s[44:47], s60 offen sc1
    s_waitcnt vmcnt(24)
    v_dot2_f32_bf16 v32, v196, s78, v32
    v_dot2_f32_bf16 v33, v196, s79, v33
    v_dot2_f32_bf16 v34, v197, s78, v34
    v_dot2_f32_bf16 v35, v197, s79, v35
    v_dot2_f32_bf16 v36, v198, s78, v36
    v_dot2_f32_bf16 v37, v198, s79, v37
    v_dot2_f32_bf16 v38, v199, s78, v38
    v_dot2_f32_bf16 v39, v199, s79, v39
    s_waitcnt vmcnt(23)
    s_nop 0
    v_dot2_f32_bf16 v32, v200, s78, v32
    v_dot2_f32_bf16 v33, v200, s79, v33
    v_dot2_f32_bf16 v34, v201, s78, v34
    v_dot2_f32_bf16 v35, v201, s79, v35
    v_dot2_f32_bf16 v36, v202, s78, v36
    v_dot2_f32_bf16 v37, v202, s79, v37
    v_dot2_f32_bf16 v38, v203, s78, v38
    v_dot2_f32_bf16 v39, v203, s79, v39
    s_waitcnt vmcnt(22)
    s_nop 0
    v_dot2_f32_bf16 v32, v204, s78, v32
    v_dot2_f32_bf16 v33, v204, s79, v33
    v_dot2_f32_bf16 v34, v205, s78, v34
    v_dot2_f32_bf16 v35, v205, s79, v35
    v_dot2_f32_bf16 v36, v206, s78, v36
    v_dot2_f32_bf16 v37, v206, s79, v37
    v_dot2_f32_bf16 v38, v207, s78, v38
    v_dot2_f32_bf16 v39, v207, s79, v39
    s_waitcnt vmcnt(21)
    s_nop 0
    v_dot2_f32_bf16 v32, v208, s78, v32
    v_dot2_f32_bf16 v33, v208, s79, v33
    v_dot2_f32_bf16 v34, v209, s78, v34
    v_dot2_f32_bf16 v35, v209, s79, v35
    v_dot2_f32_bf16 v36, v210, s78, v36
    v_dot2_f32_bf16 v37, v210, s79, v37
    v_dot2_f32_bf16 v38, v211, s78, v38
    v_dot2_f32_bf16 v39, v211, s79, v39
    s_add_u32 s60, s75, s71
    buffer_store_dwordx4 v[68:71], v18, s[44:47], s60 offen sc1
    s_waitcnt vmcnt(21)
    v_dot2_f32_bf16 v32, v212, s78, v32
    v_dot2_f32_bf16 v33, v212, s79, v33
    v_dot2_f32_bf16 v34, v213, s78, v34
    v_dot2_f32_bf16 v35, v213, s79, v35
    v_dot2_f32_bf16 v36, v214, s78, v36
    v_dot2_f32_bf16 v37, v214, s79, v37
    v_dot2_f32_bf16 v38, v215, s78, v38
    v_dot2_f32_bf16 v39, v215, s79, v39
    s_waitcnt vmcnt(20)
    s_nop 0
    v_dot2_f32_bf16 v32, v216, s78, v32
    v_dot2_f32_bf16 v33, v216, s79, v33
    v_dot2_f32_bf16 v34, v217, s78, v34
    v_dot2_f32_bf16 v35, v217, s79, v35
    v_dot2_f32_bf16 v36, v218, s78, v36
    v_dot2_f32_bf16 v37, v218, s79, v37
    v_dot2_f32_bf16 v38, v219, s78, v38
    v_dot2_f32_bf16 v39, v219, s79, v39
    s_waitcnt vmcnt(19)
    s_nop 0
    v_dot2_f32_bf16 v32, v220, s78, v32
    v_dot2_f32_bf16 v33, v220, s79, v33
    v_dot2_f32_bf16 v34, v221, s78, v34
    v_dot2_f32_bf16 v35, v221, s79, v35
    v_dot2_f32_bf16 v36, v222, s78, v36
    v_dot2_f32_bf16 v37, v222, s79, v37
    v_dot2_f32_bf16 v38, v223, s78, v38
    v_dot2_f32_bf16 v39, v223, s79, v39
    s_waitcnt vmcnt(18)
    s_nop 0
    v_dot2_f32_bf16 v32, v224, s78, v32
    v_dot2_f32_bf16 v33, v224, s79, v33
    v_dot2_f32_bf16 v34, v225, s78, v34
    v_dot2_f32_bf16 v35, v225, s79, v35
    v_dot2_f32_bf16 v36, v226, s78, v36
    v_dot2_f32_bf16 v37, v226, s79, v37
    v_dot2_f32_bf16 v38, v227, s78, v38
    v_dot2_f32_bf16 v39, v227, s79, v39
    s_add_u32 s60, s75, s72
    buffer_store_dwordx4 v[72:75], v18, s[44:47], s60 offen sc1
    s_waitcnt vmcnt(18)
    v_dot2_f32_bf16 v32, v228, s78, v32
    v_dot2_f32_bf16 v33, v228, s79, v33
    v_dot2_f32_bf16 v34, v229, s78, v34
    v_dot2_f32_bf16 v35, v229, s79, v35
    v_dot2_f32_bf16 v36, v230, s78, v36
    v_dot2_f32_bf16 v37, v230, s79, v37
    v_dot2_f32_bf16 v38, v231, s78, v38
    v_dot2_f32_bf16 v39, v231, s79, v39
    s_waitcnt vmcnt(17)
    s_nop 0
    v_dot2_f32_bf16 v32, v232, s78, v32
    v_dot2_f32_bf16 v33, v232, s79, v33
    v_dot2_f32_bf16 v34, v233, s78, v34
    v_dot2_f32_bf16 v35, v233, s79, v35
    v_dot2_f32_bf16 v36, v234, s78, v36
    v_dot2_f32_bf16 v37, v234, s79, v37
    v_dot2_f32_bf16 v38, v235, s78, v38
    v_dot2_f32_bf16 v39, v235, s79, v39
    s_waitcnt vmcnt(16)
    s_nop 0
    v_dot2_f32_bf16 v32, v236, s78, v32
    v_dot2_f32_bf16 v33, v236, s79, v33
    v_dot2_f32_bf16 v34, v237, s78, v34
    v_dot2_f32_bf16 v35, v237, s79, v35
    v_dot2_f32_bf16 v36, v238, s78, v36
    v_dot2_f32_bf16 v37, v238, s79, v37
    v_dot2_f32_bf16 v38, v239, s78, v38
    v_dot2_f32_bf16 v39, v239, s79, v39
    s_waitcnt vmcnt(15)
    s_nop 0
    v_dot2_f32_bf16 v32, v240, s78, v32
    v_dot2_f32_bf16 v33, v240, s79, v33
    v_dot2_f32_bf16 v34, v241, s78, v34
    v_dot2_f32_bf16 v35, v241, s79, v35
    v_dot2_f32_bf16 v36, v242, s78, v36
    v_dot2_f32_bf16 v37, v242, s79, v37
    v_dot2_f32_bf16 v38, v243, s78, v38
    v_dot2_f32_bf16 v39, v243, s79, v39
    s_add_u32 s60, s75, s73
    buffer_store_dwordx4 v[76:79], v18, s[44:47], s60 offen sc1
    s_waitcnt vmcnt(15)
    v_dot2_f32_bf16 v32, v244, s78, v32
    v_dot2_f32_bf16 v33, v244, s79, v33
    v_dot2_f32_bf16 v34, v245, s78, v34
    v_dot2_f32_bf16 v35, v245, s79, v35
    v_dot2_f32_bf16 v36, v246, s78, v36
    v_dot2_f32_bf16 v37, v246, s79, v37
    v_dot2_f32_bf16 v38, v247, s78, v38
    v_dot2_f32_bf16 v39, v247, s79, v39
    s_waitcnt vmcnt(14)
    s_nop 0
    v_dot2_f32_bf16 v32, v248, s78, v32
    v_dot2_f32_bf16 v33, v248, s79, v33
    v_dot2_f32_bf16 v34, v249, s78, v34
    v_dot2_f32_bf16 v35, v249, s79, v35
    v_dot2_f32_bf16 v36, v250, s78, v36
    v_dot2_f32_bf16 v37, v250, s79, v37
    v_dot2_f32_bf16 v38, v251, s78, v38
    v_dot2_f32_bf16 v39, v251, s79, v39
    s_waitcnt vmcnt(13)
    s_nop 0
    v_dot2_f32_bf16 v32, v252, s78, v32
    v_dot2_f32_bf16 v33, v252, s79, v33
    v_dot2_f32_bf16 v34, v253, s78, v34
    v_dot2_f32_bf16 v35, v253, s79, v35
    v_dot2_f32_bf16 v36, v254, s78, v36
    v_dot2_f32_bf16 v37, v254, s79, v37
    v_dot2_f32_bf16 v38, v255, s78, v38
    v_dot2_f32_bf16 v39, v255, s79, v39
    v_cvt_pk_bf16_f32 v48, v32, v33
    v_cvt_pk_bf16_f32 v49, v34, v35
    v_cvt_pk_bf16_f32 v50, v36, v37
    v_cvt_pk_bf16_f32 v51, v38, v39
    ds_write_b64 v105, v[48:49] offset:0
    ds_write_b64 v105, v[50:51] offset:512
    s_waitcnt vmcnt(9)
    v_pk_add_f32 v[40:41], v[96:97], v[98:99]
    s_waitcnt vmcnt(5)
    v_pk_add_f32 v[44:45], v[100:101], v[102:103]
    v_pk_add_f32 v[40:41], v[40:41], v[44:45]
    v_add_f32 v40, v40, v41
    v_mov_b32 v41, v40
    s_nop 1
    v_permlane32_swap_b32 v40, v41
    v_add_f32_e64 v40, v40, v41
    v_cvt_pk_bf16_f32 v40, v40, v40
    ds_write_b16 v107, v40 offset:4096
    s_waitcnt vmcnt(4)
    v_cmp_gt_u32 vcc, 1, v17
    s_nop 0
    s_and_b32 vcc_lo, vcc_lo, 0xff00
    s_cbranch_scc1 L_q_retry2
L_q_back2:
    s_xor_b32 s92, s67, 0
    s_add_u32 s92, s92, s64
    buffer_load_dwordx4 v[192:195], v6, s[44:47], s92 offen sc1
    s_xor_b32 s93, s67, 16384
    s_add_u32 s93, s93, s64
    s_nop 0
    buffer_load_dwordx4 v[196:199], v6, s[44:47], s93 offen sc1
    buffer_load_dwordx4 v[200:203], v7, s[44:47], s92 offen sc1
    buffer_load_dwordx4 v[204:207], v7, s[44:47], s93 offen sc1
    buffer_load_dwordx4 v[208:211], v12, s[44:47], s92 offen sc1
    buffer_load_dwordx4 v[212:215], v12, s[44:47], s93 offen sc1
    buffer_load_dwordx4 v[216:219], v4, s[44:47], s92 offen sc1
    buffer_load_dwordx4 v[220:223], v4, s[44:47], s93 offen sc1
    s_waitcnt lgkmcnt(0)
    s_barrier
    ds_read_b128 v[120:123], v108 offset:0
    ds_read_b128 v[124:127], v108 offset:16
    ds_read_b128 v[112:115], v109 offset:4096
    ds_read_b128 v[116:119], v109 offset:4112
    s_mov_b32 s82, s75
    s_mov_b32 s78, -1
    s_mov_b32 s79, 0
    s_mov_b32 s80, 0x11111111
    s_mov_b32 s81, 0x22222222
    s_mov_b32 s61, 0x358637bd
    s_lshl_b32 s75, s57, 6
    s_add_u32 s75, s75, 229376
    s_waitcnt lgkmcnt(3)
    s_nop 0
    v_cndmask_b32 v96, 0, v120, s[78:79]
    v_cndmask_b32 v104, v120, 0, s[78:79]
    v_cndmask_b32 v97, 0, v121, s[78:79]
    v_cndmask_b32 v105, v121, 0, s[78:79]
    v_cndmask_b32 v98, 0, v122, s[78:79]
    v_cndmask_b32 v106, v122, 0, s[78:79]
    v_cndmask_b32 v99, 0, v123, s[78:79]
    v_cndmask_b32 v107, v123, 0, s[78:79]
    s_waitcnt lgkmcnt(2)
    s_nop 0
    v_cndmask_b32 v100, 0, v124, s[78:79]
    v_cndmask_b32 v108, v124, 0, s[78:79]
    v_cndmask_b32 v101, 0, v125, s[78:79]
    v_cndmask_b32 v109, v125, 0, s[78:79]
    v_cndmask_b32 v102, 0, v126, s[78:79]
    v_cndmask_b32 v110, v126, 0, s[78:79]
    v_cndmask_b32 v103, 0, v127, s[78:79]
    v_cndmask_b32 v111, v127, 0, s[78:79]
    s_waitcnt lgkmcnt(1)
    v_cndmask_b32 v112, 0, v112, s[80:81]
    v_cndmask_b32 v113, 0, v113, s[80:81]
    v_cndmask_b32 v114, 0, v114, s[80:81]
    v_cndmask_b32 v115, 0, v115, s[80:81]
    s_waitcnt lgkmcnt(0)
    v_cndmask_b32 v116, 0, v116, s[80:81]
    v_cndmask_b32 v117, 0, v117, s[80:81]
    v_cndmask_b32 v118, 0, v118, s[80:81]
    v_cndmask_b32 v119, 0, v119, s[80:81]
    v_mfma_f32_16x16x32_bf16 v[164:167], v[96:99], v[128:131], 0
    s_xor_b32 s92, s67, 32768
    s_add_u32 s92, s92, s64
    buffer_load_dwordx4 v[224:227], v6, s[44:47], s92 offen sc1
    v_mfma_f32_16x16x32_bf16 v[164:167], v[100:103], v[144:147], v[164:167]
    v_mfma_f32_16x16x32_bf16 v[168:171], v[104:107], v[128:131], 0
    s_xor_b32 s93, s67, 49152
    v_mfma_f32_16x16x32_bf16 v[168:171], v[108:111], v[144:147], v[168:171]
    s_add_u32 s93, s93, s64
    buffer_load_dwordx4 v[228:231], v6, s[44:47], s93 offen sc1
    v_mfma_f32_16x16x32_bf16 v[160:163], v[112:115], v[128:131], 0
    v_mfma_f32_16x16x32_bf16 v[160:163], v[116:119], v[144:147], v[160:163]
    v_mfma_f32_16x16x32_bf16 v[176:179], v[96:99], v[132:135], 0
    buffer_load_dwordx4 v[232:235], v7, s[44:47], s92 offen sc1
    v_mfma_f32_16x16x32_bf16 v[176:179], v[100:103], v[148:151], v[176:179]
    v_mfma_f32_16x16x32_bf16 v[180:183], v[104:107], v[132:135], 0
    v_mfma_f32_16x16x32_bf16 v[180:183], v[108:111], v[148:151], v[180:183]
    buffer_load_dwordx4 v[236:239], v7, s[44:47], s93 offen sc1
    s_nop 1
    v_add_f32 v160, s61, v160
    v_add_f32_e64 v161, s61, v161
    v_mfma_f32_16x16x32_bf16 v[172:175], v[112:115], v[132:135], 0
    v_rcp_f32 v160, v160
    v_rcp_f32 v161, v161
    v_mfma_f32_16x16x32_bf16 v[172:175], v[116:119], v[148:151], v[172:175]
    v_mul_f32 v164, v164, v160
    v_mul_f32 v165, v165, v160
    v_mul_f32 v166, v166, v160
    v_mul_f32 v167, v167, v160
    v_mfma_f32_16x16x32_bf16 v[36:39], v[96:99], v[136:139], 0
    buffer_load_dwordx4 v[240:243], v12, s[44:47], s92 offen sc1
    v_mul_f32 v168, v168, v161
    v_mul_f32 v169, v169, v161
    v_mfma_f32_16x16x32_bf16 v[36:39], v[100:103], v[152:155], v[36:39]
    v_mul_f32 v170, v170, v161
    v_mul_f32 v171, v171, v161
    v_cvt_pk_bf16_f32 v160, v164, v165
    v_cvt_pk_bf16_f32 v161, v166, v167
    v_mfma_f32_16x16x32_bf16 v[40:43], v[104:107], v[136:139], 0
    v_cvt_pk_bf16_f32 v162, v168, v169
    v_cvt_pk_bf16_f32 v163, v170, v171
    v_mfma_f32_16x16x32_bf16 v[40:43], v[108:111], v[152:155], v[40:43]
    buffer_load_dwordx4 v[244:247], v12, s[44:47], s93 offen sc1
    v_add_f32 v172, s61, v172
    v_add_f32 v173, s61, v173
    v_mfma_f32_16x16x32_bf16 v[32:35], v[112:115], v[136:139], 0
    v_rcp_f32 v172, v172
    v_rcp_f32 v173, v173
    v_mfma_f32_16x16x32_bf16 v[32:35], v[116:119], v[152:155], v[32:35]
    v_mul_f32 v176, v176, v172
    v_mul_f32 v177, v177, v172
    v_mul_f32 v178, v178, v172
    v_mul_f32 v179, v179, v172
    buffer_load_dword v17, v3, s[48:51], s90 offen sc1
    v_mfma_f32_16x16x32_bf16 v[48:51], v[96:99], v[140:143], 0
    buffer_load_dwordx4 v[248:251], v4, s[44:47], s92 offen sc1
    v_mul_f32 v180, v180, v173
    v_mul_f32 v181, v181, v173
    v_mfma_f32_16x16x32_bf16 v[48:51], v[100:103], v[156:159], v[48:51]
    v_mul_f32 v182, v182, v173
    v_mul_f32 v183, v183, v173
    v_cvt_pk_bf16_f32 v172, v176, v177
    v_cvt_pk_bf16_f32 v173, v178, v179
    v_mfma_f32_16x16x32_bf16 v[52:55], v[104:107], v[140:143], 0
    v_cvt_pk_bf16_f32 v174, v180, v181
    v_cvt_pk_bf16_f32 v175, v182, v183
    v_mfma_f32_16x16x32_bf16 v[52:55], v[108:111], v[156:159], v[52:55]
    buffer_load_dwordx4 v[252:255], v4, s[44:47], s93 offen sc1
    v_add_f32 v32, s61, v32
    v_add_f32 v33, s61, v33
    v_mfma_f32_16x16x32_bf16 v[44:47], v[112:115], v[140:143], 0
    v_rcp_f32 v32, v32
    v_rcp_f32 v33, v33
    v_mfma_f32_16x16x32_bf16 v[44:47], v[116:119], v[156:159], v[44:47]
    v_mul_f32 v36, v36, v32
    v_mul_f32 v37, v37, v32
    v_mul_f32 v38, v38, v32
    v_mul_f32 v39, v39, v32
    s_add_u32 s60, s75, s70
    buffer_store_dwordx4 v[160:163], v18, s[44:47], s60 offen sc1
    v_mul_f32 v40, v40, v33
    v_mul_f32 v41, v41, v33
    v_mul_f32 v42, v42, v33
    v_mul_f32_e64 v43, v43, v33
    v_cvt_pk_bf16_f32 v32, v36, v37
    v_cvt_pk_bf16_f32 v33, v38, v39
    v_cvt_pk_bf16_f32 v34, v40, v41
    v_cvt_pk_bf16_f32 v35, v42, v43
    v_add_f32 v44, s61, v44
    v_add_f32 v45, s61, v45
    v_rcp_f32 v44, v44
    v_rcp_f32 v45, v45
    v_mul_f32 v48, v48, v44
    s_add_u32 s60, s75, s71
    buffer_store_dwordx4 v[172:175], v18, s[44:47], s60 offen sc1
    v_mul_f32 v49, v49, v44
    v_mul_f32 v50, v50, v44
    v_mul_f32 v51, v51, v44
    v_mul_f32 v52, v52, v45
    v_mul_f32 v53, v53, v45
    v_mul_f32 v54, v54, v45
    v_mul_f32_e64 v55, v55, v45
    v_cvt_pk_bf16_f32 v44, v48, v49
    v_cvt_pk_bf16_f32 v45, v50, v51
    v_cvt_pk_bf16_f32 v46, v52, v53
    v_cvt_pk_bf16_f32 v47, v54, v55
    s_add_u32 s60, s75, s72
    buffer_store_dwordx4 v[32:35], v18, s[44:47], s60 offen sc1
    s_add_u32 s60, s75, s73
    buffer_store_dwordx4 v[44:47], v18, s[44:47], s60 offen sc1
    s_waitcnt vmcnt(20)
    v_mfma_f32_16x16x32_bf16 v[80:83], a[0:3], v[192:195], 0
    s_add_u32 m0, s56, 114688
    s_xor_b32 s59, s6, 131072
    buffer_load_dwordx4 v16, s[28:31], s59 offen lds
    s_waitcnt vmcnt(20)
    v_mfma_f32_16x16x32_bf16 v[80:83], a[16:19], v[196:199], v[80:83]
    s_movk_i32 s60, 144
    v_lshrrev_b32 v14, 3, v1
    v_and_b32_e64 v15, 7, v1
    v_mfma_f32_16x16x32_bf16 v[84:87], a[4:7], v[192:195], 0
    s_add_u32 s61, s56, 65536
    v_lshlrev_b32_e64 v15, 4, v15
    v_lshl_add_u32 v8, v14, 10, v15
    v_mfma_f32_16x16x32_bf16 v[84:87], a[20:23], v[196:199], v[84:87]
    v_mad_u32_u24 v56, v14, s60, v15
    v_add_u32_e64 v56, s61, v56
    v_mfma_f32_16x16x32_bf16 v[88:91], a[8:11], v[192:195], 0
    buffer_load_dwordx4 v19, s[28:31], s59 offen offset:1024 lds
    v_mfma_f32_16x16x32_bf16 v[88:91], a[24:27], v[196:199], v[88:91]
    v_and_b32 v14, 15, v1
    v_lshrrev_b32 v15, 4, v1
    v_mfma_f32_16x16x32_bf16 v[92:95], a[12:15], v[192:195], 0
    v_lshlrev_b32_e64 v15, 3, v15
    v_mad_u32_u24 v57, v14, s60, v15
    v_mfma_f32_16x16x32_bf16 v[92:95], a[28:31], v[196:199], v[92:95]
    s_waitcnt vmcnt(20)
    v_add_u32 v57, s61, v57
    v_lshl_add_u32 v58, v14, 7, v15
    v_mfma_f32_16x16x32_bf16 v[96:99], a[0:3], v[200:203], 0
    s_add_u32 m0, s56, 116736
    s_xor_b32 s59, s6, 147456
    buffer_load_dwordx4 v16, s[28:31], s59 offen lds
    s_waitcnt vmcnt(20)
    v_mfma_f32_16x16x32_bf16 v[96:99], a[16:19], v[204:207], v[96:99]
    v_add_u32 v58, s56, v58
    v_add_u32 v58, 49152, v58
    v_mfma_f32_16x16x32_bf16 v[100:103], a[4:7], v[200:203], 0
    v_add_u32_e64 v9, s56, v2
    v_xor_b32 v10, 4096, v9
    v_mfma_f32_16x16x32_bf16 v[100:103], a[20:23], v[204:207], v[100:103]
    v_xor_b32 v11, 8192, v9
    v_xor_b32 v13, 12288, v9
    v_mfma_f32_16x16x32_bf16 v[104:107], a[8:11], v[200:203], 0
    buffer_load_dwordx4 v19, s[28:31], s59 offen offset:1024 lds
    v_mfma_f32_16x16x32_bf16 v[104:107], a[24:27], v[204:207], v[104:107]
    v_mfma_f32_16x16x32_bf16 v[108:111], a[12:15], v[200:203], 0
    v_mfma_f32_16x16x32_bf16 v[108:111], a[28:31], v[204:207], v[108:111]
    s_waitcnt vmcnt(20)
    v_mfma_f32_16x16x32_bf16 v[112:115], a[0:3], v[208:211], 0
    s_add_u32 m0, s56, 81920
    s_xor_b32 s59, s6, 1179648
    buffer_load_dwordx4 v16, s[24:27], s59 offen lds
    s_waitcnt vmcnt(20)
    v_mfma_f32_16x16x32_bf16 v[112:115], a[16:19], v[212:215], v[112:115]
    v_mfma_f32_16x16x32_bf16 v[116:119], a[4:7], v[208:211], 0
    v_mfma_f32_16x16x32_bf16 v[116:119], a[20:23], v[212:215], v[116:119]
    v_mfma_f32_16x16x32_bf16 v[120:123], a[8:11], v[208:211], 0
    buffer_load_dwordx4 v19, s[24:27], s59 offen offset:1024 lds
    v_mfma_f32_16x16x32_bf16 v[120:123], a[24:27], v[212:215], v[120:123]
    v_mfma_f32_16x16x32_bf16 v[124:127], a[12:15], v[208:211], 0
    v_mfma_f32_16x16x32_bf16 v[124:127], a[28:31], v[212:215], v[124:127]
    s_waitcnt vmcnt(20)
    v_mfma_f32_16x16x32_bf16 v[64:67], a[0:3], v[216:219], 0
    s_add_u32 m0, s56, 83968
    s_xor_b32 s59, s6, 1196032
    buffer_load_dwordx4 v16, s[24:27], s59 offen lds
    s_waitcnt vmcnt(20)
    v_mfma_f32_16x16x32_bf16 v[64:67], a[16:19], v[220:223], v[64:67]
    v_mfma_f32_16x16x32_bf16 v[68:71], a[4:7], v[216:219], 0
    v_mfma_f32_16x16x32_bf16 v[68:71], a[20:23], v[220:223], v[68:71]
    v_mfma_f32_16x16x32_bf16 v[72:75], a[8:11], v[216:219], 0
    buffer_load_dwordx4 v19, s[24:27], s59 offen offset:1024 lds
    v_mfma_f32_16x16x32_bf16 v[72:75], a[24:27], v[220:223], v[72:75]
    v_mfma_f32_16x16x32_bf16 v[76:79], a[12:15], v[216:219], 0
    v_mfma_f32_16x16x32_bf16 v[76:79], a[28:31], v[220:223], v[76:79]
    s_waitcnt vmcnt(8)
    s_barrier
    buffer_store_dword v59, v5, s[48:51], s84 offen sc1
    v_mfma_f32_16x16x32_bf16 v[80:83], a[128:131], v[224:227], v[80:83]
    v_cmp_gt_u32 vcc, 1, v17
    s_nop 0
    s_and_b32 vcc_lo, vcc_lo, 0xff
    s_cbranch_scc1 L_q_retry3
L_q_back3:
    s_xor_b32 s92, s67, 65536
    s_add_u32 s92, s92, s64
    buffer_load_dwordx4 v[128:131], v6, s[44:47], s92 offen sc1
    v_mfma_f32_16x16x32_bf16 v[80:83], a[144:147], v[228:231], v[80:83]
    s_xor_b32 s93, s67, 81920
    s_add_u32 s93, s93, s64
    buffer_load_dwordx4 v[132:135], v6, s[44:47], s93 offen sc1
    v_mfma_f32_16x16x32_bf16 v[84:87], a[132:135], v[224:227], v[84:87]
    buffer_load_dwordx4 v[136:139], v7, s[44:47], s92 offen sc1
    v_mfma_f32_16x16x32_bf16 v[84:87], a[148:151], v[228:231], v[84:87]
    v_mfma_f32_16x16x32_bf16 v[88:91], a[136:139], v[224:227], v[88:91]
    buffer_load_dwordx4 v[140:143], v7, s[44:47], s93 offen sc1
    v_mfma_f32_16x16x32_bf16 v[88:91], a[152:155], v[228:231], v[88:91]
    buffer_load_dwordx4 v[144:147], v12, s[44:47], s92 offen sc1
    v_mfma_f32_16x16x32_bf16 v[92:95], a[140:143], v[224:227], v[92:95]
    buffer_load_dwordx4 v[148:151], v12, s[44:47], s93 offen sc1
    v_mfma_f32_16x16x32_bf16 v[92:95], a[156:159], v[228:231], v[92:95]
    s_waitcnt vmcnt(11)
    s_barrier
    v_mfma_f32_16x16x32_bf16 v[96:99], a[128:131], v[232:235], v[96:99]
    buffer_load_dwordx4 v[152:155], v4, s[44:47], s92 offen sc1
    v_mfma_f32_16x16x32_bf16 v[96:99], a[144:147], v[236:239], v[96:99]
    buffer_load_dwordx4 v[156:159], v4, s[44:47], s93 offen sc1
    s_xor_b32 s92, s67, 98304
    s_add_u32 s92, s92, s64
    buffer_load_dwordx4 v[160:163], v6, s[44:47], s92 offen sc1
    v_mfma_f32_16x16x32_bf16 v[100:103], a[132:135], v[232:235], v[100:103]
    s_xor_b32 s93, s67, 114688
    s_add_u32 s93, s93, s64
    buffer_load_dwordx4 v[164:167], v6, s[44:47], s93 offen sc1
    s_waitcnt vmcnt(11)
    ds_read_b64_tr_b16 a[80:81], v24 offset:16384
    v_mfma_f32_16x16x32_bf16 v[100:103], a[148:151], v[236:239], v[100:103]
    ds_read_b64_tr_b16 a[82:83], v24 offset:18432
    ds_read_b64_tr_b16 a[84:85], v25 offset:16384
    v_mfma_f32_16x16x32_bf16 v[104:107], a[136:139], v[232:235], v[104:107]
    ds_read_b64_tr_b16 a[86:87], v25 offset:18432
    v_mfma_f32_16x16x32_bf16 v[104:107], a[152:155], v[236:239], v[104:107]
    ds_read_b64_tr_b16 a[88:89], v26 offset:16384
    ds_read_b64_tr_b16 a[90:91], v26 offset:18432
    v_mfma_f32_16x16x32_bf16 v[108:111], a[140:143], v[232:235], v[108:111]
    ds_read_b64_tr_b16 a[92:93], v27 offset:16384
    ds_read_b64_tr_b16 a[94:95], v27 offset:18432
    v_mfma_f32_16x16x32_bf16 v[108:111], a[156:159], v[236:239], v[108:111]
    s_add_u32 m0, s56, 0
    s_xor_b32 s59, s6, 1310720
    buffer_load_dwordx4 v16, s[24:27], s59 offen lds
    buffer_load_dwordx4 v19, s[24:27], s59 offen offset:1024 lds
    v_mfma_f32_16x16x32_bf16 v[112:115], a[128:131], v[240:243], v[112:115]
    buffer_load_dwordx4 v[168:171], v7, s[44:47], s92 offen sc1
    ds_read_b64_tr_b16 a[224:225], v28 offset:0
    v_mfma_f32_16x16x32_bf16 v[112:115], a[144:147], v[244:247], v[112:115]
    ds_read_b64_tr_b16 a[226:227], v28 offset:2048
    ds_read_b64_tr_b16 a[228:229], v29 offset:0
    v_mfma_f32_16x16x32_bf16 v[116:119], a[132:135], v[240:243], v[116:119]
    buffer_load_dwordx4 v[172:175], v7, s[44:47], s93 offen sc1
    ds_read_b64_tr_b16 a[230:231], v29 offset:2048
    v_mfma_f32_16x16x32_bf16 v[116:119], a[148:151], v[244:247], v[116:119]
    s_add_u32 m0, s56, 2048
    ds_read_b64_tr_b16 a[232:233], v30 offset:0
    ds_read_b64_tr_b16 a[234:235], v30 offset:2048
    v_mfma_f32_16x16x32_bf16 v[120:123], a[136:139], v[240:243], v[120:123]
    s_xor_b32 s59, s6, 1327104
    buffer_load_dwordx4 v16, s[24:27], s59 offen lds
    ds_read_b64_tr_b16 a[236:237], v31 offset:0
    v_mfma_f32_16x16x32_bf16 v[120:123], a[152:155], v[244:247], v[120:123]
    ds_read_b64_tr_b16 a[238:239], v31 offset:2048
    ds_read_b64_tr_b16 a[240:241], v28 offset:4096
    v_mfma_f32_16x16x32_bf16 v[124:127], a[140:143], v[240:243], v[124:127]
    buffer_load_dwordx4 v19, s[24:27], s59 offen offset:1024 lds
    ds_read_b64_tr_b16 a[242:243], v28 offset:6144
    v_mfma_f32_16x16x32_bf16 v[124:127], a[156:159], v[244:247], v[124:127]
    ds_read_b64_tr_b16 a[244:245], v29 offset:4096
    ds_read_b64_tr_b16 a[246:247], v29 offset:6144
    v_mfma_f32_16x16x32_bf16 v[64:67], a[128:131], v[248:251], v[64:67]
    buffer_load_dword v17, v3, s[48:51], s90 offen sc1
    ds_read_b64_tr_b16 a[248:249], v30 offset:4096
    v_mfma_f32_16x16x32_bf16 v[64:67], a[144:147], v[252:255], v[64:67]
    buffer_load_dwordx4 v[176:179], v12, s[44:47], s92 offen sc1
    ds_read_b64_tr_b16 a[250:251], v30 offset:6144
    v_mfma_f32_16x16x32_bf16 v[68:71], a[132:135], v[248:251], v[68:71]
    ds_read_b64_tr_b16 a[252:253], v31 offset:4096
    ds_read_b64_tr_b16 a[254:255], v31 offset:6144
    v_mfma_f32_16x16x32_bf16 v[68:71], a[148:151], v[252:255], v[68:71]
    buffer_load_dwordx4 v[180:183], v12, s[44:47], s93 offen sc1
    ds_read_b64_tr_b16 a[0:1], v28 offset:8192
    v_mfma_f32_16x16x32_bf16 v[72:75], a[136:139], v[248:251], v[72:75]
    s_add_u32 m0, s56, 65536
    s_xor_b32 s59, s6, 1441792
    buffer_load_dwordx4 v16, s[24:27], s59 offen lds
    ds_read_b64_tr_b16 a[2:3], v28 offset:10240
    v_mfma_f32_16x16x32_bf16 v[72:75], a[152:155], v[252:255], v[72:75]
    ds_read_b64_tr_b16 a[4:5], v29 offset:8192
    ds_read_b64_tr_b16 a[6:7], v29 offset:10240
    v_mfma_f32_16x16x32_bf16 v[76:79], a[140:143], v[248:251], v[76:79]
    buffer_load_dwordx4 v19, s[24:27], s59 offen offset:1024 lds
    ds_read_b64_tr_b16 a[8:9], v30 offset:8192
    v_mfma_f32_16x16x32_bf16 v[76:79], a[156:159], v[252:255], v[76:79]
    s_waitcnt vmcnt(20)
    ds_read_b64_tr_b16 a[10:11], v30 offset:10240
    ds_read_b64_tr_b16 a[12:13], v31 offset:8192
    v_mfma_f32_16x16x32_bf16 v[80:83], a[32:35], v[128:131], v[80:83]
    s_waitcnt vmcnt(19)
    buffer_load_dwordx4 v[184:187], v4, s[44:47], s92 offen sc1
    ds_read_b64_tr_b16 a[14:15], v31 offset:10240
    v_mfma_f32_16x16x32_bf16 v[80:83], a[48:51], v[132:135], v[80:83]
    ds_read_b64_tr_b16 a[16:17], v28 offset:12288
    ds_read_b64_tr_b16 a[18:19], v28 offset:14336
    v_mfma_f32_16x16x32_bf16 v[84:87], a[36:39], v[128:131], v[84:87]
    buffer_load_dwordx4 v[188:191], v4, s[44:47], s93 offen sc1
    ds_read_b64_tr_b16 a[20:21], v29 offset:12288
    v_mfma_f32_16x16x32_bf16 v[84:87], a[52:55], v[132:135], v[84:87]
    s_add_u32 m0, s56, 67584
    ds_read_b64_tr_b16 a[22:23], v29 offset:14336
    ds_read_b64_tr_b16 a[24:25], v30 offset:12288
    v_mfma_f32_16x16x32_bf16 v[88:91], a[40:43], v[128:131], v[88:91]
    s_xor_b32 s59, s6, 1458176
    buffer_load_dwordx4 v16, s[24:27], s59 offen lds
    ds_read_b64_tr_b16 a[26:27], v30 offset:14336
    v_mfma_f32_16x16x32_bf16 v[88:91], a[56:59], v[132:135], v[88:91]
    ds_read_b64_tr_b16 a[28:29], v31 offset:12288
    ds_read_b64_tr_b16 a[30:31], v31 offset:14336
    v_mfma_f32_16x16x32_bf16 v[92:95], a[44:47], v[128:131], v[92:95]
    buffer_load_dwordx4 v19, s[24:27], s59 offen offset:1024 lds
    ds_read_b64_tr_b16 a[128:129], v28 offset:16384
    v_mfma_f32_16x16x32_bf16 v[92:95], a[60:63], v[132:135], v[92:95]
    s_waitcnt vmcnt(22)
    ds_read_b64_tr_b16 a[130:131], v28 offset:18432
    ds_read_b64_tr_b16 a[132:133], v29 offset:16384
    v_mfma_f32_16x16x32_bf16 v[96:99], a[32:35], v[136:139], v[96:99]
    s_waitcnt vmcnt(8)
    v_cmp_gt_u32 vcc, 2, v17
    s_nop 0
    s_and_b32 vcc_lo, vcc_lo, 0xff00
    s_cbranch_scc1 L_q_retry4
L_q_back4:
    s_xor_b32 s92, s65, 131072
    s_add_u32 s92, s92, s64
    buffer_load_dwordx4 v[192:195], v6, s[44:47], s92 offen sc1
    v_mfma_f32_16x16x32_bf16 v[96:99], a[48:51], v[140:143], v[96:99]
    ds_read_b64_tr_b16 a[192:193], v20 offset:0
    ds_read_b64_tr_b16 a[194:195], v20 offset:2048
    v_mfma_f32_16x16x32_bf16 v[100:103], a[36:39], v[136:139], v[100:103]
    ds_read_b64_tr_b16 a[196:197], v21 offset:0
    v_mfma_f32_16x16x32_bf16 v[100:103], a[52:55], v[140:143], v[100:103]
    ds_read_b64_tr_b16 a[198:199], v21 offset:2048
    ds_read_b64_tr_b16 a[200:201], v22 offset:0
    v_mfma_f32_16x16x32_bf16 v[104:107], a[40:43], v[136:139], v[104:107]
    ds_read_b64_tr_b16 a[202:203], v22 offset:2048
    v_mfma_f32_16x16x32_bf16 v[104:107], a[56:59], v[140:143], v[104:107]
    ds_read_b64_tr_b16 a[204:205], v23 offset:0
    ds_read_b64_tr_b16 a[206:207], v23 offset:2048
    v_mfma_f32_16x16x32_bf16 v[108:111], a[44:47], v[136:139], v[108:111]
    s_xor_b32 s93, s65, 147456
    s_add_u32 s93, s93, s64
    buffer_load_dwordx4 v[196:199], v6, s[44:47], s93 offen sc1
    v_mfma_f32_16x16x32_bf16 v[108:111], a[60:63], v[140:143], v[108:111]
    s_add_u32 m0, s56, 16384
    s_xor_b32 s59, s7, 1572864
    buffer_load_dwordx4 v16, s[24:27], s59 offen lds
    buffer_load_dwordx4 v19, s[24:27], s59 offen offset:1024 lds
    v_mfma_f32_16x16x32_bf16 v[112:115], a[32:35], v[144:147], v[112:115]
    buffer_load_dwordx4 v[200:203], v7, s[44:47], s92 offen sc1
    ds_read_b64_tr_b16 a[134:135], v29 offset:18432
    v_mfma_f32_16x16x32_bf16 v[112:115], a[48:51], v[148:151], v[112:115]
    ds_read_b64_tr_b16 a[136:137], v30 offset:16384
    ds_read_b64_tr_b16 a[138:139], v30 offset:18432
    v_mfma_f32_16x16x32_bf16 v[116:119], a[36:39], v[144:147], v[116:119]
    buffer_load_dwordx4 v[204:207], v7, s[44:47], s93 offen sc1
    ds_read_b64_tr_b16 a[140:141], v31 offset:16384
    v_mfma_f32_16x16x32_bf16 v[116:119], a[52:55], v[148:151], v[116:119]
    s_add_u32 m0, s56, 18432
    ds_read_b64_tr_b16 a[142:143], v31 offset:18432
    ds_read_b64_tr_b16 a[144:145], v28 offset:20480
    v_mfma_f32_16x16x32_bf16 v[120:123], a[40:43], v[144:147], v[120:123]
    s_xor_b32 s59, s7, 1589248
    buffer_load_dwordx4 v16, s[24:27], s59 offen lds
    ds_read_b64_tr_b16 a[146:147], v28 offset:22528
    v_mfma_f32_16x16x32_bf16 v[120:123], a[56:59], v[148:151], v[120:123]
    ds_read_b64_tr_b16 a[148:149], v29 offset:20480
    ds_read_b64_tr_b16 a[150:151], v29 offset:22528
    v_mfma_f32_16x16x32_bf16 v[124:127], a[44:47], v[144:147], v[124:127]
    buffer_load_dwordx4 v19, s[24:27], s59 offen offset:1024 lds
    ds_read_b64_tr_b16 a[152:153], v30 offset:20480
    v_mfma_f32_16x16x32_bf16 v[124:127], a[60:63], v[148:151], v[124:127]
    ds_read_b64_tr_b16 a[154:155], v30 offset:22528
    ds_read_b64_tr_b16 a[156:157], v31 offset:20480
    v_mfma_f32_16x16x32_bf16 v[64:67], a[32:35], v[152:155], v[64:67]
    buffer_load_dwordx4 v[208:211], v12, s[44:47], s92 offen sc1
    v_mfma_f32_16x16x32_bf16 v[64:67], a[48:51], v[156:159], v[64:67]
    s_waitcnt vmcnt(9)
    buffer_load_dwordx4 v[212:215], v12, s[44:47], s93 offen sc1
    ds_read_b64_tr_b16 a[208:209], v24 offset:0
    v_mfma_f32_16x16x32_bf16 v[68:71], a[36:39], v[152:155], v[68:71]
    ds_read_b64_tr_b16 a[210:211], v24 offset:2048
    v_mfma_f32_16x16x32_bf16 v[68:71], a[52:55], v[156:159], v[68:71]
    ds_read_b64_tr_b16 a[212:213], v25 offset:0
    ds_read_b64_tr_b16 a[214:215], v25 offset:2048
    v_mfma_f32_16x16x32_bf16 v[72:75], a[40:43], v[152:155], v[72:75]
    ds_read_b64_tr_b16 a[216:217], v26 offset:0
    v_mfma_f32_16x16x32_bf16 v[72:75], a[56:59], v[156:159], v[72:75]
    ds_read_b64_tr_b16 a[218:219], v26 offset:2048
    ds_read_b64_tr_b16 a[220:221], v27 offset:0
    v_mfma_f32_16x16x32_bf16 v[76:79], a[44:47], v[152:155], v[76:79]
    ds_read_b64_tr_b16 a[222:223], v27 offset:2048
    v_mfma_f32_16x16x32_bf16 v[76:79], a[60:63], v[156:159], v[76:79]
    s_add_u32 m0, s56, 32768
    s_xor_b32 s59, s7, 1703936
    buffer_load_dwordx4 v16, s[24:27], s59 offen lds
    buffer_load_dwordx4 v19, s[24:27], s59 offen offset:1024 lds
    v_mfma_f32_16x16x32_bf16 v[80:83], a[160:163], v[160:163], v[80:83]
    buffer_load_dword v17, v3, s[48:51], s90 offen sc1
    ds_read_b64_tr_b16 a[158:159], v31 offset:22528
    v_mfma_f32_16x16x32_bf16 v[80:83], a[176:179], v[164:167], v[80:83]
    buffer_load_dwordx4 v[216:219], v4, s[44:47], s92 offen sc1
    ds_read_b64_tr_b16 a[32:33], v28 offset:24576
    v_mfma_f32_16x16x32_bf16 v[84:87], a[164:167], v[160:163], v[84:87]
    ds_read_b64_tr_b16 a[34:35], v28 offset:26624
    ds_read_b64_tr_b16 a[36:37], v29 offset:24576
    v_mfma_f32_16x16x32_bf16 v[84:87], a[180:183], v[164:167], v[84:87]
    s_add_u32 m0, s56, 34816
    buffer_load_dwordx4 v[220:223], v4, s[44:47], s93 offen sc1
    ds_read_b64_tr_b16 a[38:39], v29 offset:26624
    v_mfma_f32_16x16x32_bf16 v[88:91], a[168:171], v[160:163], v[88:91]
    s_xor_b32 s59, s7, 1720320
    buffer_load_dwordx4 v16, s[24:27], s59 offen lds
    ds_read_b64_tr_b16 a[40:41], v30 offset:24576
    v_mfma_f32_16x16x32_bf16 v[88:91], a[184:187], v[164:167], v[88:91]
    ds_read_b64_tr_b16 a[42:43], v30 offset:26624
    ds_read_b64_tr_b16 a[44:45], v31 offset:24576
    v_mfma_f32_16x16x32_bf16 v[92:95], a[172:175], v[160:163], v[92:95]
    buffer_load_dwordx4 v19, s[24:27], s59 offen offset:1024 lds
    ds_read_b64_tr_b16 a[46:47], v31 offset:26624
    v_mfma_f32_16x16x32_bf16 v[92:95], a[188:191], v[164:167], v[92:95]
    ds_read_b64_tr_b16 a[48:49], v28 offset:28672
    ds_read_b64_tr_b16 a[50:51], v28 offset:30720
    v_mfma_f32_16x16x32_bf16 v[96:99], a[160:163], v[168:171], v[96:99]
    s_xor_b32 s92, s65, 163840
    s_add_u32 s92, s92, s64
    buffer_load_dwordx4 v[224:227], v6, s[44:47], s92 offen sc1
    v_mfma_f32_16x16x32_bf16 v[96:99], a[176:179], v[172:175], v[96:99]
    s_waitcnt vmcnt(10)
    ds_read_b64_tr_b16 a[96:97], v20 offset:16384
    ds_read_b64_tr_b16 a[98:99], v20 offset:18432
    v_mfma_f32_16x16x32_bf16 v[100:103], a[164:167], v[168:171], v[100:103]
    ds_read_b64_tr_b16 a[100:101], v21 offset:16384
    v_mfma_f32_16x16x32_bf16 v[100:103], a[180:183], v[172:175], v[100:103]
    ds_read_b64_tr_b16 a[102:103], v21 offset:18432
    ds_read_b64_tr_b16 a[104:105], v22 offset:16384
    v_mfma_f32_16x16x32_bf16 v[104:107], a[168:171], v[168:171], v[104:107]
    ds_read_b64_tr_b16 a[106:107], v22 offset:18432
    v_mfma_f32_16x16x32_bf16 v[104:107], a[184:187], v[172:175], v[104:107]
    ds_read_b64_tr_b16 a[108:109], v23 offset:16384
    ds_read_b64_tr_b16 a[110:111], v23 offset:18432
    v_mfma_f32_16x16x32_bf16 v[108:111], a[172:175], v[168:171], v[108:111]
    s_xor_b32 s93, s65, 180224
    s_add_u32 s93, s93, s64
    buffer_load_dwordx4 v[228:231], v6, s[44:47], s93 offen sc1
    v_mfma_f32_16x16x32_bf16 v[108:111], a[188:191], v[172:175], v[108:111]
    s_add_u32 m0, s56, 49152
    s_nop 0
    buffer_load_dwordx4 v8, s[8:11], s91 offen lds
    s_add_u32 s59, s91, 7168
    buffer_load_dwordx4 v8, s[8:11], s59 offen offset:1024 lds
    v_mfma_f32_16x16x32_bf16 v[112:115], a[160:163], v[176:179], v[112:115]
    s_waitcnt vmcnt(8)
    v_cmp_gt_u32 vcc, 2, v17
    s_nop 0
    s_and_b32 vcc_lo, vcc_lo, 0xff
    s_cbranch_scc1 L_q_retry5
L_q_back5:
    s_xor_b32 s86, s66, 196608
    s_add_u32 s86, s86, s64
    buffer_load_dwordx4 v[232:235], v6, s[44:47], s86 offen sc1
    v_mfma_f32_16x16x32_bf16 v[112:115], a[176:179], v[180:183], v[112:115]
    ds_read_b64_tr_b16 a[52:53], v29 offset:28672
    v_mfma_f32_16x16x32_bf16 v[116:119], a[164:167], v[176:179], v[116:119]
    ds_read_b64_tr_b16 a[54:55], v29 offset:30720
    v_mfma_f32_16x16x32_bf16 v[116:119], a[180:183], v[180:183], v[116:119]
    s_xor_b32 s87, s66, 212992
    ds_read_b64_tr_b16 a[56:57], v30 offset:28672
    v_mfma_f32_16x16x32_bf16 v[120:123], a[168:171], v[176:179], v[120:123]
    s_add_u32 s87, s87, s64
    buffer_load_dwordx4 v[236:239], v6, s[44:47], s87 offen sc1
    v_mfma_f32_16x16x32_bf16 v[120:123], a[184:187], v[180:183], v[120:123]
    ds_read_b64_tr_b16 a[58:59], v30 offset:30720
    v_mfma_f32_16x16x32_bf16 v[124:127], a[172:175], v[176:179], v[124:127]
    ds_read_b64_tr_b16 a[60:61], v31 offset:28672
    v_mfma_f32_16x16x32_bf16 v[124:127], a[188:191], v[180:183], v[124:127]
    ds_read_b64_tr_b16 a[62:63], v31 offset:30720
    v_mfma_f32_16x16x32_bf16 v[64:67], a[160:163], v[184:187], v[64:67]
    buffer_load_dwordx4 v[240:243], v7, s[44:47], s92 offen sc1
    v_mfma_f32_16x16x32_bf16 v[64:67], a[176:179], v[188:191], v[64:67]
    v_mfma_f32_16x16x32_bf16 v[68:71], a[164:167], v[184:187], v[68:71]
    v_mfma_f32_16x16x32_bf16 v[68:71], a[180:183], v[188:191], v[68:71]
    v_mfma_f32_16x16x32_bf16 v[72:75], a[168:171], v[184:187], v[72:75]
    buffer_load_dwordx4 v[244:247], v7, s[44:47], s93 offen sc1
    v_mfma_f32_16x16x32_bf16 v[72:75], a[184:187], v[188:191], v[72:75]
    v_mfma_f32_16x16x32_bf16 v[76:79], a[172:175], v[184:187], v[76:79]
    v_mfma_f32_16x16x32_bf16 v[76:79], a[188:191], v[188:191], v[76:79]
    v_mfma_f32_16x16x32_bf16 v[80:83], a[64:67], v[192:195], v[80:83]
    s_waitcnt lgkmcnt(0)
    buffer_load_dwordx4 v[248:251], v7, s[44:47], s86 offen sc1
    v_mfma_f32_16x16x32_bf16 v[80:83], a[80:83], v[196:199], v[80:83]
    buffer_load_dwordx4 v[252:255], v7, s[44:47], s87 offen sc1
    v_mfma_f32_16x16x32_bf16 v[84:87], a[68:71], v[192:195], v[84:87]
    s_waitcnt vmcnt(10)
    ds_read_b64_tr_b16 a[112:113], v20 offset:32768
    v_mfma_f32_16x16x32_bf16 v[84:87], a[84:87], v[196:199], v[84:87]
    ds_read_b64_tr_b16 a[114:115], v20 offset:34816
    ds_read_b64_tr_b16 a[116:117], v21 offset:32768
    v_mfma_f32_16x16x32_bf16 v[88:91], a[72:75], v[192:195], v[88:91]
    ds_read_b64_tr_b16 a[118:119], v21 offset:34816
    v_mfma_f32_16x16x32_bf16 v[88:91], a[88:91], v[196:199], v[88:91]
    ds_read_b64_tr_b16 a[120:121], v22 offset:32768
    v_mfma_f32_16x16x32_bf16 v[92:95], a[76:79], v[192:195], v[92:95]
    ds_read_b64_tr_b16 a[122:123], v22 offset:34816
    v_mfma_f32_16x16x32_bf16 v[92:95], a[92:95], v[196:199], v[92:95]
    ds_read_b64_tr_b16 a[124:125], v23 offset:32768
    ds_read_b64_tr_b16 a[126:127], v23 offset:34816
    v_mfma_f32_16x16x32_bf16 v[96:99], a[64:67], v[200:203], v[96:99]
    buffer_load_dwordx4 v[128:131], v12, s[44:47], s92 offen sc1
    ds_read_b64_tr_b16 a[160:161], v28 offset:32768
    v_mfma_f32_16x16x32_bf16 v[96:99], a[80:83], v[204:207], v[96:99]
    ds_read_b64_tr_b16 a[162:163], v28 offset:34816
    ds_read_b64_tr_b16 a[164:165], v29 offset:32768
    v_mfma_f32_16x16x32_bf16 v[100:103], a[68:71], v[200:203], v[100:103]
    ds_read_b64_tr_b16 a[166:167], v29 offset:34816
    ds_read_b64_tr_b16 a[168:169], v30 offset:32768
    v_mfma_f32_16x16x32_bf16 v[100:103], a[84:87], v[204:207], v[100:103]
    ds_read_b64_tr_b16 a[170:171], v30 offset:34816
    ds_read_b64_tr_b16 a[172:173], v31 offset:32768
    v_mfma_f32_16x16x32_bf16 v[104:107], a[72:75], v[200:203], v[104:107]
    buffer_load_dwordx4 v[132:135], v12, s[44:47], s93 offen sc1
    ds_read_b64_tr_b16 a[174:175], v31 offset:34816
    v_mfma_f32_16x16x32_bf16 v[104:107], a[88:91], v[204:207], v[104:107]
    ds_read_b64_tr_b16 a[176:177], v28 offset:36864
    ds_read_b64_tr_b16 a[178:179], v28 offset:38912
    v_mfma_f32_16x16x32_bf16 v[108:111], a[76:79], v[200:203], v[108:111]
    ds_read_b64_tr_b16 a[180:181], v29 offset:36864
    ds_read_b64_tr_b16 a[182:183], v29 offset:38912
    v_mfma_f32_16x16x32_bf16 v[108:111], a[92:95], v[204:207], v[108:111]
    ds_read_b64_tr_b16 a[184:185], v30 offset:36864
    ds_read_b64_tr_b16 a[186:187], v30 offset:38912
    v_mfma_f32_16x16x32_bf16 v[112:115], a[64:67], v[208:211], v[112:115]
    buffer_load_dwordx4 v[136:139], v12, s[44:47], s86 offen sc1
    v_mfma_f32_16x16x32_bf16 v[112:115], a[80:83], v[212:215], v[112:115]
    ds_read_b64_tr_b16 a[188:189], v31 offset:36864
    v_mfma_f32_16x16x32_bf16 v[116:119], a[68:71], v[208:211], v[116:119]
    ds_read_b64_tr_b16 a[190:191], v31 offset:38912
    v_mfma_f32_16x16x32_bf16 v[116:119], a[84:87], v[212:215], v[116:119]
    v_mfma_f32_16x16x32_bf16 v[120:123], a[72:75], v[208:211], v[120:123]
    buffer_load_dwordx4 v[140:143], v12, s[44:47], s87 offen sc1
    v_mfma_f32_16x16x32_bf16 v[120:123], a[88:91], v[212:215], v[120:123]
    v_mfma_f32_16x16x32_bf16 v[124:127], a[76:79], v[208:211], v[124:127]
    v_mfma_f32_16x16x32_bf16 v[124:127], a[92:95], v[212:215], v[124:127]
    v_mfma_f32_16x16x32_bf16 v[64:67], a[64:67], v[216:219], v[64:67]
    buffer_load_dwordx4 v[144:147], v4, s[44:47], s92 offen sc1
    v_mfma_f32_16x16x32_bf16 v[64:67], a[80:83], v[220:223], v[64:67]
    v_mfma_f32_16x16x32_bf16 v[68:71], a[68:71], v[216:219], v[68:71]
    v_mfma_f32_16x16x32_bf16 v[68:71], a[84:87], v[220:223], v[68:71]
    v_mfma_f32_16x16x32_bf16 v[72:75], a[72:75], v[216:219], v[72:75]
    buffer_load_dwordx4 v[148:151], v4, s[44:47], s93 offen sc1
    v_mfma_f32_16x16x32_bf16 v[72:75], a[88:91], v[220:223], v[72:75]
    v_mfma_f32_16x16x32_bf16 v[76:79], a[76:79], v[216:219], v[76:79]
    v_mfma_f32_16x16x32_bf16 v[76:79], a[92:95], v[220:223], v[76:79]
    s_waitcnt vmcnt(15)
    v_mfma_f32_16x16x32_bf16 v[80:83], a[192:195], v[224:227], v[80:83]
    s_waitcnt vmcnt(14)
    buffer_load_dwordx4 v[152:155], v4, s[44:47], s86 offen sc1
    ds_read_b64_tr_b16 a[64:65], v28 offset:40960
    v_mfma_f32_16x16x32_bf16 v[80:83], a[208:211], v[228:231], v[80:83]
    ds_read_b64_tr_b16 a[66:67], v28 offset:43008
    ds_read_b64_tr_b16 a[68:69], v29 offset:40960
    v_mfma_f32_16x16x32_bf16 v[84:87], a[196:199], v[224:227], v[84:87]
    ds_read_b64_tr_b16 a[70:71], v29 offset:43008
    ds_read_b64_tr_b16 a[72:73], v30 offset:40960
    v_mfma_f32_16x16x32_bf16 v[84:87], a[212:215], v[228:231], v[84:87]
    ds_read_b64_tr_b16 a[74:75], v30 offset:43008
    ds_read_b64_tr_b16 a[76:77], v31 offset:40960
    v_mfma_f32_16x16x32_bf16 v[88:91], a[200:203], v[224:227], v[88:91]
    buffer_load_dwordx4 v[156:159], v4, s[44:47], s87 offen sc1
    ds_read_b64_tr_b16 a[78:79], v31 offset:43008
    v_mfma_f32_16x16x32_bf16 v[88:91], a[216:219], v[228:231], v[88:91]
    ds_read_b64_tr_b16 a[80:81], v28 offset:45056
    ds_read_b64_tr_b16 a[82:83], v28 offset:47104
    v_mfma_f32_16x16x32_bf16 v[92:95], a[204:207], v[224:227], v[92:95]
    ds_read_b64_tr_b16 a[84:85], v29 offset:45056
    ds_read_b64_tr_b16 a[86:87], v29 offset:47104
    v_mfma_f32_16x16x32_bf16 v[92:95], a[220:223], v[228:231], v[92:95]
    s_waitcnt vmcnt(13)
    ds_read_b64_tr_b16 a[88:89], v30 offset:45056
    ds_read_b64_tr_b16 a[90:91], v30 offset:47104
    v_mfma_f32_16x16x32_bf16 v[80:83], a[96:99], v[232:235], v[80:83]
    s_xor_b32 s92, s65, 0
    s_add_u32 s92, s92, s68
    buffer_load_dwordx4 v[160:163], v4, s[44:47], s92 offen sc1
    ds_read_b64_tr_b16 a[92:93], v31 offset:45056
    s_waitcnt vmcnt(13) lgkmcnt(11)
    v_mfma_f32_16x16x32_bf16 v[80:83], a[112:115], v[236:239], v[80:83]
    ds_read_b64_tr_b16 a[94:95], v31 offset:47104
    ds_read_b64 v[48:49], v58 offset:0
    v_mfma_f32_16x16x32_bf16 v[84:87], a[100:103], v[232:235], v[84:87]
    ds_read_b64 v[50:51], v58 offset:32
    ds_read_b64 v[52:53], v58 offset:64
    v_mfma_f32_16x16x32_bf16 v[84:87], a[116:119], v[236:239], v[84:87]
    s_xor_b32 s93, s65, 4096
    ds_read_b64 v[54:55], v58 offset:96
    v_mfma_f32_16x16x32_bf16 v[88:91], a[104:107], v[232:235], v[88:91]
    s_add_u32 s93, s93, s68
    buffer_load_dwordx4 v[164:167], v4, s[44:47], s93 offen sc1
    v_mfma_f32_16x16x32_bf16 v[88:91], a[120:123], v[236:239], v[88:91]
    v_mfma_f32_16x16x32_bf16 v[92:95], a[108:111], v[232:235], v[92:95]
    v_mfma_f32_16x16x32_bf16 v[92:95], a[124:127], v[236:239], v[92:95]
    s_waitcnt vmcnt(13)
    v_mfma_f32_16x16x32_bf16 v[96:99], a[192:195], v[240:243], v[96:99]
    s_xor_b32 s92, s65, 8192
    s_add_u32 s92, s92, s68
    buffer_load_dwordx4 v[168:171], v4, s[44:47], s92 offen sc1
    s_waitcnt vmcnt(13)
    v_mfma_f32_16x16x32_bf16 v[96:99], a[208:211], v[244:247], v[96:99]
    s_waitcnt lgkmcnt(1)
    ds_write_b128 v9, v[80:83] offset:0
    v_lshlrev_b32_e64 v224, 16, v48
    v_mfma_f32_16x16x32_bf16 v[100:103], a[196:199], v[240:243], v[100:103]
    v_and_b32 v225, 0xffff0000, v48
    v_lshlrev_b32_e64 v226, 16, v49
    v_mfma_f32_16x16x32_bf16 v[100:103], a[212:215], v[244:247], v[100:103]
    s_xor_b32 s93, s65, 12288
    v_and_b32 v227, 0xffff0000, v49
    v_lshlrev_b32_e64 v228, 16, v50
    v_mfma_f32_16x16x32_bf16 v[104:107], a[200:203], v[240:243], v[104:107]
    s_add_u32 s93, s93, s68
    buffer_load_dwordx4 v[172:175], v4, s[44:47], s93 offen sc1
    v_mfma_f32_16x16x32_bf16 v[104:107], a[216:219], v[244:247], v[104:107]
    ds_write_b128 v9, v[84:87] offset:1024
    v_and_b32 v229, 0xffff0000, v50
    v_mfma_f32_16x16x32_bf16 v[108:111], a[204:207], v[240:243], v[108:111]
    v_lshlrev_b32 v230, 16, v51
    v_and_b32 v231, 0xffff0000, v51
    v_mfma_f32_16x16x32_bf16 v[108:111], a[220:223], v[244:247], v[108:111]
    s_waitcnt vmcnt(13)
    v_lshlrev_b32 v232, 16, v52
    v_and_b32 v233, 0xffff0000, v52
    v_mfma_f32_16x16x32_bf16 v[96:99], a[96:99], v[248:251], v[96:99]
    s_xor_b32 s92, s65, 16384
    s_add_u32 s92, s92, s68
    buffer_load_dwordx4 v[176:179], v4, s[44:47], s92 offen sc1
    s_waitcnt vmcnt(13)
    v_mfma_f32_16x16x32_bf16 v[96:99], a[112:115], v[252:255], v[96:99]
    ds_write_b128 v9, v[88:91] offset:2048
    v_lshlrev_b32_e64 v234, 16, v53
    v_mfma_f32_16x16x32_bf16 v[100:103], a[100:103], v[248:251], v[100:103]
    s_waitcnt lgkmcnt(3)
    v_and_b32 v235, 0xffff0000, v53
    v_lshlrev_b32 v236, 16, v54
    v_mfma_f32_16x16x32_bf16 v[100:103], a[116:119], v[252:255], v[100:103]
    s_xor_b32 s93, s65, 20480
    v_and_b32 v237, 0xffff0000, v54
    v_lshlrev_b32_e64 v238, 16, v55
    v_mfma_f32_16x16x32_bf16 v[104:107], a[104:107], v[248:251], v[104:107]
    s_add_u32 s93, s93, s68
    buffer_load_dwordx4 v[180:183], v4, s[44:47], s93 offen sc1
    v_mfma_f32_16x16x32_bf16 v[104:107], a[120:123], v[252:255], v[104:107]
    ds_write_b128 v9, v[92:95] offset:3072
    v_and_b32 v239, 0xffff0000, v55
    v_mfma_f32_16x16x32_bf16 v[108:111], a[108:111], v[248:251], v[108:111]
    v_mfma_f32_16x16x32_bf16 v[108:111], a[124:127], v[252:255], v[108:111]
    s_waitcnt vmcnt(13)
    v_mfma_f32_16x16x32_bf16 v[112:115], a[192:195], v[128:131], v[112:115]
    s_xor_b32 s92, s65, 24576
    s_add_u32 s92, s92, s68
    buffer_load_dwordx4 v[184:187], v4, s[44:47], s92 offen sc1
    s_waitcnt vmcnt(13)
    v_mfma_f32_16x16x32_bf16 v[112:115], a[208:211], v[132:135], v[112:115]
    ds_write_b128 v9, v[96:99] offset:16384
    v_mfma_f32_16x16x32_bf16 v[116:119], a[196:199], v[128:131], v[116:119]
    v_mfma_f32_16x16x32_bf16 v[116:119], a[212:215], v[132:135], v[116:119]
    s_xor_b32 s93, s65, 28672
    v_mfma_f32_16x16x32_bf16 v[120:123], a[200:203], v[128:131], v[120:123]
    s_add_u32 s93, s93, s68
    buffer_load_dwordx4 v[188:191], v4, s[44:47], s93 offen sc1
    v_mfma_f32_16x16x32_bf16 v[120:123], a[216:219], v[132:135], v[120:123]
    ds_write_b128 v9, v[100:103] offset:17408
    v_mfma_f32_16x16x32_bf16 v[124:127], a[204:207], v[128:131], v[124:127]
    v_mfma_f32_16x16x32_bf16 v[124:127], a[220:223], v[132:135], v[124:127]
    s_waitcnt vmcnt(13)
    v_mfma_f32_16x16x32_bf16 v[112:115], a[96:99], v[136:139], v[112:115]
    s_xor_b32 s92, s65, 32768
    s_add_u32 s92, s92, s68
    buffer_load_dwordx4 v[192:195], v4, s[44:47], s92 offen sc1
    s_waitcnt vmcnt(13)
    v_mfma_f32_16x16x32_bf16 v[112:115], a[112:115], v[140:143], v[112:115]
    ds_write_b128 v9, v[104:107] offset:18432
    v_mfma_f32_16x16x32_bf16 v[116:119], a[100:103], v[136:139], v[116:119]
    v_mfma_f32_16x16x32_bf16 v[116:119], a[116:119], v[140:143], v[116:119]
    s_xor_b32 s93, s65, 36864
    v_mfma_f32_16x16x32_bf16 v[120:123], a[104:107], v[136:139], v[120:123]
    s_add_u32 s93, s93, s68
    buffer_load_dwordx4 v[196:199], v4, s[44:47], s93 offen sc1
    v_mfma_f32_16x16x32_bf16 v[120:123], a[120:123], v[140:143], v[120:123]
    ds_write_b128 v9, v[108:111] offset:19456
    v_mfma_f32_16x16x32_bf16 v[124:127], a[108:111], v[136:139], v[124:127]
    v_mfma_f32_16x16x32_bf16 v[124:127], a[124:127], v[140:143], v[124:127]
    s_waitcnt vmcnt(13)
    v_mfma_f32_16x16x32_bf16 v[64:67], a[192:195], v[144:147], v[64:67]
    s_xor_b32 s92, s65, 40960
    s_add_u32 s92, s92, s68
    buffer_load_dwordx4 v[200:203], v4, s[44:47], s92 offen sc1
    s_waitcnt vmcnt(13)
    v_mfma_f32_16x16x32_bf16 v[64:67], a[208:211], v[148:151], v[64:67]
    ds_write_b128 v9, v[112:115] offset:32768
    v_mfma_f32_16x16x32_bf16 v[68:71], a[196:199], v[144:147], v[68:71]
    v_mfma_f32_16x16x32_bf16 v[68:71], a[212:215], v[148:151], v[68:71]
    s_xor_b32 s93, s65, 45056
    v_mfma_f32_16x16x32_bf16 v[72:75], a[200:203], v[144:147], v[72:75]
    s_add_u32 s93, s93, s68
    buffer_load_dwordx4 v[204:207], v4, s[44:47], s93 offen sc1
    v_mfma_f32_16x16x32_bf16 v[72:75], a[216:219], v[148:151], v[72:75]
    ds_write_b128 v9, v[116:119] offset:33792
    v_mfma_f32_16x16x32_bf16 v[76:79], a[204:207], v[144:147], v[76:79]
    v_mfma_f32_16x16x32_bf16 v[76:79], a[220:223], v[148:151], v[76:79]
    s_waitcnt vmcnt(13)
    v_mfma_f32_16x16x32_bf16 v[64:67], a[96:99], v[152:155], v[64:67]
    s_xor_b32 s92, s65, 49152
    s_add_u32 s92, s92, s68
    buffer_load_dwordx4 v[208:211], v4, s[44:47], s92 offen sc1
    s_waitcnt vmcnt(13)
    v_mfma_f32_16x16x32_bf16 v[64:67], a[112:115], v[156:159], v[64:67]
    ds_write_b128 v9, v[120:123] offset:34816
    v_mfma_f32_16x16x32_bf16 v[68:71], a[100:103], v[152:155], v[68:71]
    v_mfma_f32_16x16x32_bf16 v[68:71], a[116:119], v[156:159], v[68:71]
    s_xor_b32 s93, s65, 53248
    v_mfma_f32_16x16x32_bf16 v[72:75], a[104:107], v[152:155], v[72:75]
    s_add_u32 s93, s93, s68
    buffer_load_dwordx4 v[212:215], v4, s[44:47], s93 offen sc1
    v_mfma_f32_16x16x32_bf16 v[72:75], a[120:123], v[156:159], v[72:75]
    ds_write_b128 v9, v[124:127] offset:35840
    v_mfma_f32_16x16x32_bf16 v[76:79], a[108:111], v[152:155], v[76:79]
    v_mfma_f32_16x16x32_bf16 v[76:79], a[124:127], v[156:159], v[76:79]
    s_waitcnt vmcnt(13)
    v_mfma_f32_16x16x32_bf16 v[32:35], a[224:227], v[160:163], 0
    s_xor_b32 s92, s65, 57344
    s_add_u32 s92, s92, s68
    buffer_load_dwordx4 v[216:219], v4, s[44:47], s92 offen sc1
    s_waitcnt vmcnt(13)
    v_mfma_f32_16x16x32_bf16 v[32:35], a[240:243], v[164:167], v[32:35]
    s_waitcnt vmcnt(12)
    ds_read_b64_tr_b16 a[192:193], v28 offset:49152
    ds_read_b64_tr_b16 a[194:195], v28 offset:51200
    v_mfma_f32_16x16x32_bf16 v[32:35], a[0:3], v[168:171], v[32:35]
    s_waitcnt vmcnt(11)
    ds_read_b64_tr_b16 a[196:197], v29 offset:49152
    ds_read_b64_tr_b16 a[198:199], v29 offset:51200
    v_mfma_f32_16x16x32_bf16 v[32:35], a[16:19], v[172:175], v[32:35]
    s_xor_b32 s93, s65, 61440
    ds_read_b64_tr_b16 a[200:201], v30 offset:49152
    ds_read_b64_tr_b16 a[202:203], v30 offset:51200
    v_mfma_f32_16x16x32_bf16 v[36:39], a[228:231], v[160:163], 0
    s_add_u32 s93, s93, s68
    buffer_load_dwordx4 v[220:223], v4, s[44:47], s93 offen sc1
    ds_read_b64_tr_b16 a[204:205], v31 offset:49152
    v_mfma_f32_16x16x32_bf16 v[36:39], a[244:247], v[164:167], v[36:39]
    ds_read_b64_tr_b16 a[206:207], v31 offset:51200
    ds_read_b64_tr_b16 a[208:209], v28 offset:53248
    v_mfma_f32_16x16x32_bf16 v[36:39], a[4:7], v[168:171], v[36:39]
    ds_read_b64_tr_b16 a[210:211], v28 offset:55296
    ds_read_b64_tr_b16 a[212:213], v29 offset:53248
    v_mfma_f32_16x16x32_bf16 v[36:39], a[20:23], v[172:175], v[36:39]
    s_waitcnt lgkmcnt(11)
    ds_read_b64_tr_b16 a[214:215], v29 offset:55296
    ds_read_b64_tr_b16 a[216:217], v30 offset:53248
    s_barrier
    v_mfma_f32_16x16x32_bf16 v[40:43], a[232:235], v[160:163], 0
    ds_read_b128 v[80:83], v10 offset:0
    ds_read_b128 v[96:99], v11 offset:16384
    v_mfma_f32_16x16x32_bf16 v[40:43], a[248:251], v[164:167], v[40:43]
    ds_read_b128 v[112:115], v13 offset:32768
    ds_read_b128 v[84:87], v10 offset:1024
    v_mfma_f32_16x16x32_bf16 v[40:43], a[8:11], v[168:171], v[40:43]
    ds_read_b128 v[100:103], v11 offset:17408
    ds_read_b128 v[116:119], v13 offset:33792
    v_mfma_f32_16x16x32_bf16 v[40:43], a[24:27], v[172:175], v[40:43]
    ds_read_b128 v[88:91], v10 offset:2048
    ds_read_b128 v[104:107], v11 offset:18432
    v_mfma_f32_16x16x32_bf16 v[44:47], a[236:239], v[160:163], 0
    ds_read_b128 v[120:123], v13 offset:34816
    ds_read_b128 v[92:95], v10 offset:3072
    v_mfma_f32_16x16x32_bf16 v[44:47], a[252:255], v[164:167], v[44:47]
    ds_read_b128 v[108:111], v11 offset:19456
    ds_read_b128 v[124:127], v13 offset:35840
    v_mfma_f32_16x16x32_bf16 v[44:47], a[12:15], v[168:171], v[44:47]
    ds_read_b64_tr_b16 a[218:219], v30 offset:55296
    ds_read_b64_tr_b16 a[220:221], v31 offset:53248
    v_mfma_f32_16x16x32_bf16 v[44:47], a[28:31], v[172:175], v[44:47]
    s_waitcnt vmcnt(11) lgkmcnt(12)
    ds_read_b64_tr_b16 a[222:223], v31 offset:55296
    ds_read_b64_tr_b16 a[96:97], v28 offset:57344
    v_add_f32_e64 v64, v64, v80
    v_mfma_f32_16x16x32_bf16 v[32:35], a[128:131], v[176:179], v[32:35]
    s_waitcnt vmcnt(10) lgkmcnt(12)
    ds_read_b64_tr_b16 a[98:99], v28 offset:59392
    ds_read_b64_tr_b16 a[100:101], v29 offset:57344
    v_add_f32 v96, v96, v112
    v_mfma_f32_16x16x32_bf16 v[32:35], a[144:147], v[180:183], v[32:35]
    s_waitcnt vmcnt(9)
    ds_read_b64_tr_b16 a[102:103], v29 offset:59392
    ds_read_b64_tr_b16 a[104:105], v30 offset:57344
    v_add_f32 v64, v64, v96
    v_mfma_f32_16x16x32_bf16 v[32:35], a[32:35], v[184:187], v[32:35]
    s_waitcnt vmcnt(8)
    ds_read_b64_tr_b16 a[106:107], v30 offset:59392
    ds_read_b64_tr_b16 a[108:109], v31 offset:57344
    v_mul_f32 v80, s76, v64
    v_mfma_f32_16x16x32_bf16 v[32:35], a[48:51], v[188:191], v[32:35]
    ds_read_b64_tr_b16 a[110:111], v31 offset:59392
    ds_read_b64_tr_b16 a[112:113], v28 offset:61440
    v_add_f32_e64 v65, v65, v81
    v_mfma_f32_16x16x32_bf16 v[36:39], a[132:135], v[176:179], v[36:39]
    ds_read_b64_tr_b16 a[114:115], v28 offset:63488
    ds_read_b64_tr_b16 a[116:117], v29 offset:61440
    v_add_f32_e64 v97, v97, v113
    v_mfma_f32_16x16x32_bf16 v[36:39], a[148:151], v[180:183], v[36:39]
    ds_read_b64_tr_b16 a[118:119], v29 offset:63488
    ds_read_b64_tr_b16 a[120:121], v30 offset:61440
    v_add_f32_e64 v65, v65, v97
    v_mfma_f32_16x16x32_bf16 v[36:39], a[36:39], v[184:187], v[36:39]
    ds_read_b64_tr_b16 a[122:123], v30 offset:63488
    ds_read_b64_tr_b16 a[124:125], v31 offset:61440
    v_mul_f32_e64 v81, s76, v65
    v_mfma_f32_16x16x32_bf16 v[36:39], a[52:55], v[188:191], v[36:39]
    ds_read_b64_tr_b16 a[126:127], v31 offset:63488
    v_exp_f32 v80, v80
    v_add_f32 v66, v66, v82
    v_mfma_f32_16x16x32_bf16 v[40:43], a[136:139], v[176:179], v[40:43]
    v_exp_f32 v81, v81
    v_add_f32 v80, 1.0, v80
    v_add_f32_e64 v98, v98, v114
    v_mfma_f32_16x16x32_bf16 v[40:43], a[152:155], v[180:183], v[40:43]
    v_rcp_f32 v80, v80
    v_add_f32 v81, 1.0, v81
    v_add_f32_e64 v66, v66, v98
    v_mfma_f32_16x16x32_bf16 v[40:43], a[40:43], v[184:187], v[40:43]
    v_rcp_f32 v81, v81
    v_mul_f32 v64, v64, v80
    v_mul_f32_e64 v82, s76, v66
    v_mfma_f32_16x16x32_bf16 v[40:43], a[56:59], v[188:191], v[40:43]
    v_exp_f32 v82, v82
    v_mul_f32 v65, v65, v81
    v_add_f32_e64 v67, v67, v83
    v_mfma_f32_16x16x32_bf16 v[44:47], a[140:143], v[176:179], v[44:47]
    v_add_f32 v82, 1.0, v82
    v_rcp_f32 v82, v82
    v_add_f32_e64 v99, v99, v115
    v_mfma_f32_16x16x32_bf16 v[44:47], a[156:159], v[180:183], v[44:47]
    v_mul_f32 v66, v66, v82
    v_add_f32 v67, v67, v99
    v_mul_f32 v83, s76, v67
    v_add_f32 v68, v68, v84
    v_mfma_f32_16x16x32_bf16 v[44:47], a[44:47], v[184:187], v[44:47]
    s_waitcnt lgkmcnt(0)
    v_exp_f32 v83, v83
    v_add_f32 v100, v100, v116
    v_add_f32 v68, v68, v100
    v_mfma_f32_16x16x32_bf16 v[44:47], a[60:63], v[188:191], v[44:47]
    s_waitcnt vmcnt(7)
    v_add_f32 v83, 1.0, v83
    v_rcp_f32 v83, v83
    v_mul_f32 v84, s76, v68
    v_mfma_f32_16x16x32_bf16 v[32:35], a[160:163], v[192:195], v[32:35]
    s_waitcnt vmcnt(6)
    v_exp_f32 v84, v84
    v_mul_f32 v67, v67, v83
    v_add_f32 v69, v69, v85
    v_mfma_f32_16x16x32_bf16 v[32:35], a[176:179], v[196:199], v[32:35]
    s_waitcnt vmcnt(5)
    v_add_f32 v84, 1.0, v84
    v_rcp_f32 v84, v84
    v_add_f32 v101, v101, v117
    v_mfma_f32_16x16x32_bf16 v[32:35], a[64:67], v[200:203], v[32:35]
    s_waitcnt vmcnt(4)
    v_mul_f32 v68, v68, v84
    v_add_f32 v69, v69, v101
    v_mul_f32 v85, s76, v69
    v_add_f32_e64 v70, v70, v86
    v_mfma_f32_16x16x32_bf16 v[32:35], a[80:83], v[204:207], v[32:35]
    v_exp_f32 v85, v85
    v_add_f32 v102, v102, v118
    v_add_f32_e64 v70, v70, v102
    v_mfma_f32_16x16x32_bf16 v[36:39], a[164:167], v[192:195], v[36:39]
    v_add_f32 v85, 1.0, v85
    v_rcp_f32 v85, v85
    v_mul_f32_e64 v86, s76, v70
    v_mfma_f32_16x16x32_bf16 v[36:39], a[180:183], v[196:199], v[36:39]
    v_exp_f32 v86, v86
    v_mul_f32 v69, v69, v85
    v_add_f32_e64 v71, v71, v87
    v_mfma_f32_16x16x32_bf16 v[36:39], a[68:71], v[200:203], v[36:39]
    v_add_f32 v86, 1.0, v86
    v_rcp_f32 v86, v86
    v_add_f32_e64 v103, v103, v119
    v_mfma_f32_16x16x32_bf16 v[36:39], a[84:87], v[204:207], v[36:39]
    v_mul_f32 v70, v70, v86
    v_add_f32 v71, v71, v103
    v_mul_f32 v87, s76, v71
    v_add_f32 v72, v72, v88
    v_mfma_f32_16x16x32_bf16 v[40:43], a[168:171], v[192:195], v[40:43]
    v_exp_f32 v87, v87
    v_add_f32 v104, v104, v120
    v_add_f32_e64 v72, v72, v104
    v_mfma_f32_16x16x32_bf16 v[40:43], a[184:187], v[196:199], v[40:43]
    v_add_f32 v87, 1.0, v87
    v_rcp_f32 v87, v87
    v_mul_f32_e64 v88, s76, v72
    v_mfma_f32_16x16x32_bf16 v[40:43], a[72:75], v[200:203], v[40:43]
    v_exp_f32 v88, v88
    v_mul_f32 v71, v71, v87
    v_add_f32_e64 v73, v73, v89
    v_mfma_f32_16x16x32_bf16 v[40:43], a[88:91], v[204:207], v[40:43]
    v_add_f32 v88, 1.0, v88
    v_rcp_f32 v88, v88
    v_add_f32_e64 v105, v105, v121
    v_mfma_f32_16x16x32_bf16 v[44:47], a[172:175], v[192:195], v[44:47]
    v_mul_f32 v72, v72, v88
    v_add_f32 v73, v73, v105
    v_mul_f32 v89, s76, v73
    v_add_f32 v74, v74, v90
    v_mfma_f32_16x16x32_bf16 v[44:47], a[188:191], v[196:199], v[44:47]
    v_exp_f32 v89, v89
    v_add_f32 v106, v106, v122
    v_add_f32_e64 v74, v74, v106
    v_mfma_f32_16x16x32_bf16 v[44:47], a[76:79], v[200:203], v[44:47]
    v_add_f32 v89, 1.0, v89
    v_rcp_f32 v89, v89
    v_mul_f32_e64 v90, s76, v74
    v_mfma_f32_16x16x32_bf16 v[44:47], a[92:95], v[204:207], v[44:47]
    s_waitcnt vmcnt(3)
    v_exp_f32 v90, v90
    v_mul_f32 v73, v73, v89
    v_add_f32 v75, v75, v91
    v_mfma_f32_16x16x32_bf16 v[32:35], a[192:195], v[208:211], v[32:35]
    s_waitcnt vmcnt(2)
    v_add_f32 v90, 1.0, v90
    v_rcp_f32 v90, v90
    v_add_f32 v107, v107, v123
    v_mfma_f32_16x16x32_bf16 v[32:35], a[208:211], v[212:215], v[32:35]
    s_waitcnt vmcnt(1)
    v_mul_f32 v74, v74, v90
    v_add_f32 v75, v75, v107
    v_mul_f32 v91, s76, v75
    v_add_f32_e64 v76, v76, v92
    v_mfma_f32_16x16x32_bf16 v[32:35], a[96:99], v[216:219], v[32:35]
    s_waitcnt vmcnt(0)
    v_exp_f32 v91, v91
    v_add_f32 v108, v108, v124
    v_add_f32 v76, v76, v108
    v_mfma_f32_16x16x32_bf16 v[32:35], a[112:115], v[220:223], v[32:35]
    v_add_f32 v91, 1.0, v91
    v_rcp_f32 v91, v91
    v_mul_f32_e64 v92, s76, v76
    v_mfma_f32_16x16x32_bf16 v[36:39], a[196:199], v[208:211], v[36:39]
    v_exp_f32 v92, v92
    v_mul_f32 v75, v75, v91
    v_add_f32_e64 v77, v77, v93
    v_mfma_f32_16x16x32_bf16 v[36:39], a[212:215], v[212:215], v[36:39]
    v_add_f32 v92, 1.0, v92
    v_rcp_f32 v92, v92
    v_add_f32_e64 v109, v109, v125
    v_mfma_f32_16x16x32_bf16 v[36:39], a[100:103], v[216:219], v[36:39]
    v_mul_f32 v76, v76, v92
    v_add_f32 v77, v77, v109
    v_mul_f32 v93, s76, v77
    v_add_f32 v78, v78, v94
    v_mfma_f32_16x16x32_bf16 v[36:39], a[116:119], v[220:223], v[36:39]
    v_exp_f32 v93, v93
    v_add_f32 v110, v110, v126
    v_add_f32_e64 v78, v78, v110
    v_mfma_f32_16x16x32_bf16 v[40:43], a[200:203], v[208:211], v[40:43]
    v_add_f32 v93, 1.0, v93
    v_rcp_f32 v93, v93
    v_mul_f32_e64 v94, s76, v78
    v_mfma_f32_16x16x32_bf16 v[40:43], a[216:219], v[212:215], v[40:43]
    v_exp_f32 v94, v94
    v_mul_f32 v77, v77, v93
    v_add_f32_e64 v79, v79, v95
    v_mfma_f32_16x16x32_bf16 v[40:43], a[104:107], v[216:219], v[40:43]
    v_add_f32 v94, 1.0, v94
    v_rcp_f32 v94, v94
    v_add_f32_e64 v111, v111, v127
    v_mfma_f32_16x16x32_bf16 v[40:43], a[120:123], v[220:223], v[40:43]
    v_mul_f32 v78, v78, v94
    v_add_f32 v79, v79, v111
    v_mul_f32_e64 v95, s76, v79
    v_fma_f32 v32, v32, v64, v224
    v_mfma_f32_16x16x32_bf16 v[44:47], a[204:207], v[208:211], v[44:47]
    v_exp_f32_e64 v95, v95
    v_fma_f32 v33, v33, v65, v225
    v_fma_f32 v34, v34, v66, v226
    v_mfma_f32_16x16x32_bf16 v[44:47], a[220:223], v[212:215], v[44:47]
    v_add_f32 v95, 1.0, v95
    v_rcp_f32 v95, v95
    v_fma_f32 v35, v35, v67, v227
    v_mfma_f32_16x16x32_bf16 v[44:47], a[108:111], v[216:219], v[44:47]
    v_mul_f32_e64 v79, v79, v95
    v_cvt_pk_bf16_f32 v32, v32, v33
    v_cvt_pk_bf16_f32 v33, v34, v35
    v_fma_f32 v36, v36, v68, v228
    v_mfma_f32_16x16x32_bf16 v[44:47], a[124:127], v[220:223], v[44:47]
    ds_write_b64 v57, v[32:33] offset:0
    v_fma_f32 v37, v37, v69, v229
    v_fma_f32 v38, v38, v70, v230
    v_fma_f32 v39, v39, v71, v231
    v_cvt_pk_bf16_f32 v36, v36, v37
    v_cvt_pk_bf16_f32 v37, v38, v39
    ds_write_b64 v57, v[36:37] offset:32
    v_fma_f32 v40, v40, v72, v232
    v_fma_f32 v41, v41, v73, v233
    v_fma_f32 v42, v42, v74, v234
    v_fma_f32 v43, v43, v75, v235
    v_cvt_pk_bf16_f32 v40, v40, v41
    v_cvt_pk_bf16_f32 v41, v42, v43
    v_fma_f32 v44, v44, v76, v236
    v_fma_f32 v45, v45, v77, v237
    ds_write_b64 v57, v[40:41] offset:64
    v_fma_f32 v46, v46, v78, v238
    v_fma_f32 v47, v47, v79, v239
    v_cvt_pk_bf16_f32 v44, v44, v45
    v_cvt_pk_bf16_f32 v45, v46, v47
    ds_write_b64 v57, v[44:45] offset:96
    ds_read_b128 v[96:99], v56 offset:0
    ds_read_b128 v[100:103], v56 offset:1152
    s_add_u32 s59, s91, 8192
    s_waitcnt lgkmcnt(1)
    buffer_store_dwordx4 v[96:99], v8, s[36:39], s91 offen sc1
    s_waitcnt lgkmcnt(0)
    buffer_store_dwordx4 v[100:103], v8, s[36:39], s59 offen sc1
    s_endpgm
L_q_retry0:
    s_mov_b32 s85, 0x40000
L_q_retry0_loop:
    s_sleep 1
    buffer_load_dword v17, v3, s[40:43], 0 offen sc1
    s_waitcnt vmcnt(0)
    v_cmp_gt_u32 vcc, 1, v17
    s_nop 1
    s_and_b32 vcc_lo, vcc_lo, 0xff
    s_cbranch_scc0 L_q_back0
    s_sub_u32 s85, s85, 1
    s_cbranch_scc0 L_q_retry0_loop
    s_branch L_q_back0
L_q_retry1:
    s_mov_b32 s85, 0x40000
L_q_retry1_loop:
    s_sleep 1
    buffer_load_dword v17, v3, s[48:51], s61 offen sc1
    s_waitcnt vmcnt(0)
    v_cmp_gt_u32 vcc, 1, v17
    s_nop 1
    s_and_b32 vcc_lo, vcc_lo, 0xffff
    s_cbranch_scc0 L_q_back1
    s_sub_u32 s85, s85, 1
    s_cbranch_scc0 L_q_retry1_loop
    s_branch L_q_back1
L_q_retry2:
    s_mov_b32 s85, 0x40000
L_q_retry2_loop:
    s_sleep 1
    buffer_load_dword v17, v3, s[48:51], s90 offen sc1
    s_waitcnt vmcnt(0)
    v_cmp_gt_u32 vcc, 1, v17
    s_nop 1
    s_and_b32 vcc_lo, vcc_lo, 0xff00
    s_cbranch_scc0 L_q_back2
    s_sub_u32 s85, s85, 1
    s_cbranch_scc0 L_q_retry2_loop
    s_branch L_q_back2
L_q_retry3:
    s_mov_b32 s85, 0x40000
L_q_retry3_loop:
    s_sleep 1
    buffer_load_dword v17, v3, s[48:51], s90 offen sc1
    s_waitcnt vmcnt(0)
    v_cmp_gt_u32 vcc, 1, v17
    s_nop 1
    s_and_b32 vcc_lo, vcc_lo, 0xff
    s_cbranch_scc0 L_q_back3
    s_sub_u32 s85, s85, 1
    s_cbranch_scc0 L_q_retry3_loop
    s_branch L_q_back3
L_q_retry4:
    s_mov_b32 s85, 0x40000
L_q_retry4_loop:
    s_sleep 1
    buffer_load_dword v17, v3, s[48:51], s90 offen sc1
    s_waitcnt vmcnt(0)
    v_cmp_gt_u32 vcc, 2, v17
    s_nop 1
    s_and_b32 vcc_lo, vcc_lo, 0xff00
    s_cbranch_scc0 L_q_back4
    s_sub_u32 s85, s85, 1
    s_cbranch_scc0 L_q_retry4_loop
    s_branch L_q_back4
L_q_retry5:
    s_mov_b32 s85, 0x40000
L_q_retry5_loop:
    s_sleep 1
    buffer_load_dword v17, v3, s[48:51], s90 offen sc1
    s_waitcnt vmcnt(0)
    v_cmp_gt_u32 vcc, 2, v17
    s_nop 1
    s_and_b32 vcc_lo, vcc_lo, 0xff
    s_cbranch_scc0 L_q_back5
    s_sub_u32 s85, s85, 1
    s_cbranch_scc0 L_q_retry5_loop
    s_branch L_q_back5
L_code_end:
.section .rodata,"a"
.p2align 6
.amdhsa_kernel recurrent_scan__linear_kernel_hedgehog__glu_gated_bilinear__prompt_kernel
  .amdhsa_next_free_vgpr 512
  .amdhsa_next_free_sgpr 102
  .amdhsa_accum_offset 256
  .amdhsa_group_segment_fixed_size 0
  .amdhsa_kernarg_size 88
  .amdhsa_user_sgpr_count 2
  .amdhsa_user_sgpr_kernarg_segment_ptr 1
  .amdhsa_system_sgpr_workgroup_id_x 1
.end_amdhsa_kernel
```
